```python
import torch

def _softmax(x, axis=-1):
    return torch.softmax(x, dim=axis)
def _gelu(x):
    return torch.nn.functional.gelu(x, approximate="tanh")
def _silu(x):
    return torch.nn.functional.silu(x)
def _sigmoid(x):
    return torch.sigmoid(x)
def _layernorm(x, axis=-1, eps=1e-5):
    m = x.mean(dim=axis, keepdim=True)
    v = x.var(dim=axis, keepdim=True, unbiased=False)
    return (x - m) / torch.sqrt(v + eps)
def _scatter_add(tgt, idx, src, axis=0):
    return tgt.clone().index_add_(axis, idx, src)
def _segment_sum(src, seg, n):
    out = torch.zeros((n,) + src.shape[1:], dtype=src.dtype)
    return out.index_add_(0, seg, src)
def _pad(x, pw):
    flat = tuple(v for pair in reversed(pw) for v in pair)
    return torch.nn.functional.pad(x, flat)

kernel_name = 'parallel_sum__ssm_conv_s4d__glu_gated_reglu__prompt'

def setup_inputs():

    _w = (lambda a: (lambda t: t.to(torch.bfloat16) if t.is_floating_point() else t)(torch.as_tensor(a)))
    def _A_setup():
        Bsz, L, D, N = 1, 2048, 640, 128
        return {
            "u": _w((lambda *s: torch.randn(*s, dtype=torch.bfloat16) * 0.05)(Bsz, L, D)),
            "log_A_real": _w((lambda *s: torch.randn(*s, dtype=torch.bfloat16) * 3.2)(D, N) * 0.5),
            "A_imag": _w((lambda *s: torch.randn(*s, dtype=torch.bfloat16) * 0.05)(D, N) * 3.14),
            "C_real": _w((lambda *s: torch.randn(*s, dtype=torch.bfloat16) * 0.2)(D, N) / N ** 0.5),
            "C_imag": _w((lambda *s: torch.randn(*s, dtype=torch.bfloat16) * 0.2)(D, N) / N ** 0.5),
            "log_dt": _w((lambda *s: torch.randn(*s, dtype=torch.bfloat16) * 0.05)(D) * 0.5 - 4.0),
            "D_skip": _w((lambda *s: torch.randn(*s, dtype=torch.bfloat16) * 0.05)(D)),
        }
    _A_in = _A_setup()

    def _B_setup():
        B, S, D, F = 1, 2048, 640, 1728
        return {
            "x": _w((lambda *s: torch.randn(*s, dtype=torch.bfloat16) * 0.05)(B, S, D)),
            "W_gate": _w((lambda *s: torch.randn(*s, dtype=torch.bfloat16) * 0.4)(D, F) * (2.0 / D) ** 0.5),
            "W_up": _w((lambda *s: torch.randn(*s, dtype=torch.bfloat16) * 0.4)(D, F) * (2.0 / D) ** 0.5),
            "W_down": _w((lambda *s: torch.randn(*s, dtype=torch.bfloat16) * 0.4)(F, D) * (1.0 / F) ** 0.5),
        }
    _B_in = _B_setup()

    return {
        "A_u": _A_in["u"],
        "A_log_A_real": _A_in["log_A_real"],
        "A_A_imag": _A_in["A_imag"],
        "A_C_real": _A_in["C_real"],
        "A_C_imag": _A_in["C_imag"],
        "A_log_dt": _A_in["log_dt"],
        "A_D_skip": _A_in["D_skip"],
        "B_x": _B_in["x"],
        "B_W_gate": _B_in["W_gate"],
        "B_W_up": _B_in["W_up"],
        "B_W_down": _B_in["W_down"],
    }

def reference(A_u, A_log_A_real, A_A_imag, A_C_real, A_C_imag, A_log_dt, A_D_skip, B_x, B_W_gate, B_W_up, B_W_down):
    def _A_ref(u, log_A_real, A_imag, C_real, C_imag, log_dt, D_skip):
        L = u.shape[1]
        dt = torch.exp(log_dt)
        A = -torch.exp(log_A_real) + 1j * A_imag
        C = (C_real + 1j * C_imag) * dt[:, None]
        pos = (lambda x, dt: x.to(dt))(torch.arange(L), log_dt.dtype)
        P = torch.exp((A * dt[:, None])[:, :, None] * pos[None, None, :])
        K = 2.0 * torch.einsum("dn,dnl->dl", C, P).real
        L2 = 2 * L
        u_t = (lambda x, *d: x.permute(*d))(u, 0, 2, 1)
        Kf = (lambda x, *a, **k: torch.fft.rfft(x.float(), *a, **k))(K, L2)
        Uf = (lambda x, *a, **k: torch.fft.rfft(x.float(), *a, **k))(u_t, L2)
        y = (lambda x, *a, **k: torch.fft.irfft(x, *a, **k).to(torch.bfloat16))(Uf * Kf[None, :, :], L2)[:, :, :L]
        y = (lambda x, *d: x.permute(*d))(y, 0, 2, 1)
        return y + u * D_skip[None, None, :]

    def _B_ref(x, W_gate, W_up, W_down):
        gate = torch.einsum("bsd,df->bsf", x, W_gate)
        up = torch.einsum("bsd,df->bsf", x, W_up)
        gate = gate * (lambda x, dt: x.to(dt))(gate > 0, gate.dtype)
        h = gate * up
        return torch.einsum("bsf,fd->bsd", h, W_down)

    x = A_u
    xn = _layernorm(x, axis=-1)
    return x + _A_ref(xn, A_log_A_real, A_A_imag, A_C_real, A_C_imag, A_log_dt, A_D_skip) + _B_ref(xn, B_W_gate, B_W_up, B_W_down)
```

```asm
; @launch grid=(256,1,1) block=(512,1,1) lds=163840
.amdgcn_target "amdgcn-amd-amdhsa--gfx950"
.text
.globl parallel_sum__ssm_conv_s4d__glu_gated_reglu__prompt_kernel
.p2align 8
.type parallel_sum__ssm_conv_s4d__glu_gated_reglu__prompt_kernel,@function
parallel_sum__ssm_conv_s4d__glu_gated_reglu__prompt_kernel:
    s_cmp_ge_u32 s2, 256
    s_cbranch_scc1 K_end
    s_load_dwordx16 s[60:75], s[0:1], 0
    s_load_dwordx8 s[76:83], s[0:1], 64
    s_load_dwordx4 s[84:87], s[0:1], 96
    v_lshrrev_b32 v1, 6, v0
    s_nop 0
    v_readfirstlane_b32 s3, v1
    v_and_b32 v1, 63, v0
    s_and_b32 s32, s2, 7
    s_lshr_b32 s33, s2, 3
    s_lshl_b32 s47, s32, 2
    s_and_b32 s34, s33, 3
    s_add_u32 s47, s47, s34
    s_lshr_b32 s48, s33, 2
    s_mov_b32 s52, 0
    s_cmp_lg_u32 s3, 3
    s_cbranch_scc1 PF_done
    s_getpc_b64 s[34:35]
PF_base:
    v_lshl_add_u32 v2, v1, 5, s33
    v_lshlrev_b32 v2, 6, v2
    v_min_u32 v2, K_stop - PF_base - 4, v2
    global_load_dword v0, v2, s[34:35]
PF_done:
    s_cmp_lt_u32 s33, 4
    s_cbranch_scc1 SIDE
    s_sub_u32 s46, s2, 32
    s_sub_u32 s33, s33, 4
    s_bfe_u32 s34, s32, 0x10001
    s_mul_i32 s34, s34, 28
    s_add_u32 s34, s34, s33
    s_lshr_b32 s45, s32, 2
    s_mul_i32 s45, s45, 7
    s_lshr_b32 s35, s34, 3
    s_add_u32 s45, s45, s35
    s_and_b32 s44, s32, 1
    s_lshl_b32 s44, s44, 3
    s_and_b32 s34, s34, 7
    s_add_u32 s44, s44, s34
    s_cmp_lt_u32 s3, 4
    s_cbranch_scc1 COMPUTE
    s_cmp_ge_u32 s3, 6
    s_cbranch_scc1 KGEN
    s_sub_u32 s35, s3, 4
    v_lshrrev_b32 v4, 4, v1
    s_lshl_b32 s36, s35, 2
    v_add_u32 v4, s36, v4
    v_and_b32 v2, 7, v1
    v_xor_b32 v2, v2, v4
    v_lshlrev_b32 v2, 4, v2
    v_lshrrev_b32 v5, 3, v1
    v_mul_u32_u24 v5, 1280, v5
    v_add_u32 v2, v2, v5
    v_lshlrev_b32 v4, 1, v4
    v_and_b32 v3, 15, v1
    v_xor_b32 v3, v3, v4
    s_cmp_eq_u32 s45, 13
    s_cselect_b32 s36, 23, 0
    v_and_b32 v6, 8, v3
    v_lshlrev_b32 v6, s36, v6
    v_or_b32 v3, v3, v6
    v_lshlrev_b32 v3, 4, v3
    v_lshrrev_b32 v5, 4, v1
    v_mul_u32_u24 v5, 3456, v5
    v_add_u32 v3, v3, v5
    s_lshl_b32 s38, s44, 4
    s_add_u32 s38, s38, s35
    s_mul_i32 s38, s38, 10240
    s_mul_i32 s39, s35, 27648
    s_lshl_b32 s36, s45, 8
    s_add_u32 s39, s39, s36
    s_lshr_b32 s36, s44, 3
    s_mul_i32 s36, s36, 5
    s_mul_i32 s58, s36, 256
    s_mul_i32 s59, s36, 442368
    v_add_u32 v224, 0, v2
    v_add_u32 v225, 18432, v2
    v_add_u32 v226, 40960, v2
    v_add_u32 v227, 59392, v2
    v_add_u32 v228, 81920, v2
    v_add_u32 v229, 100352, v2
    v_add_u32 v230, 122880, v2
    v_add_u32 v231, 141312, v2
    v_add_u32 v232, 0, v3
    v_add_u32 v233, 12800, v3
    v_add_u32 v234, 55296, v3
    v_add_u32 v235, 68096, v3
    s_lshl_b32 s37, s36, 7
    s_add_u32 s38, s38, s37
    s_mul_i32 s37, s36, 221184
    s_add_u32 s39, s39, s37
    s_lshl_b32 s40, s35, 10
    s_lshl_b32 s41, s35, 11
    v_mov_b32 v6, 0
    s_waitcnt lgkmcnt(0)
    s_mov_b32 s4, s60
    s_mov_b32 s5, s61
    s_mov_b32 s6, 0x280000
    s_mov_b32 s7, 0x20000
    s_mov_b32 s8, s76
    s_mov_b32 s9, s77
    s_mov_b32 s10, 0x21c000
    s_mov_b32 s11, 0x20000
    s_mov_b32 s12, s78
    s_mov_b32 s13, s79
    s_mov_b32 s14, 0x21c000
    s_mov_b32 s15, 0x20000
    s_mov_b32 s16, s84
    s_mov_b32 s17, s85
    s_mov_b32 s18, 0x100
    s_mov_b32 s19, 0x20000
    s_add_u32 m0, s40, 81920
    s_nop 0
    buffer_load_dwordx4 v224, s[4:7], s38 offen offset:0  lds
    buffer_load_dwordx4 v225, s[4:7], s38 offen offset:2048  lds
    s_add_u32 m0, s40, 86016
    s_nop 0
    buffer_load_dwordx4 v226, s[4:7], s38 offen offset:0  lds
    buffer_load_dwordx4 v227, s[4:7], s38 offen offset:2048  lds
    s_add_u32 m0, s40, 90112
    s_nop 0
    buffer_load_dwordx4 v228, s[4:7], s38 offen offset:0  lds
    buffer_load_dwordx4 v229, s[4:7], s38 offen offset:2048  lds
    s_add_u32 m0, s40, 94208
    s_nop 0
    buffer_load_dwordx4 v230, s[4:7], s38 offen offset:0  lds
    buffer_load_dwordx4 v231, s[4:7], s38 offen offset:2048  lds
    s_add_u32 s38, s38, 128
    s_add_u32 m0, s41, 32768
    s_nop 0
    buffer_load_dwordx4 v232, s[8:11], s39 offen offset:0  lds
    buffer_load_dwordx4 v233, s[8:11], s39 offen offset:1024  lds
    s_add_u32 m0, s41, 40960
    s_nop 0
    buffer_load_dwordx4 v232, s[12:15], s39 offen offset:0  lds
    buffer_load_dwordx4 v233, s[12:15], s39 offen offset:1024  lds
    s_add_u32 m0, s41, 36864
    s_nop 0
    buffer_load_dwordx4 v234, s[8:11], s39 offen offset:0  lds
    buffer_load_dwordx4 v235, s[8:11], s39 offen offset:1024  lds
    s_add_u32 m0, s41, 45056
    s_nop 0
    buffer_load_dwordx4 v234, s[12:15], s39 offen offset:0  lds
    buffer_load_dwordx4 v235, s[12:15], s39 offen offset:1024  lds
    s_add_u32 s39, s39, 110592
    s_add_u32 m0, s41, 49152
    s_nop 0
    buffer_load_dwordx4 v232, s[8:11], s39 offen offset:0  lds
    buffer_load_dwordx4 v233, s[8:11], s39 offen offset:1024  lds
    s_add_u32 m0, s41, 57344
    s_nop 0
    buffer_load_dwordx4 v232, s[12:15], s39 offen offset:0  lds
    buffer_load_dwordx4 v233, s[12:15], s39 offen offset:1024  lds
    s_add_u32 m0, s41, 53248
    s_nop 0
    buffer_load_dwordx4 v234, s[8:11], s39 offen offset:0  lds
    buffer_load_dwordx4 v235, s[8:11], s39 offen offset:1024  lds
    s_add_u32 m0, s41, 61440
    s_nop 0
    buffer_load_dwordx4 v234, s[12:15], s39 offen offset:0  lds
    buffer_load_dwordx4 v235, s[12:15], s39 offen offset:1024  lds
    s_add_u32 s39, s39, 110592
    s_add_u32 m0, s40, 98304
    s_nop 0
    buffer_load_dwordx4 v224, s[4:7], s38 offen offset:0  lds
    buffer_load_dwordx4 v225, s[4:7], s38 offen offset:2048  lds
    s_add_u32 m0, s40, 102400
    s_nop 0
    buffer_load_dwordx4 v226, s[4:7], s38 offen offset:0  lds
    buffer_load_dwordx4 v227, s[4:7], s38 offen offset:2048  lds
    s_add_u32 m0, s40, 106496
    s_nop 0
    buffer_load_dwordx4 v228, s[4:7], s38 offen offset:0  lds
    buffer_load_dwordx4 v229, s[4:7], s38 offen offset:2048  lds
    s_add_u32 m0, s40, 110592
    s_nop 0
    buffer_load_dwordx4 v230, s[4:7], s38 offen offset:0  lds
    buffer_load_dwordx4 v231, s[4:7], s38 offen offset:2048  lds
    s_add_u32 s38, s38, 128
    s_add_u32 s24, s86, 0x1800000
    s_addc_u32 s25, s87, 0
    s_mov_b32 s26, 0x4b000
    s_mov_b32 s27, 0x20000
    s_add_u32 s28, s86, 0x1700000
    s_addc_u32 s29, s87, 0
    s_mov_b32 s30, 0x4000
    s_mov_b32 s31, 0x20000
    v_cmp_le_u32 vcc, 5, v1
    s_nop 1
    v_cndmask_b32 v7, 0, 3, vcc
    v_add_u32 v7, v7, v1
    s_lshl_b32 s33, s45, 4
    s_add_u32 s33, s33, 288
    v_add_u32 v7, s33, v7
    v_and_b32 v14, 1, v1
    s_lshl_b32 s33, s44, 1
    s_add_u32 s33, s33, 0
    v_add_u32 v14, s33, v14
    v_cmp_gt_u32 vcc, 16, v1
    s_nop 1
    v_cndmask_b32 v7, v14, v7, vcc
    v_lshlrev_b32 v7, 7, v7
    s_mov_b32 s56, 0x303ff
    s_mov_b32 s57, 0
    s_add_u32 s53, s35, 2
    s_mul_i32 s34, s48, 276480
    s_add_u32 s34, s34, 0x900000
    s_add_u32 s20, s86, s34
    s_addc_u32 s21, s87, 0
    s_mov_b32 s22, 276480
    s_mov_b32 s23, 0x20000
    v_lshlrev_b32 v12, 4, v1
    v_add_u32 v13, 4096, v12
    s_and_b32 s33, s47, 3
    s_lshl_b32 s33, s33, 1
    s_add_u32 s33, s33, s48
    s_and_b32 s33, s33, 7
    s_mul_i32 s33, s33, 7
    s_add_u32 s33, s33, s53
    s_add_u32 s34, s33, 20
    s_cmp_ge_u32 s34, 54
    s_cselect_b32 s32, 54, 0
    s_sub_u32 s34, s34, s32
    s_mul_i32 s0, s34, 5120
    s_add_u32 s34, s33, 24
    s_cmp_ge_u32 s34, 54
    s_cselect_b32 s32, 54, 0
    s_sub_u32 s34, s34, s32
    s_mul_i32 s1, s34, 5120
    s_add_u32 s34, s33, 28
    s_cmp_ge_u32 s34, 54
    s_cselect_b32 s32, 54, 0
    s_sub_u32 s34, s34, s32
    s_mul_i32 s36, s34, 5120
    s_add_u32 s34, s33, 32
    s_cmp_ge_u32 s34, 54
    s_cselect_b32 s32, 54, 0
    s_sub_u32 s34, s34, s32
    s_mul_i32 s37, s34, 5120
    s_add_u32 s64, s33, 36
    s_mul_i32 s65, s53, 5120
    s_mul_i32 s42, s53, 20480
    s_cmp_ge_u32 s53, 2
    s_cselect_b32 s32, 8192, 0
    s_add_u32 s42, s42, s32
    s_and_b32 s62, s47, 3
    s_lshl_b32 s62, s62, 1
    s_add_u32 s62, s62, s48
    s_and_b32 s62, s62, 7
    s_mul_i32 s62, s62, 7
    s_add_u32 s62, s62, s35
    s_add_u32 s62, s62, 44
    s_cmp_ge_u32 s62, 54
    s_cselect_b32 s63, 54, 0
    s_sub_u32 s62, s62, s63
    s_mul_i32 s62, s62, 5120
    s_lshl_b32 s66, s44, 10
    s_lshl_b32 s49, s45, 10
    v_mov_b32 v10, 0
    v_mov_b32 v11, 0
    v_mov_b32 v14, 48128
    v_lshlrev_b32 v12, 4, v1
    v_add_u32 v15, 46080, v12
    s_waitcnt vmcnt(16)
    s_barrier
    s_add_u32 m0, s41, 65536
    s_nop 0
    buffer_load_dwordx4 v232, s[8:11], s39 offen offset:0  lds
    buffer_load_dwordx4 v233, s[8:11], s39 offen offset:1024  lds
    s_add_u32 m0, s41, 73728
    s_nop 0
    buffer_load_dwordx4 v232, s[12:15], s39 offen offset:0  lds
    buffer_load_dwordx4 v233, s[12:15], s39 offen offset:1024  lds
    s_add_u32 m0, s41, 69632
    s_nop 0
    buffer_load_dwordx4 v234, s[8:11], s39 offen offset:0  lds
    buffer_load_dwordx4 v235, s[8:11], s39 offen offset:1024  lds
    s_add_u32 m0, s41, 77824
    s_nop 0
    buffer_load_dwordx4 v234, s[12:15], s39 offen offset:0  lds
    buffer_load_dwordx4 v235, s[12:15], s39 offen offset:1024  lds
    s_add_u32 s39, s39, 110592
    s_add_u32 m0, s41, 114688
    s_nop 0
    buffer_load_dwordx4 v232, s[8:11], s39 offen offset:0  lds
    buffer_load_dwordx4 v233, s[8:11], s39 offen offset:1024  lds
    s_add_u32 m0, s41, 122880
    s_nop 0
    buffer_load_dwordx4 v232, s[12:15], s39 offen offset:0  lds
    buffer_load_dwordx4 v233, s[12:15], s39 offen offset:1024  lds
    s_add_u32 m0, s41, 118784
    s_nop 0
    buffer_load_dwordx4 v234, s[8:11], s39 offen offset:0  lds
    buffer_load_dwordx4 v235, s[8:11], s39 offen offset:1024  lds
    s_add_u32 m0, s41, 126976
    s_nop 0
    buffer_load_dwordx4 v234, s[12:15], s39 offen offset:0  lds
    buffer_load_dwordx4 v235, s[12:15], s39 offen offset:1024  lds
    s_add_u32 s39, s39, 110592
    s_waitcnt vmcnt(24)
    s_barrier
    s_add_u32 m0, s40, 0
    s_nop 0
    buffer_load_dwordx4 v224, s[4:7], s38 offen offset:0  lds
    buffer_load_dwordx4 v225, s[4:7], s38 offen offset:2048  lds
    s_add_u32 m0, s40, 4096
    s_nop 0
    buffer_load_dwordx4 v226, s[4:7], s38 offen offset:0  lds
    buffer_load_dwordx4 v227, s[4:7], s38 offen offset:2048  lds
    s_add_u32 m0, s40, 8192
    s_nop 0
    buffer_load_dwordx4 v228, s[4:7], s38 offen offset:0  lds
    buffer_load_dwordx4 v229, s[4:7], s38 offen offset:2048  lds
    s_add_u32 m0, s40, 12288
    s_nop 0
    buffer_load_dwordx4 v230, s[4:7], s38 offen offset:0  lds
    buffer_load_dwordx4 v231, s[4:7], s38 offen offset:2048  lds
    s_add_u32 s38, s38, 128
    s_add_u32 m0, s41, 131072
    s_nop 0
    buffer_load_dwordx4 v232, s[8:11], s39 offen offset:0  lds
    buffer_load_dwordx4 v233, s[8:11], s39 offen offset:1024  lds
    s_add_u32 m0, s41, 139264
    s_nop 0
    buffer_load_dwordx4 v232, s[12:15], s39 offen offset:0  lds
    buffer_load_dwordx4 v233, s[12:15], s39 offen offset:1024  lds
    s_add_u32 m0, s41, 135168
    s_nop 0
    buffer_load_dwordx4 v234, s[8:11], s39 offen offset:0  lds
    buffer_load_dwordx4 v235, s[8:11], s39 offen offset:1024  lds
    s_add_u32 m0, s41, 143360
    s_nop 0
    buffer_load_dwordx4 v234, s[12:15], s39 offen offset:0  lds
    buffer_load_dwordx4 v235, s[12:15], s39 offen offset:1024  lds
    s_add_u32 s39, s39, 110592
    s_add_u32 m0, s41, 32768
    s_nop 0
    buffer_load_dwordx4 v232, s[8:11], s39 offen offset:0  lds
    buffer_load_dwordx4 v233, s[8:11], s39 offen offset:1024  lds
    s_add_u32 m0, s41, 40960
    s_nop 0
    buffer_load_dwordx4 v232, s[12:15], s39 offen offset:0  lds
    buffer_load_dwordx4 v233, s[12:15], s39 offen offset:1024  lds
    s_add_u32 m0, s41, 36864
    s_nop 0
    buffer_load_dwordx4 v234, s[8:11], s39 offen offset:0  lds
    buffer_load_dwordx4 v235, s[8:11], s39 offen offset:1024  lds
    s_add_u32 m0, s41, 45056
    s_nop 0
    buffer_load_dwordx4 v234, s[12:15], s39 offen offset:0  lds
    buffer_load_dwordx4 v235, s[12:15], s39 offen offset:1024  lds
    s_add_u32 s39, s39, 110592
    s_waitcnt vmcnt(32)
    s_barrier
    s_add_u32 m0, s40, 16384
    s_nop 0
    buffer_load_dwordx4 v224, s[4:7], s38 offen offset:0  lds
    buffer_load_dwordx4 v225, s[4:7], s38 offen offset:2048  lds
    s_add_u32 m0, s40, 20480
    s_nop 0
    buffer_load_dwordx4 v226, s[4:7], s38 offen offset:0  lds
    buffer_load_dwordx4 v227, s[4:7], s38 offen offset:2048  lds
    s_add_u32 m0, s40, 24576
    s_nop 0
    buffer_load_dwordx4 v228, s[4:7], s38 offen offset:0  lds
    buffer_load_dwordx4 v229, s[4:7], s38 offen offset:2048  lds
    s_add_u32 m0, s40, 28672
    s_nop 0
    buffer_load_dwordx4 v230, s[4:7], s38 offen offset:0  lds
    buffer_load_dwordx4 v231, s[4:7], s38 offen offset:2048  lds
    s_add_u32 s38, s38, 128
    s_add_u32 m0, s41, 49152
    s_nop 0
    buffer_load_dwordx4 v232, s[8:11], s39 offen offset:0  lds
    buffer_load_dwordx4 v233, s[8:11], s39 offen offset:1024  lds
    s_add_u32 m0, s41, 57344
    s_nop 0
    buffer_load_dwordx4 v232, s[12:15], s39 offen offset:0  lds
    buffer_load_dwordx4 v233, s[12:15], s39 offen offset:1024  lds
    s_add_u32 m0, s41, 53248
    s_nop 0
    buffer_load_dwordx4 v234, s[8:11], s39 offen offset:0  lds
    buffer_load_dwordx4 v235, s[8:11], s39 offen offset:1024  lds
    s_add_u32 m0, s41, 61440
    s_nop 0
    buffer_load_dwordx4 v234, s[12:15], s39 offen offset:0  lds
    buffer_load_dwordx4 v235, s[12:15], s39 offen offset:1024  lds
    s_add_u32 s39, s39, 110592
    s_add_u32 m0, s40, 81920
    s_nop 0
    buffer_load_dwordx4 v224, s[4:7], s38 offen offset:0  lds
    buffer_load_dwordx4 v225, s[4:7], s38 offen offset:2048  lds
    s_add_u32 m0, s40, 86016
    s_nop 0
    buffer_load_dwordx4 v226, s[4:7], s38 offen offset:0  lds
    buffer_load_dwordx4 v227, s[4:7], s38 offen offset:2048  lds
    s_waitcnt vmcnt(44)
    s_barrier
    s_add_u32 m0, s41, 65536
    s_nop 0
    buffer_load_dwordx4 v232, s[8:11], s39 offen offset:0  lds
    buffer_load_dwordx4 v233, s[8:11], s39 offen offset:1024  lds
    s_add_u32 m0, s41, 73728
    s_nop 0
    buffer_load_dwordx4 v232, s[12:15], s39 offen offset:0  lds
    buffer_load_dwordx4 v233, s[12:15], s39 offen offset:1024  lds
    s_add_u32 m0, s41, 69632
    s_nop 0
    buffer_load_dwordx4 v234, s[8:11], s39 offen offset:0  lds
    buffer_load_dwordx4 v235, s[8:11], s39 offen offset:1024  lds
    s_add_u32 m0, s41, 77824
    s_nop 0
    buffer_load_dwordx4 v234, s[12:15], s39 offen offset:0  lds
    buffer_load_dwordx4 v235, s[12:15], s39 offen offset:1024  lds
    s_add_u32 s39, s39, 110592
    s_add_u32 m0, s40, 90112
    s_nop 0
    buffer_load_dwordx4 v228, s[4:7], s38 offen offset:0  lds
    buffer_load_dwordx4 v229, s[4:7], s38 offen offset:2048  lds
    s_add_u32 m0, s40, 94208
    s_nop 0
    buffer_load_dwordx4 v230, s[4:7], s38 offen offset:0  lds
    buffer_load_dwordx4 v231, s[4:7], s38 offen offset:2048  lds
    s_add_u32 s38, s38, 128
    s_sub_u32 s38, s38, s58
    s_waitcnt vmcnt(40)
    s_barrier
    s_add_u32 m0, s41, 114688
    s_nop 0
    buffer_load_dwordx4 v232, s[8:11], s39 offen offset:0  lds
    buffer_load_dwordx4 v233, s[8:11], s39 offen offset:1024  lds
    s_add_u32 m0, s41, 122880
    s_nop 0
    buffer_load_dwordx4 v232, s[12:15], s39 offen offset:0  lds
    buffer_load_dwordx4 v233, s[12:15], s39 offen offset:1024  lds
    s_add_u32 m0, s41, 118784
    s_nop 0
    buffer_load_dwordx4 v234, s[8:11], s39 offen offset:0  lds
    buffer_load_dwordx4 v235, s[8:11], s39 offen offset:1024  lds
    s_add_u32 m0, s41, 126976
    s_nop 0
    buffer_load_dwordx4 v234, s[12:15], s39 offen offset:0  lds
    buffer_load_dwordx4 v235, s[12:15], s39 offen offset:1024  lds
    s_add_u32 s39, s39, 110592
    s_add_u32 m0, s40, 98304
    s_nop 0
    buffer_load_dwordx4 v224, s[4:7], s38 offen offset:0  lds
    buffer_load_dwordx4 v225, s[4:7], s38 offen offset:2048  lds
    s_add_u32 m0, s40, 102400
    s_nop 0
    buffer_load_dwordx4 v226, s[4:7], s38 offen offset:0  lds
    buffer_load_dwordx4 v227, s[4:7], s38 offen offset:2048  lds
    s_waitcnt vmcnt(44)
    s_barrier
    s_add_u32 m0, s41, 131072
    s_nop 0
    buffer_load_dwordx4 v232, s[8:11], s39 offen offset:0  lds
    buffer_load_dwordx4 v233, s[8:11], s39 offen offset:1024  lds
    s_add_u32 m0, s41, 139264
    s_nop 0
    buffer_load_dwordx4 v232, s[12:15], s39 offen offset:0  lds
    buffer_load_dwordx4 v233, s[12:15], s39 offen offset:1024  lds
    s_add_u32 m0, s41, 135168
    s_nop 0
    buffer_load_dwordx4 v234, s[8:11], s39 offen offset:0  lds
    buffer_load_dwordx4 v235, s[8:11], s39 offen offset:1024  lds
    s_add_u32 m0, s41, 143360
    s_nop 0
    buffer_load_dwordx4 v234, s[12:15], s39 offen offset:0  lds
    buffer_load_dwordx4 v235, s[12:15], s39 offen offset:1024  lds
    s_add_u32 s39, s39, 110592
    s_sub_u32 s39, s39, s59
    s_add_u32 m0, s40, 106496
    s_nop 0
    buffer_load_dwordx4 v228, s[4:7], s38 offen offset:0  lds
    buffer_load_dwordx4 v229, s[4:7], s38 offen offset:2048  lds
    s_add_u32 m0, s40, 110592
    s_nop 0
    buffer_load_dwordx4 v230, s[4:7], s38 offen offset:0  lds
    buffer_load_dwordx4 v231, s[4:7], s38 offen offset:2048  lds
    s_add_u32 s38, s38, 128
    s_waitcnt vmcnt(40)
    s_barrier
    s_add_u32 m0, s41, 32768
    s_nop 0
    buffer_load_dwordx4 v232, s[8:11], s39 offen offset:0  lds
    buffer_load_dwordx4 v233, s[8:11], s39 offen offset:1024  lds
    s_add_u32 m0, s41, 40960
    s_nop 0
    buffer_load_dwordx4 v232, s[12:15], s39 offen offset:0  lds
    buffer_load_dwordx4 v233, s[12:15], s39 offen offset:1024  lds
    s_add_u32 m0, s41, 36864
    s_nop 0
    buffer_load_dwordx4 v234, s[8:11], s39 offen offset:0  lds
    buffer_load_dwordx4 v235, s[8:11], s39 offen offset:1024  lds
    s_add_u32 m0, s41, 45056
    s_nop 0
    buffer_load_dwordx4 v234, s[12:15], s39 offen offset:0  lds
    buffer_load_dwordx4 v235, s[12:15], s39 offen offset:1024  lds
    s_add_u32 s39, s39, 110592
    s_add_u32 m0, s40, 0
    s_nop 0
    buffer_load_dwordx4 v224, s[4:7], s38 offen offset:0  lds
    buffer_load_dwordx4 v225, s[4:7], s38 offen offset:2048  lds
    s_add_u32 m0, s40, 4096
    s_nop 0
    buffer_load_dwordx4 v226, s[4:7], s38 offen offset:0  lds
    buffer_load_dwordx4 v227, s[4:7], s38 offen offset:2048  lds
    s_waitcnt vmcnt(40)
    s_barrier
    s_add_u32 m0, s41, 49152
    s_nop 0
    buffer_load_dwordx4 v232, s[8:11], s39 offen offset:0  lds
    buffer_load_dwordx4 v233, s[8:11], s39 offen offset:1024  lds
    s_add_u32 m0, s41, 57344
    s_nop 0
    buffer_load_dwordx4 v232, s[12:15], s39 offen offset:0  lds
    buffer_load_dwordx4 v233, s[12:15], s39 offen offset:1024  lds
    s_add_u32 m0, s41, 53248
    s_nop 0
    buffer_load_dwordx4 v234, s[8:11], s39 offen offset:0  lds
    buffer_load_dwordx4 v235, s[8:11], s39 offen offset:1024  lds
    s_add_u32 m0, s41, 61440
    s_nop 0
    buffer_load_dwordx4 v234, s[12:15], s39 offen offset:0  lds
    buffer_load_dwordx4 v235, s[12:15], s39 offen offset:1024  lds
    s_add_u32 s39, s39, 110592
    s_add_u32 m0, s40, 8192
    s_nop 0
    buffer_load_dwordx4 v228, s[4:7], s38 offen offset:0  lds
    buffer_load_dwordx4 v229, s[4:7], s38 offen offset:2048  lds
    s_add_u32 m0, s40, 12288
    s_nop 0
    buffer_load_dwordx4 v230, s[4:7], s38 offen offset:0  lds
    buffer_load_dwordx4 v231, s[4:7], s38 offen offset:2048  lds
    s_add_u32 s38, s38, 128
    s_waitcnt vmcnt(40)
    s_barrier
    buffer_load_dwordx2 v[8:9], v6, s[16:19], 0 offen sc1
    s_add_u32 m0, s41, 65536
    s_nop 0
    buffer_load_dwordx4 v232, s[8:11], s39 offen offset:0  lds
    buffer_load_dwordx4 v233, s[8:11], s39 offen offset:1024  lds
    s_add_u32 m0, s41, 73728
    s_nop 0
    buffer_load_dwordx4 v232, s[12:15], s39 offen offset:0  lds
    buffer_load_dwordx4 v233, s[12:15], s39 offen offset:1024  lds
    s_add_u32 m0, s41, 69632
    s_nop 0
    buffer_load_dwordx4 v234, s[8:11], s39 offen offset:0  lds
    buffer_load_dwordx4 v235, s[8:11], s39 offen offset:1024  lds
    s_add_u32 m0, s41, 77824
    s_nop 0
    buffer_load_dwordx4 v234, s[12:15], s39 offen offset:0  lds
    buffer_load_dwordx4 v235, s[12:15], s39 offen offset:1024  lds
    s_add_u32 s39, s39, 110592
    s_add_u32 m0, s40, 16384
    s_nop 0
    buffer_load_dwordx4 v224, s[4:7], s38 offen offset:0  lds
    buffer_load_dwordx4 v225, s[4:7], s38 offen offset:2048  lds
    s_add_u32 m0, s40, 20480
    s_nop 0
    buffer_load_dwordx4 v226, s[4:7], s38 offen offset:0  lds
    buffer_load_dwordx4 v227, s[4:7], s38 offen offset:2048  lds
    s_waitcnt vmcnt(41)
    s_barrier
    s_add_u32 m0, s41, 114688
    s_nop 0
    buffer_load_dwordx4 v232, s[8:11], s39 offen offset:0  lds
    buffer_load_dwordx4 v233, s[8:11], s39 offen offset:1024  lds
    s_add_u32 m0, s41, 122880
    s_nop 0
    buffer_load_dwordx4 v232, s[12:15], s39 offen offset:0  lds
    buffer_load_dwordx4 v233, s[12:15], s39 offen offset:1024  lds
    s_add_u32 m0, s41, 118784
    s_nop 0
    buffer_load_dwordx4 v234, s[8:11], s39 offen offset:0  lds
    buffer_load_dwordx4 v235, s[8:11], s39 offen offset:1024  lds
    s_add_u32 m0, s41, 126976
    s_nop 0
    buffer_load_dwordx4 v234, s[12:15], s39 offen offset:0  lds
    buffer_load_dwordx4 v235, s[12:15], s39 offen offset:1024  lds
    s_add_u32 s39, s39, 110592
    s_add_u32 m0, s40, 24576
    s_nop 0
    buffer_load_dwordx4 v228, s[4:7], s38 offen offset:0  lds
    buffer_load_dwordx4 v229, s[4:7], s38 offen offset:2048  lds
    s_add_u32 m0, s40, 28672
    s_nop 0
    buffer_load_dwordx4 v230, s[4:7], s38 offen offset:0  lds
    buffer_load_dwordx4 v231, s[4:7], s38 offen offset:2048  lds
    s_add_u32 s38, s38, 128
    s_waitcnt vmcnt(41)
    s_barrier
    s_add_u32 m0, s41, 131072
    s_nop 0
    buffer_load_dwordx4 v232, s[8:11], s39 offen offset:0  lds
    buffer_load_dwordx4 v233, s[8:11], s39 offen offset:1024  lds
    s_add_u32 m0, s41, 139264
    s_nop 0
    buffer_load_dwordx4 v232, s[12:15], s39 offen offset:0  lds
    buffer_load_dwordx4 v233, s[12:15], s39 offen offset:1024  lds
    s_add_u32 m0, s41, 135168
    s_nop 0
    buffer_load_dwordx4 v234, s[8:11], s39 offen offset:0  lds
    buffer_load_dwordx4 v235, s[8:11], s39 offen offset:1024  lds
    s_add_u32 m0, s41, 143360
    s_nop 0
    buffer_load_dwordx4 v234, s[12:15], s39 offen offset:0  lds
    buffer_load_dwordx4 v235, s[12:15], s39 offen offset:1024  lds
    s_add_u32 s39, s39, 110592
    s_add_u32 m0, s40, 81920
    s_nop 0
    buffer_load_dwordx4 v224, s[4:7], s38 offen offset:0  lds
    buffer_load_dwordx4 v225, s[4:7], s38 offen offset:2048  lds
    s_add_u32 m0, s40, 86016
    s_nop 0
    buffer_load_dwordx4 v226, s[4:7], s38 offen offset:0  lds
    buffer_load_dwordx4 v227, s[4:7], s38 offen offset:2048  lds
    s_waitcnt vmcnt(41)
    s_barrier
    s_add_u32 m0, s41, 32768
    s_nop 0
    buffer_load_dwordx4 v232, s[8:11], s39 offen offset:0  lds
    buffer_load_dwordx4 v233, s[8:11], s39 offen offset:1024  lds
    s_add_u32 m0, s41, 40960
    s_nop 0
    buffer_load_dwordx4 v232, s[12:15], s39 offen offset:0  lds
    buffer_load_dwordx4 v233, s[12:15], s39 offen offset:1024  lds
    s_add_u32 m0, s41, 36864
    s_nop 0
    buffer_load_dwordx4 v234, s[8:11], s39 offen offset:0  lds
    buffer_load_dwordx4 v235, s[8:11], s39 offen offset:1024  lds
    s_add_u32 m0, s41, 45056
    s_nop 0
    buffer_load_dwordx4 v234, s[12:15], s39 offen offset:0  lds
    buffer_load_dwordx4 v235, s[12:15], s39 offen offset:1024  lds
    s_add_u32 s39, s39, 110592
    s_add_u32 m0, s40, 90112
    s_nop 0
    buffer_load_dwordx4 v228, s[4:7], s38 offen offset:0  lds
    buffer_load_dwordx4 v229, s[4:7], s38 offen offset:2048  lds
    s_add_u32 m0, s40, 94208
    s_nop 0
    buffer_load_dwordx4 v230, s[4:7], s38 offen offset:0  lds
    buffer_load_dwordx4 v231, s[4:7], s38 offen offset:2048  lds
    s_add_u32 s38, s38, 128
    s_waitcnt vmcnt(40)
    s_barrier
    s_add_u32 m0, s41, 49152
    s_nop 0
    buffer_load_dwordx4 v232, s[8:11], s39 offen offset:0  lds
    buffer_load_dwordx4 v233, s[8:11], s39 offen offset:1024  lds
    s_add_u32 m0, s41, 57344
    s_nop 0
    buffer_load_dwordx4 v232, s[12:15], s39 offen offset:0  lds
    buffer_load_dwordx4 v233, s[12:15], s39 offen offset:1024  lds
    s_add_u32 m0, s41, 53248
    s_nop 0
    buffer_load_dwordx4 v234, s[8:11], s39 offen offset:0  lds
    buffer_load_dwordx4 v235, s[8:11], s39 offen offset:1024  lds
    s_add_u32 m0, s41, 61440
    s_nop 0
    buffer_load_dwordx4 v234, s[12:15], s39 offen offset:0  lds
    buffer_load_dwordx4 v235, s[12:15], s39 offen offset:1024  lds
    s_add_u32 s39, s39, 110592
    s_add_u32 m0, s40, 98304
    s_nop 0
    buffer_load_dwordx4 v224, s[4:7], s38 offen offset:0  lds
    buffer_load_dwordx4 v225, s[4:7], s38 offen offset:2048  lds
    s_add_u32 m0, s40, 102400
    s_nop 0
    buffer_load_dwordx4 v226, s[4:7], s38 offen offset:0  lds
    buffer_load_dwordx4 v227, s[4:7], s38 offen offset:2048  lds
    s_waitcnt vmcnt(40)
    s_barrier
    s_add_u32 m0, s41, 65536
    s_nop 0
    buffer_load_dwordx4 v232, s[8:11], s39 offen offset:0  lds
    buffer_load_dwordx4 v233, s[8:11], s39 offen offset:1024  lds
    s_add_u32 m0, s41, 73728
    s_nop 0
    buffer_load_dwordx4 v232, s[12:15], s39 offen offset:0  lds
    buffer_load_dwordx4 v233, s[12:15], s39 offen offset:1024  lds
    s_add_u32 m0, s41, 69632
    s_nop 0
    buffer_load_dwordx4 v234, s[8:11], s39 offen offset:0  lds
    buffer_load_dwordx4 v235, s[8:11], s39 offen offset:1024  lds
    s_add_u32 m0, s41, 77824
    s_nop 0
    buffer_load_dwordx4 v234, s[12:15], s39 offen offset:0  lds
    buffer_load_dwordx4 v235, s[12:15], s39 offen offset:1024  lds
    s_add_u32 s39, s39, 110592
    s_add_u32 m0, s40, 106496
    s_nop 0
    buffer_load_dwordx4 v228, s[4:7], s38 offen offset:0  lds
    buffer_load_dwordx4 v229, s[4:7], s38 offen offset:2048  lds
    s_add_u32 m0, s40, 110592
    s_nop 0
    buffer_load_dwordx4 v230, s[4:7], s38 offen offset:0  lds
    buffer_load_dwordx4 v231, s[4:7], s38 offen offset:2048  lds
    s_add_u32 s38, s38, 128
    s_mov_b32 s53, 0
    s_waitcnt vmcnt(52)
TG_1:
    v_readfirstlane_b32 s50, v8
    v_readfirstlane_b32 s51, v9
    s_cmp_lg_u32 s50, 0
    s_cbranch_scc1 TD_2
    s_add_u32 s53, s53, 1
    s_cmp_gt_u32 s53, 200000
    s_cbranch_scc1 TD_2
    s_sleep 2
    buffer_load_dwordx2 v[8:9], v6, s[16:19], 0 offen sc1
    s_waitcnt vmcnt(0)
    s_branch TG_1
TD_2:
    s_add_u32 s16, s86, 0x1710000
    s_addc_u32 s17, s87, 0
    s_mov_b32 s18, 0x23000
    s_mov_b32 s19, 0x20000
    s_waitcnt vmcnt(40)
    s_barrier
    s_add_u32 m0, s41, 114688
    s_nop 0
    buffer_load_dwordx4 v232, s[8:11], s39 offen offset:0  lds
    buffer_load_dwordx4 v233, s[8:11], s39 offen offset:1024  lds
    s_add_u32 m0, s41, 122880
    s_nop 0
    buffer_load_dwordx4 v232, s[12:15], s39 offen offset:0  lds
    buffer_load_dwordx4 v233, s[12:15], s39 offen offset:1024  lds
    s_add_u32 m0, s41, 118784
    s_nop 0
    buffer_load_dwordx4 v234, s[8:11], s39 offen offset:0  lds
    buffer_load_dwordx4 v235, s[8:11], s39 offen offset:1024  lds
    s_add_u32 m0, s41, 126976
    s_nop 0
    buffer_load_dwordx4 v234, s[12:15], s39 offen offset:0  lds
    buffer_load_dwordx4 v235, s[12:15], s39 offen offset:1024  lds
    s_add_u32 s39, s39, 110592
    s_cmp_eq_u32 s3, 5
    s_cbranch_scc1 LD5
    s_waitcnt vmcnt(36)
    s_barrier
    s_add_u32 m0, s41, 131072
    s_nop 0
    buffer_load_dwordx4 v232, s[8:11], s39 offen offset:0  lds
    buffer_load_dwordx4 v233, s[8:11], s39 offen offset:1024  lds
    s_add_u32 m0, s41, 139264
    s_nop 0
    buffer_load_dwordx4 v232, s[12:15], s39 offen offset:0  lds
    buffer_load_dwordx4 v233, s[12:15], s39 offen offset:1024  lds
    s_add_u32 m0, s41, 135168
    s_nop 0
    buffer_load_dwordx4 v234, s[8:11], s39 offen offset:0  lds
    buffer_load_dwordx4 v235, s[8:11], s39 offen offset:1024  lds
    s_add_u32 m0, s41, 143360
    s_nop 0
    buffer_load_dwordx4 v234, s[12:15], s39 offen offset:0  lds
    buffer_load_dwordx4 v235, s[12:15], s39 offen offset:1024  lds
    s_add_u32 s39, s39, 110592
    s_waitcnt vmcnt(32)
    s_barrier
    buffer_load_dwordx4 v[16:19], v12, s[20:23], s62 offen offset:0 sc1
    buffer_load_dwordx4 v[20:23], v12, s[20:23], s62 offen offset:1024 sc1
    buffer_load_dwordx4 v[24:27], v12, s[20:23], s62 offen offset:2048 sc1
    buffer_load_dwordx4 v[28:31], v12, s[20:23], s62 offen offset:3072 sc1
    buffer_load_dwordx4 v[32:35], v13, s[20:23], s62 offen sc1
    s_add_u32 s62, s62, 10240
    s_cmp_ge_u32 s62, 276480
    s_cselect_b32 s63, 276480, 0
    s_sub_u32 s62, s62, s63
    buffer_load_dwordx4 v[36:39], v12, s[20:23], s62 offen offset:0 sc1
    buffer_load_dwordx4 v[40:43], v12, s[20:23], s62 offen offset:1024 sc1
    buffer_load_dwordx4 v[44:47], v12, s[20:23], s62 offen offset:2048 sc1
    buffer_load_dwordx4 v[48:51], v12, s[20:23], s62 offen offset:3072 sc1
    buffer_load_dwordx4 v[52:55], v13, s[20:23], s62 offen sc1
    s_add_u32 s62, s62, 10240
    s_cmp_ge_u32 s62, 276480
    s_cselect_b32 s63, 276480, 0
    s_sub_u32 s62, s62, s63
    buffer_load_dwordx4 v[56:59], v12, s[20:23], s62 offen offset:0 sc1
    buffer_load_dwordx4 v[60:63], v12, s[20:23], s62 offen offset:1024 sc1
    buffer_load_dwordx4 v[64:67], v12, s[20:23], s62 offen offset:2048 sc1
    buffer_load_dwordx4 v[68:71], v12, s[20:23], s62 offen offset:3072 sc1
    buffer_load_dwordx4 v[72:75], v13, s[20:23], s62 offen sc1
    s_add_u32 s62, s62, 10240
    s_cmp_ge_u32 s62, 276480
    s_cselect_b32 s63, 276480, 0
    s_sub_u32 s62, s62, s63
    s_waitcnt vmcnt(35)
    s_barrier
    buffer_load_dwordx4 v[76:79], v12, s[20:23], s62 offen offset:0 sc1
    buffer_load_dwordx4 v[80:83], v12, s[20:23], s62 offen offset:1024 sc1
    buffer_load_dwordx4 v[84:87], v12, s[20:23], s62 offen offset:2048 sc1
    buffer_load_dwordx4 v[88:91], v12, s[20:23], s62 offen offset:3072 sc1
    buffer_load_dwordx4 v[92:95], v13, s[20:23], s62 offen sc1
    s_add_u32 s62, s62, 10240
    s_cmp_ge_u32 s62, 276480
    s_cselect_b32 s63, 276480, 0
    s_sub_u32 s62, s62, s63
    buffer_load_dwordx4 v[96:99], v12, s[20:23], s62 offen offset:0 sc1
    buffer_load_dwordx4 v[100:103], v12, s[20:23], s62 offen offset:1024 sc1
    buffer_load_dwordx4 v[104:107], v12, s[20:23], s62 offen offset:2048 sc1
    buffer_load_dwordx4 v[108:111], v12, s[20:23], s62 offen offset:3072 sc1
    buffer_load_dwordx4 v[112:115], v13, s[20:23], s62 offen sc1
    s_add_u32 s62, s62, 10240
    s_cmp_ge_u32 s62, 276480
    s_cselect_b32 s63, 276480, 0
    s_sub_u32 s62, s62, s63
    s_waitcnt vmcnt(33)
    s_barrier
    s_add_u32 m0, s42, 0
    s_nop 0
    buffer_load_dwordx4 v12, s[20:23], s0 offen offset:0 sc1 lds
    buffer_load_dwordx4 v12, s[20:23], s0 offen offset:1024 sc1 lds
    buffer_load_dwordx4 v12, s[20:23], s0 offen offset:2048 sc1 lds
    buffer_load_dwordx4 v12, s[20:23], s0 offen offset:3072 sc1 lds
    s_add_u32 m0, s42, 4096
    s_nop 0
    buffer_load_dwordx4 v13, s[20:23], s0 offen sc1 lds
    s_add_u32 m0, s42, 5120
    s_nop 0
    buffer_load_dwordx4 v12, s[20:23], s1 offen offset:0 sc1 lds
    buffer_load_dwordx4 v12, s[20:23], s1 offen offset:1024 sc1 lds
    s_waitcnt vmcnt(32)
    s_barrier
    s_add_u32 m0, s42, 5120
    s_nop 0
    buffer_load_dwordx4 v12, s[20:23], s1 offen offset:2048 sc1 lds
    buffer_load_dwordx4 v12, s[20:23], s1 offen offset:3072 sc1 lds
    s_add_u32 m0, s42, 9216
    s_nop 0
    buffer_load_dwordx4 v13, s[20:23], s1 offen sc1 lds
    s_add_u32 m0, s42, 10240
    s_nop 0
    buffer_load_dwordx4 v12, s[20:23], s36 offen offset:0 sc1 lds
    buffer_load_dwordx4 v12, s[20:23], s36 offen offset:1024 sc1 lds
    buffer_load_dwordx4 v12, s[20:23], s36 offen offset:2048 sc1 lds
    buffer_load_dwordx4 v12, s[20:23], s36 offen offset:3072 sc1 lds
    s_movk_i32 s32, 1280
    v_add_u32 v165, 0, v1
    v_mul_u32_u24 v166, 205, v165
    v_lshrrev_b32 v166, 11, v166
    v_mul_u32_u24 v160, 10, v166
    v_sub_u32 v165, v165, v160
    v_lshlrev_b32 v165, 4, v165
    v_mad_u32_u24 v160, v166, s32, v165
    v_add_u32 v165, 64, v1
    v_mul_u32_u24 v166, 205, v165
    v_lshrrev_b32 v166, 11, v166
    v_mul_u32_u24 v161, 10, v166
    v_sub_u32 v165, v165, v161
    v_lshlrev_b32 v165, 4, v165
    v_mad_u32_u24 v161, v166, s32, v165
    v_add_u32 v165, 128, v1
    v_mul_u32_u24 v166, 205, v165
    v_lshrrev_b32 v166, 11, v166
    v_mul_u32_u24 v162, 10, v166
    v_sub_u32 v165, v165, v162
    v_lshlrev_b32 v165, 4, v165
    v_mad_u32_u24 v162, v166, s32, v165
    v_add_u32 v165, 192, v1
    v_mul_u32_u24 v166, 205, v165
    v_lshrrev_b32 v166, 11, v166
    v_mul_u32_u24 v163, 10, v166
    v_sub_u32 v165, v165, v163
    v_lshlrev_b32 v165, 4, v165
    v_mad_u32_u24 v163, v166, s32, v165
    v_add_u32 v165, 256, v1
    v_mul_u32_u24 v166, 205, v165
    v_lshrrev_b32 v166, 11, v166
    v_mul_u32_u24 v164, 10, v166
    v_sub_u32 v165, v165, v164
    v_lshlrev_b32 v165, 4, v165
    v_mad_u32_u24 v164, v166, s32, v165
    s_barrier
    s_lshl_b32 s32, s47, 1
    s_mul_i32 s32, s32, 40960
    s_mul_i32 s33, s48, 160
    s_add_u32 s32, s32, s33
    s_mov_b32 m0, 90112
    s_nop 0
    buffer_load_dwordx4 v160, s[4:7], s32 offen lds
    s_mov_b32 m0, 91136
    s_nop 0
    buffer_load_dwordx4 v161, s[4:7], s32 offen lds
    s_mov_b32 m0, 92160
    s_nop 0
    buffer_load_dwordx4 v162, s[4:7], s32 offen lds
    s_mov_b32 m0, 93184
    s_nop 0
    buffer_load_dwordx4 v163, s[4:7], s32 offen lds
    s_mov_b32 m0, 94208
    s_nop 0
    buffer_load_dwordx4 v164, s[4:7], s32 offen lds
    s_add_u32 s32, s32, 40960
    s_mov_b32 m0, 95232
    s_nop 0
    buffer_load_dwordx4 v160, s[4:7], s32 offen lds
    s_mov_b32 m0, 96256
    s_nop 0
    buffer_load_dwordx4 v161, s[4:7], s32 offen lds
    s_mov_b32 m0, 97280
    s_nop 0
    buffer_load_dwordx4 v162, s[4:7], s32 offen lds
    s_mov_b32 m0, 98304
    s_nop 0
    buffer_load_dwordx4 v163, s[4:7], s32 offen lds
    s_mov_b32 m0, 99328
    s_nop 0
    buffer_load_dwordx4 v164, s[4:7], s32 offen lds
    v_mov_b32 v3, 48152
    s_add_u32 m0, s42, 14336
    s_nop 0
    buffer_load_dwordx4 v13, s[20:23], s36 offen sc1 lds
    s_add_u32 m0, s42, 15360
    s_nop 0
    buffer_load_dwordx4 v12, s[20:23], s37 offen offset:0 sc1 lds
    buffer_load_dwordx4 v12, s[20:23], s37 offen offset:1024 sc1 lds
    buffer_load_dwordx4 v12, s[20:23], s37 offen offset:2048 sc1 lds
    buffer_load_dwordx4 v12, s[20:23], s37 offen offset:3072 sc1 lds
    s_add_u32 m0, s42, 19456
    s_nop 0
    buffer_load_dwordx4 v13, s[20:23], s37 offen sc1 lds
    v_mov_b32 v14, 48136
    s_mov_b32 s53, 0
LS_3:
    ds_read_b32 v15, v14
    s_waitcnt lgkmcnt(0)
    v_readfirstlane_b32 s54, v15
    s_nop 0
    s_cmp_ge_u32 s54, 4
    s_cbranch_scc1 LD_4
    s_add_u32 s53, s53, 1
    s_cmp_gt_u32 s53, 3200000
    s_cbranch_scc1 LD_4
    s_sleep 1
    s_branch LS_3
LD_4:
    s_add_i32 s33, s64, -2
    s_cmp_ge_u32 s33, 54
    s_cselect_b32 s53, 54, 0
    s_sub_u32 s33, s33, s53
    s_mul_i32 s33, s33, 5120
    s_add_u32 m0, s65, 133120
    s_nop 0
    buffer_load_dwordx4 v12, s[20:23], s33 offen offset:0 sc1 lds
    buffer_load_dwordx4 v12, s[20:23], s33 offen offset:1024 sc1 lds
    buffer_load_dwordx4 v12, s[20:23], s33 offen offset:2048 sc1 lds
    buffer_load_dwordx4 v12, s[20:23], s33 offen offset:3072 sc1 lds
    s_add_u32 m0, s65, 137216
    s_nop 0
    buffer_load_dwordx4 v13, s[20:23], s33 offen sc1 lds
    v_mov_b32 v14, 48136
    s_mov_b32 s53, 0
LS_5:
    ds_read_b32 v15, v14
    s_waitcnt lgkmcnt(0)
    v_readfirstlane_b32 s54, v15
    s_nop 0
    s_cmp_ge_u32 s54, 8
    s_cbranch_scc1 LD_6
    s_add_u32 s53, s53, 1
    s_cmp_gt_u32 s53, 3200000
    s_cbranch_scc1 LD_6
    s_sleep 1
    s_branch LS_5
LD_6:
    s_setprio 0
    v_min_u32 v170, 53, v1
    s_lshr_b32 s33, s47, 1
    s_lshl_b32 s33, s33, 6
    v_add_u32 v170, s33, v170
    v_lshlrev_b32 v170, 7, v170
    v_add_u32 v170, 176128, v170
    s_mov_b64 s[56:57], 0
    s_mov_b32 s53, 0
    buffer_load_dwordx2 v[168:169], v170, s[24:27], 0 offen offset:0 sc1
    s_waitcnt vmcnt(1)
    v_mov_b32 v14, 48140
    v_mov_b32 v15, 1
    s_waitcnt lgkmcnt(0)
    s_mov_b64 exec, 1
    ds_add_u32 v14, v15
    s_mov_b64 exec, -1
    s_branch HP_7x
HP_7:
    buffer_load_dwordx2 v[168:169], v170, s[24:27], 0 offen offset:0 sc1
HP_7x:
    s_waitcnt vmcnt(0)
    v_cmp_eq_u64 vcc, s[50:51], v[168:169]
    s_add_u32 s53, s53, 1
    s_cmp_gt_u32 s53, 200000
    s_cselect_b64 s[54:55], -1, vcc
    s_or_b64 s[56:57], s[56:57], s[54:55]
    s_mov_b64 exec, 1
    v_mov_b32 v172, s56
    v_mov_b32 v173, s57
    ds_write_b64 v3, v[172:173]
    s_not_b64 exec, s[56:57]
    s_cbranch_scc0 HD_8
    s_sleep 1
    s_branch HP_7
HD_8:
    s_mov_b64 exec, -1
    s_branch G2H
LD5:
    s_setprio 3
    s_waitcnt vmcnt(36)
    s_barrier
    buffer_load_dwordx2 v[168:169], v7, s[24:27], 0 offen offset:0 sc1
    s_add_u32 m0, s41, 131072
    s_nop 0
    buffer_load_dwordx4 v232, s[8:11], s39 offen offset:0  lds
    buffer_load_dwordx4 v233, s[8:11], s39 offen offset:1024  lds
    s_add_u32 m0, s41, 139264
    s_nop 0
    buffer_load_dwordx4 v232, s[12:15], s39 offen offset:0  lds
    buffer_load_dwordx4 v233, s[12:15], s39 offen offset:1024  lds
    s_add_u32 m0, s41, 135168
    s_nop 0
    buffer_load_dwordx4 v234, s[8:11], s39 offen offset:0  lds
    buffer_load_dwordx4 v235, s[8:11], s39 offen offset:1024  lds
    s_add_u32 m0, s41, 143360
    s_nop 0
    buffer_load_dwordx4 v234, s[12:15], s39 offen offset:0  lds
    buffer_load_dwordx4 v235, s[12:15], s39 offen offset:1024  lds
    s_add_u32 s39, s39, 110592
    s_waitcnt vmcnt(33)
    s_barrier
    ds_write_b128 v14, v[8:11]
    ds_write_b64 v14, v[10:11] offset:16
    ds_write_b64 v14, v[10:11] offset:24
    ds_write_b64 v14, v[10:11] offset:32
    ds_write_b64 v14, v[10:11] offset:64
    s_waitcnt vmcnt(8)
    v_cmp_eq_u64 vcc, s[50:51], v[168:169]
    s_nop 0
    s_andn2_b64 s[54:55], s[56:57], vcc
    s_cbranch_scc1 L5_late
    buffer_load_dwordx4 v[176:179], v12, s[16:19], s49 offen sc1
    s_add_u32 s49, s49, 14336
    buffer_load_dwordx4 v[180:183], v12, s[16:19], s49 offen sc1
    s_add_u32 s49, s49, 14336
    buffer_load_dwordx4 v[184:187], v12, s[16:19], s49 offen sc1
    s_add_u32 s49, s49, 14336
    buffer_load_dwordx4 v[188:191], v12, s[16:19], s49 offen sc1
    s_add_u32 s49, s49, 14336
    buffer_load_dwordx4 v[192:195], v12, s[16:19], s49 offen sc1
    s_add_u32 s49, s49, 14336
    s_barrier
    s_branch L5_join
L5_late:
    buffer_load_dwordx2 v[168:169], v7, s[24:27], 0 offen offset:0 sc1
    s_barrier
    s_mov_b32 s53, 0
    s_waitcnt vmcnt(0)
PL_9:
    v_cmp_eq_u64 vcc, s[50:51], v[168:169]
    s_nop 0
    s_andn2_b64 s[54:55], s[56:57], vcc
    s_cbranch_scc0 PD_10
    s_add_u32 s53, s53, 1
    s_cmp_gt_u32 s53, 200000
    s_cbranch_scc1 PD_10
    s_sleep 2
    buffer_load_dwordx2 v[168:169], v7, s[24:27], 0 offen offset:0 sc1
    s_waitcnt vmcnt(0)
    s_branch PL_9
PD_10:
    buffer_load_dwordx4 v[176:179], v12, s[16:19], s49 offen sc1
    s_add_u32 s49, s49, 14336
    buffer_load_dwordx4 v[180:183], v12, s[16:19], s49 offen sc1
    s_add_u32 s49, s49, 14336
    buffer_load_dwordx4 v[184:187], v12, s[16:19], s49 offen sc1
    s_add_u32 s49, s49, 14336
    buffer_load_dwordx4 v[188:191], v12, s[16:19], s49 offen sc1
    s_add_u32 s49, s49, 14336
    buffer_load_dwordx4 v[192:195], v12, s[16:19], s49 offen sc1
    s_add_u32 s49, s49, 14336
L5_join:
    buffer_load_dwordx4 v[196:199], v12, s[16:19], s49 offen sc1
    s_add_u32 s49, s49, 14336
    buffer_load_dwordx4 v[200:203], v12, s[16:19], s49 offen sc1
    s_add_u32 s49, s49, 14336
    buffer_load_dwordx4 v[204:207], v12, s[16:19], s49 offen sc1
    s_add_u32 s49, s49, 14336
    buffer_load_dwordx4 v[208:211], v12, s[16:19], s49 offen sc1
    s_add_u32 s49, s49, 14336
    buffer_load_dwordx4 v[212:215], v12, s[16:19], s49 offen sc1
    s_mov_b32 m0, 45056
    s_nop 0
    buffer_load_dwordx4 v12, s[28:31], s66 offen sc1 lds
    s_barrier
    s_add_u32 m0, s42, 0
    s_nop 0
    buffer_load_dwordx4 v12, s[20:23], s0 offen offset:0 sc1 lds
    buffer_load_dwordx4 v12, s[20:23], s0 offen offset:1024 sc1 lds
    buffer_load_dwordx4 v12, s[20:23], s0 offen offset:2048 sc1 lds
    buffer_load_dwordx4 v12, s[20:23], s0 offen offset:3072 sc1 lds
    s_add_u32 m0, s42, 4096
    s_nop 0
    buffer_load_dwordx4 v13, s[20:23], s0 offen sc1 lds
    s_add_u32 m0, s42, 5120
    s_nop 0
    buffer_load_dwordx4 v12, s[20:23], s1 offen offset:0 sc1 lds
    s_waitcnt vmcnt(12)
    v_add_f32 v176, v176, v180
    v_add_f32 v177, v177, v181
    v_add_f32 v178, v178, v182
    v_add_f32 v179, v179, v183
    v_add_f32 v184, v184, v188
    v_add_f32 v185, v185, v189
    v_add_f32 v186, v186, v190
    v_add_f32 v187, v187, v191
    v_add_f32 v176, v176, v192
    v_add_f32 v177, v177, v193
    v_add_f32 v178, v178, v194
    v_add_f32 v179, v179, v195
    v_add_f32 v176, v176, v184
    v_add_f32 v177, v177, v185
    v_add_f32 v178, v178, v186
    v_add_f32 v179, v179, v187
    s_barrier
    s_waitcnt vmcnt(6)
    v_add_f32 v196, v196, v200
    v_add_f32 v197, v197, v201
    v_add_f32 v198, v198, v202
    v_add_f32 v199, v199, v203
    v_add_f32 v204, v204, v208
    v_add_f32 v205, v205, v209
    v_add_f32 v206, v206, v210
    v_add_f32 v207, v207, v211
    v_add_f32 v176, v176, v212
    v_add_f32 v177, v177, v213
    v_add_f32 v178, v178, v214
    v_add_f32 v179, v179, v215
    v_add_f32 v196, v196, v204
    v_add_f32 v197, v197, v205
    v_add_f32 v198, v198, v206
    v_add_f32 v199, v199, v207
    v_add_f32 v176, v176, v196
    v_add_f32 v177, v177, v197
    v_add_f32 v178, v178, v198
    v_add_f32 v179, v179, v199
    ds_write_b128 v15, v[176:179]
    s_waitcnt lgkmcnt(0)
    s_barrier
    s_setprio 0
    v_mov_b32 v14, 48136
    s_mov_b32 s53, 0
LS_11:
    ds_read_b32 v15, v14
    s_waitcnt lgkmcnt(0)
    v_readfirstlane_b32 s54, v15
    s_nop 0
    s_cmp_ge_u32 s54, 4
    s_cbranch_scc1 LD_12
    s_add_u32 s53, s53, 1
    s_cmp_gt_u32 s53, 3200000
    s_cbranch_scc1 LD_12
    s_sleep 1
    s_branch LS_11
LD_12:
    s_add_u32 m0, s42, 5120
    s_nop 0
    buffer_load_dwordx4 v12, s[20:23], s1 offen offset:1024 sc1 lds
    buffer_load_dwordx4 v12, s[20:23], s1 offen offset:2048 sc1 lds
    buffer_load_dwordx4 v12, s[20:23], s1 offen offset:3072 sc1 lds
    s_add_u32 m0, s42, 9216
    s_nop 0
    buffer_load_dwordx4 v13, s[20:23], s1 offen sc1 lds
    s_add_u32 m0, s42, 10240
    s_nop 0
    buffer_load_dwordx4 v12, s[20:23], s36 offen offset:0 sc1 lds
    buffer_load_dwordx4 v12, s[20:23], s36 offen offset:1024 sc1 lds
    buffer_load_dwordx4 v12, s[20:23], s36 offen offset:2048 sc1 lds
    buffer_load_dwordx4 v12, s[20:23], s36 offen offset:3072 sc1 lds
    s_add_u32 m0, s42, 14336
    s_nop 0
    buffer_load_dwordx4 v13, s[20:23], s36 offen sc1 lds
    s_add_u32 m0, s42, 15360
    s_nop 0
    buffer_load_dwordx4 v12, s[20:23], s37 offen offset:0 sc1 lds
    buffer_load_dwordx4 v12, s[20:23], s37 offen offset:1024 sc1 lds
    buffer_load_dwordx4 v12, s[20:23], s37 offen offset:2048 sc1 lds
    buffer_load_dwordx4 v12, s[20:23], s37 offen offset:3072 sc1 lds
    s_add_u32 m0, s42, 19456
    s_nop 0
    buffer_load_dwordx4 v13, s[20:23], s37 offen sc1 lds
    buffer_load_dwordx4 v[16:19], v12, s[20:23], s62 offen offset:0 sc1
    buffer_load_dwordx4 v[20:23], v12, s[20:23], s62 offen offset:1024 sc1
    buffer_load_dwordx4 v[24:27], v12, s[20:23], s62 offen offset:2048 sc1
    buffer_load_dwordx4 v[28:31], v12, s[20:23], s62 offen offset:3072 sc1
    buffer_load_dwordx4 v[32:35], v13, s[20:23], s62 offen sc1
    s_add_u32 s62, s62, 10240
    s_cmp_ge_u32 s62, 276480
    s_cselect_b32 s63, 276480, 0
    s_sub_u32 s62, s62, s63
    buffer_load_dwordx4 v[36:39], v12, s[20:23], s62 offen offset:0 sc1
    buffer_load_dwordx4 v[40:43], v12, s[20:23], s62 offen offset:1024 sc1
    buffer_load_dwordx4 v[44:47], v12, s[20:23], s62 offen offset:2048 sc1
    buffer_load_dwordx4 v[48:51], v12, s[20:23], s62 offen offset:3072 sc1
    buffer_load_dwordx4 v[52:55], v13, s[20:23], s62 offen sc1
    s_add_u32 s62, s62, 10240
    s_cmp_ge_u32 s62, 276480
    s_cselect_b32 s63, 276480, 0
    s_sub_u32 s62, s62, s63
    buffer_load_dwordx4 v[56:59], v12, s[20:23], s62 offen offset:0 sc1
    buffer_load_dwordx4 v[60:63], v12, s[20:23], s62 offen offset:1024 sc1
    buffer_load_dwordx4 v[64:67], v12, s[20:23], s62 offen offset:2048 sc1
    buffer_load_dwordx4 v[68:71], v12, s[20:23], s62 offen offset:3072 sc1
    buffer_load_dwordx4 v[72:75], v13, s[20:23], s62 offen sc1
    s_add_u32 s62, s62, 10240
    s_cmp_ge_u32 s62, 276480
    s_cselect_b32 s63, 276480, 0
    s_sub_u32 s62, s62, s63
    buffer_load_dwordx4 v[76:79], v12, s[20:23], s62 offen offset:0 sc1
    buffer_load_dwordx4 v[80:83], v12, s[20:23], s62 offen offset:1024 sc1
    buffer_load_dwordx4 v[84:87], v12, s[20:23], s62 offen offset:2048 sc1
    buffer_load_dwordx4 v[88:91], v12, s[20:23], s62 offen offset:3072 sc1
    buffer_load_dwordx4 v[92:95], v13, s[20:23], s62 offen sc1
    s_add_u32 s62, s62, 10240
    s_cmp_ge_u32 s62, 276480
    s_cselect_b32 s63, 276480, 0
    s_sub_u32 s62, s62, s63
    buffer_load_dwordx4 v[96:99], v12, s[20:23], s62 offen offset:0 sc1
    buffer_load_dwordx4 v[100:103], v12, s[20:23], s62 offen offset:1024 sc1
    buffer_load_dwordx4 v[104:107], v12, s[20:23], s62 offen offset:2048 sc1
    buffer_load_dwordx4 v[108:111], v12, s[20:23], s62 offen offset:3072 sc1
    buffer_load_dwordx4 v[112:115], v13, s[20:23], s62 offen sc1
    s_add_u32 s62, s62, 10240
    s_cmp_ge_u32 s62, 276480
    s_cselect_b32 s63, 276480, 0
    s_sub_u32 s62, s62, s63
    s_waitcnt vmcnt(25)
    v_mov_b32 v14, 48140
    v_mov_b32 v15, 1
    s_waitcnt lgkmcnt(0)
    s_mov_b64 exec, 1
    ds_add_u32 v14, v15
    s_mov_b64 exec, -1
    v_mov_b32 v3, 48152
G2H:
    s_setprio 2
    s_and_b32 s49, s3, 1
    s_mul_i32 s34, s47, 221184
    s_add_u32 s34, s34, 0xc00000
    s_add_u32 s4, s86, s34
    s_addc_u32 s5, s87, 0
    s_mov_b32 s6, 221184
    s_mov_b32 s7, 0x20000
    s_and_b32 s36, s47, 3
    s_lshl_b32 s36, s36, 1
    s_add_u32 s36, s36, s48
    s_and_b32 s36, s36, 7
    s_mul_i32 s36, s36, 7
    s_add_u32 s36, s36, s49
    s_add_u32 s24, s36, 44
    s_cmp_ge_u32 s24, 54
    s_cselect_b32 s39, 54, 0
    s_sub_u32 s24, s24, s39
    s_lshl_b32 s24, s24, 12
    s_add_u32 s25, s36, 46
    s_cmp_ge_u32 s25, 54
    s_cselect_b32 s39, 54, 0
    s_sub_u32 s25, s25, s39
    s_lshl_b32 s25, s25, 12
    s_add_u32 s26, s36, 48
    s_cmp_ge_u32 s26, 54
    s_cselect_b32 s39, 54, 0
    s_sub_u32 s26, s26, s39
    s_lshl_b32 s26, s26, 12
    s_add_u32 s27, s36, 50
    s_cmp_ge_u32 s27, 54
    s_cselect_b32 s39, 54, 0
    s_sub_u32 s27, s27, s39
    s_lshl_b32 s27, s27, 12
    s_add_u32 s28, s36, 52
    s_cmp_ge_u32 s28, 54
    s_cselect_b32 s39, 54, 0
    s_sub_u32 s28, s28, s39
    s_lshl_b32 s28, s28, 12
    s_mov_b64 s[58:59], 0
    s_lshr_b32 s38, s24, 12
    s_bitcmp1_b64 s[58:59], s38
    s_cbranch_scc0 HW_g0
HR_g0:
    buffer_load_dwordx4 v[116:119], v12, s[4:7], s24 offen offset:0 sc1
    s_lshr_b32 s38, s25, 12
    s_bitcmp1_b64 s[58:59], s38
    s_cbranch_scc0 HW_g1
HR_g1:
    buffer_load_dwordx4 v[120:123], v12, s[4:7], s25 offen offset:0 sc1
    s_lshr_b32 s38, s26, 12
    s_bitcmp1_b64 s[58:59], s38
    s_cbranch_scc0 HW_g2
HR_g2:
    buffer_load_dwordx4 v[124:127], v12, s[4:7], s26 offen offset:0 sc1
    s_lshr_b32 s38, s27, 12
    s_bitcmp1_b64 s[58:59], s38
    s_cbranch_scc0 HW_g3
HR_g3:
    buffer_load_dwordx4 v[128:131], v12, s[4:7], s27 offen offset:0 sc1
    s_lshr_b32 s38, s28, 12
    s_bitcmp1_b64 s[58:59], s38
    s_cbranch_scc0 HW_g4
HR_g4:
    buffer_load_dwordx4 v[132:135], v12, s[4:7], s28 offen offset:0 sc1
    buffer_load_dwordx4 v[136:139], v12, s[4:7], s24 offen offset:1024 sc1
    buffer_load_dwordx4 v[140:143], v12, s[4:7], s25 offen offset:1024 sc1
    buffer_load_dwordx4 v[144:147], v12, s[4:7], s26 offen offset:1024 sc1
    buffer_load_dwordx4 v[148:151], v12, s[4:7], s27 offen offset:1024 sc1
    buffer_load_dwordx4 v[152:155], v12, s[4:7], s28 offen offset:1024 sc1
    buffer_load_dwordx4 v[156:159], v12, s[4:7], s24 offen offset:2048 sc1
    buffer_load_dwordx4 v[160:163], v12, s[4:7], s25 offen offset:2048 sc1
    buffer_load_dwordx4 v[164:167], v12, s[4:7], s26 offen offset:2048 sc1
    buffer_load_dwordx4 v[168:171], v12, s[4:7], s27 offen offset:2048 sc1
    buffer_load_dwordx4 v[172:175], v12, s[4:7], s28 offen offset:2048 sc1
    buffer_load_dwordx4 v[176:179], v12, s[4:7], s24 offen offset:3072 sc1
    buffer_load_dwordx4 v[180:183], v12, s[4:7], s25 offen offset:3072 sc1
    buffer_load_dwordx4 v[184:187], v12, s[4:7], s26 offen offset:3072 sc1
    buffer_load_dwordx4 v[188:191], v12, s[4:7], s27 offen offset:3072 sc1
    buffer_load_dwordx4 v[192:195], v12, s[4:7], s28 offen offset:3072 sc1
    s_cmp_lt_u32 s2, 32
    s_cselect_b32 s38, 0xffff5900, 0
    s_add_u32 s38, s38, 0x5400
    s_mul_i32 s38, s38, s49
    s_cmp_lt_u32 s2, 32
    s_cselect_b32 s33, 0x2fc0, 0
    s_add_u32 s33, s33, 0x18800
    s_add_u32 s33, s33, s38
    s_cmp_lt_u32 s2, 32
    s_cselect_b32 s38, 0xffff6780, 0
    s_add_u32 s38, s38, 0x5400
    s_mul_i32 s38, s38, s49
    s_cmp_lt_u32 s2, 32
    s_cselect_b32 s32, 0x9f40, 0
    s_add_u32 s32, s32, 0x1c400
    s_add_u32 s32, s32, s38
    v_add_u32 v8, s33, v12
    v_add_u32 v9, s32, v12
    s_lshl_b32 s34, 8, s49
    v_mov_b32 v13, s34
    s_add_u32 s34, s49, 6
    s_waitcnt vmcnt(19)
    v_mfma_f32_16x16x32_bf16 v[216:219], v[16:19], v[116:119], 0
    v_mfma_f32_16x16x32_bf16 v[220:223], v[20:23], v[116:119], 0
    v_mfma_f32_16x16x32_bf16 v[224:227], v[24:27], v[116:119], 0
    v_mfma_f32_16x16x32_bf16 v[228:231], v[28:31], v[116:119], 0
    v_mfma_f32_16x16x32_bf16 v[232:235], v[32:35], v[116:119], 0
    s_waitcnt vmcnt(18)
    v_mfma_f32_16x16x32_bf16 v[216:219], v[36:39], v[120:123], v[216:219]
    v_mfma_f32_16x16x32_bf16 v[220:223], v[40:43], v[120:123], v[220:223]
    v_mfma_f32_16x16x32_bf16 v[224:227], v[44:47], v[120:123], v[224:227]
    v_mfma_f32_16x16x32_bf16 v[228:231], v[48:51], v[120:123], v[228:231]
    v_mfma_f32_16x16x32_bf16 v[232:235], v[52:55], v[120:123], v[232:235]
    s_waitcnt vmcnt(17)
    v_mfma_f32_16x16x32_bf16 v[216:219], v[56:59], v[124:127], v[216:219]
    v_mfma_f32_16x16x32_bf16 v[220:223], v[60:63], v[124:127], v[220:223]
    v_mfma_f32_16x16x32_bf16 v[224:227], v[64:67], v[124:127], v[224:227]
    v_mfma_f32_16x16x32_bf16 v[228:231], v[68:71], v[124:127], v[228:231]
    v_mfma_f32_16x16x32_bf16 v[232:235], v[72:75], v[124:127], v[232:235]
    s_waitcnt vmcnt(16)
    v_mfma_f32_16x16x32_bf16 v[216:219], v[76:79], v[128:131], v[216:219]
    v_mfma_f32_16x16x32_bf16 v[220:223], v[80:83], v[128:131], v[220:223]
    v_mfma_f32_16x16x32_bf16 v[224:227], v[84:87], v[128:131], v[224:227]
    v_mfma_f32_16x16x32_bf16 v[228:231], v[88:91], v[128:131], v[228:231]
    v_mfma_f32_16x16x32_bf16 v[232:235], v[92:95], v[128:131], v[232:235]
    s_waitcnt vmcnt(15)
    ds_read_b32 v7, v3 offset:40
    v_mfma_f32_16x16x32_bf16 v[216:219], v[96:99], v[132:135], v[216:219]
    v_mfma_f32_16x16x32_bf16 v[220:223], v[100:103], v[132:135], v[220:223]
    v_mfma_f32_16x16x32_bf16 v[224:227], v[104:107], v[132:135], v[224:227]
    v_mfma_f32_16x16x32_bf16 v[228:231], v[108:111], v[132:135], v[228:231]
    v_mfma_f32_16x16x32_bf16 v[232:235], v[112:115], v[132:135], v[232:235]
    s_waitcnt vmcnt(14)
    v_mfma_f32_16x16x32_bf16 v[236:239], v[16:19], v[136:139], 0
    v_mfma_f32_16x16x32_bf16 v[240:243], v[20:23], v[136:139], 0
    v_mfma_f32_16x16x32_bf16 v[244:247], v[24:27], v[136:139], 0
    v_mfma_f32_16x16x32_bf16 v[248:251], v[28:31], v[136:139], 0
    v_mfma_f32_16x16x32_bf16 v[252:255], v[32:35], v[136:139], 0
    s_waitcnt vmcnt(13)
    s_waitcnt lgkmcnt(0)
    v_readfirstlane_b32 s54, v7
    s_nop 0
    s_bitcmp1_b32 s54, s34
    s_cbranch_scc0 FR_wait
FR_ret:
    v_mfma_f32_16x16x32_bf16 v[236:239], v[36:39], v[140:143], v[236:239]
    ds_write_b128 v8, v[216:219] offset:0
    v_mfma_f32_16x16x32_bf16 v[240:243], v[40:43], v[140:143], v[240:243]
    ds_write_b128 v8, v[220:223] offset:1024
    v_mfma_f32_16x16x32_bf16 v[244:247], v[44:47], v[140:143], v[244:247]
    ds_write_b128 v8, v[224:227] offset:2048
    v_mfma_f32_16x16x32_bf16 v[248:251], v[48:51], v[140:143], v[248:251]
    ds_write_b128 v8, v[228:231] offset:3072
    v_mfma_f32_16x16x32_bf16 v[252:255], v[52:55], v[140:143], v[252:255]
    ds_write_b128 v8, v[232:235] offset:4096
    s_waitcnt vmcnt(12)
    v_mfma_f32_16x16x32_bf16 v[236:239], v[56:59], v[144:147], v[236:239]
    s_mov_b64 exec, 1
    ds_add_u32 v3, v13 offset:40
    s_mov_b64 exec, -1
    v_lshlrev_b32 v13, 8, v13
    v_mfma_f32_16x16x32_bf16 v[240:243], v[60:63], v[144:147], v[240:243]
    v_mfma_f32_16x16x32_bf16 v[244:247], v[64:67], v[144:147], v[244:247]
    v_mfma_f32_16x16x32_bf16 v[248:251], v[68:71], v[144:147], v[248:251]
    v_mfma_f32_16x16x32_bf16 v[252:255], v[72:75], v[144:147], v[252:255]
    s_waitcnt vmcnt(11)
    v_mfma_f32_16x16x32_bf16 v[236:239], v[76:79], v[148:151], v[236:239]
    v_mfma_f32_16x16x32_bf16 v[240:243], v[80:83], v[148:151], v[240:243]
    v_mfma_f32_16x16x32_bf16 v[244:247], v[84:87], v[148:151], v[244:247]
    v_mfma_f32_16x16x32_bf16 v[248:251], v[88:91], v[148:151], v[248:251]
    v_mfma_f32_16x16x32_bf16 v[252:255], v[92:95], v[148:151], v[252:255]
    s_waitcnt vmcnt(10)
    v_mfma_f32_16x16x32_bf16 v[236:239], v[96:99], v[152:155], v[236:239]
    v_mfma_f32_16x16x32_bf16 v[240:243], v[100:103], v[152:155], v[240:243]
    v_mfma_f32_16x16x32_bf16 v[244:247], v[104:107], v[152:155], v[244:247]
    v_mfma_f32_16x16x32_bf16 v[248:251], v[108:111], v[152:155], v[248:251]
    v_mfma_f32_16x16x32_bf16 v[252:255], v[112:115], v[152:155], v[252:255]
    s_waitcnt vmcnt(9)
    v_mfma_f32_16x16x32_bf16 v[216:219], v[16:19], v[156:159], 0
    v_mfma_f32_16x16x32_bf16 v[220:223], v[20:23], v[156:159], 0
    v_mfma_f32_16x16x32_bf16 v[224:227], v[24:27], v[156:159], 0
    ds_write_b128 v8, v[236:239] offset:5120
    v_mfma_f32_16x16x32_bf16 v[228:231], v[28:31], v[156:159], 0
    ds_write_b128 v8, v[240:243] offset:6144
    v_mfma_f32_16x16x32_bf16 v[232:235], v[32:35], v[156:159], 0
    ds_write_b128 v8, v[244:247] offset:7168
    s_waitcnt vmcnt(8)
    v_mfma_f32_16x16x32_bf16 v[216:219], v[36:39], v[160:163], v[216:219]
    ds_write_b128 v8, v[248:251] offset:8192
    v_mfma_f32_16x16x32_bf16 v[220:223], v[40:43], v[160:163], v[220:223]
    ds_write_b128 v8, v[252:255] offset:9216
    v_mfma_f32_16x16x32_bf16 v[224:227], v[44:47], v[160:163], v[224:227]
    s_mov_b64 exec, 1
    ds_add_u32 v3, v13 offset:40
    s_mov_b64 exec, -1
    v_lshlrev_b32 v13, 8, v13
    v_mfma_f32_16x16x32_bf16 v[228:231], v[48:51], v[160:163], v[228:231]
    v_mfma_f32_16x16x32_bf16 v[232:235], v[52:55], v[160:163], v[232:235]
    s_waitcnt vmcnt(7)
    v_mfma_f32_16x16x32_bf16 v[216:219], v[56:59], v[164:167], v[216:219]
    v_mfma_f32_16x16x32_bf16 v[220:223], v[60:63], v[164:167], v[220:223]
    v_mfma_f32_16x16x32_bf16 v[224:227], v[64:67], v[164:167], v[224:227]
    v_mfma_f32_16x16x32_bf16 v[228:231], v[68:71], v[164:167], v[228:231]
    v_mfma_f32_16x16x32_bf16 v[232:235], v[72:75], v[164:167], v[232:235]
    s_waitcnt vmcnt(6)
    v_mfma_f32_16x16x32_bf16 v[216:219], v[76:79], v[168:171], v[216:219]
    v_mfma_f32_16x16x32_bf16 v[220:223], v[80:83], v[168:171], v[220:223]
    v_mfma_f32_16x16x32_bf16 v[224:227], v[84:87], v[168:171], v[224:227]
    v_mfma_f32_16x16x32_bf16 v[228:231], v[88:91], v[168:171], v[228:231]
    v_mfma_f32_16x16x32_bf16 v[232:235], v[92:95], v[168:171], v[232:235]
    s_waitcnt vmcnt(5)
    v_mfma_f32_16x16x32_bf16 v[216:219], v[96:99], v[172:175], v[216:219]
    v_mfma_f32_16x16x32_bf16 v[220:223], v[100:103], v[172:175], v[220:223]
    v_mfma_f32_16x16x32_bf16 v[224:227], v[104:107], v[172:175], v[224:227]
    v_mfma_f32_16x16x32_bf16 v[228:231], v[108:111], v[172:175], v[228:231]
    v_mfma_f32_16x16x32_bf16 v[232:235], v[112:115], v[172:175], v[232:235]
    s_waitcnt vmcnt(4)
    v_mfma_f32_16x16x32_bf16 v[236:239], v[16:19], v[176:179], 0
    v_mfma_f32_16x16x32_bf16 v[240:243], v[20:23], v[176:179], 0
    v_mfma_f32_16x16x32_bf16 v[244:247], v[24:27], v[176:179], 0
    ds_write_b128 v8, v[216:219] offset:10240
    v_mfma_f32_16x16x32_bf16 v[248:251], v[28:31], v[176:179], 0
    ds_write_b128 v8, v[220:223] offset:11264
    v_mfma_f32_16x16x32_bf16 v[252:255], v[32:35], v[176:179], 0
    ds_write_b128 v8, v[224:227] offset:12288
    s_waitcnt vmcnt(3)
    v_mfma_f32_16x16x32_bf16 v[236:239], v[36:39], v[180:183], v[236:239]
    ds_write_b128 v8, v[228:231] offset:13312
    v_mfma_f32_16x16x32_bf16 v[240:243], v[40:43], v[180:183], v[240:243]
    ds_write_b128 v8, v[232:235] offset:14336
    v_mfma_f32_16x16x32_bf16 v[244:247], v[44:47], v[180:183], v[244:247]
    s_mov_b64 exec, 1
    ds_add_u32 v3, v13 offset:40
    s_mov_b64 exec, -1
    v_lshlrev_b32 v13, 8, v13
    v_mfma_f32_16x16x32_bf16 v[248:251], v[48:51], v[180:183], v[248:251]
    v_mfma_f32_16x16x32_bf16 v[252:255], v[52:55], v[180:183], v[252:255]
    s_waitcnt vmcnt(2)
    v_mfma_f32_16x16x32_bf16 v[236:239], v[56:59], v[184:187], v[236:239]
    v_mfma_f32_16x16x32_bf16 v[240:243], v[60:63], v[184:187], v[240:243]
    v_mfma_f32_16x16x32_bf16 v[244:247], v[64:67], v[184:187], v[244:247]
    v_mfma_f32_16x16x32_bf16 v[248:251], v[68:71], v[184:187], v[248:251]
    v_mfma_f32_16x16x32_bf16 v[252:255], v[72:75], v[184:187], v[252:255]
    s_waitcnt vmcnt(1)
    v_mfma_f32_16x16x32_bf16 v[236:239], v[76:79], v[188:191], v[236:239]
    v_mfma_f32_16x16x32_bf16 v[240:243], v[80:83], v[188:191], v[240:243]
    v_mfma_f32_16x16x32_bf16 v[244:247], v[84:87], v[188:191], v[244:247]
    v_mfma_f32_16x16x32_bf16 v[248:251], v[88:91], v[188:191], v[248:251]
    v_mfma_f32_16x16x32_bf16 v[252:255], v[92:95], v[188:191], v[252:255]
    s_waitcnt vmcnt(0)
    v_mfma_f32_16x16x32_bf16 v[236:239], v[96:99], v[192:195], v[236:239]
    v_mfma_f32_16x16x32_bf16 v[240:243], v[100:103], v[192:195], v[240:243]
    v_mfma_f32_16x16x32_bf16 v[244:247], v[104:107], v[192:195], v[244:247]
    v_mfma_f32_16x16x32_bf16 v[248:251], v[108:111], v[192:195], v[248:251]
    v_mfma_f32_16x16x32_bf16 v[252:255], v[112:115], v[192:195], v[252:255]
    s_nop 3
    ds_write_b128 v9, v[236:239] offset:0
    ds_write_b128 v9, v[240:243] offset:1024
    ds_write_b128 v9, v[244:247] offset:2048
    ds_write_b128 v9, v[248:251] offset:3072
    ds_write_b128 v9, v[252:255] offset:4096
    s_mov_b64 exec, 1
    ds_add_u32 v3, v13 offset:40
    s_mov_b64 exec, -1
    v_lshlrev_b32 v13, 8, v13
    s_lshl_b32 s33, s2, 3
    s_add_u32 s33, s33, s3
    s_cmp_lg_u32 s33, 5
    s_cbranch_scc1 GH_exit
    s_add_u32 s4, s86, 0x1800000
    s_addc_u32 s5, s87, 0
    s_mov_b32 s6, 0x4b000
    s_mov_b32 s7, 0x20000
    v_lshlrev_b32 v2, 7, v1
    s_mov_b32 s33, 94208
    buffer_load_dwordx2 v[16:17], v2, s[4:7], s33 offen sc1
    s_mov_b32 s33, 102400
    buffer_load_dwordx2 v[18:19], v2, s[4:7], s33 offen sc1
    s_mov_b32 s33, 110592
    buffer_load_dwordx2 v[20:21], v2, s[4:7], s33 offen sc1
    s_mov_b32 s33, 118784
    buffer_load_dwordx2 v[22:23], v2, s[4:7], s33 offen sc1
    s_mov_b32 s53, 0
    s_waitcnt vmcnt(0)
PL_13:
    v_cmp_eq_u64 vcc, s[50:51], v[16:17]
    v_cmp_eq_u64 s[54:55], s[50:51], v[18:19]
    s_nop 0
    s_and_b64 vcc, s[54:55], vcc
    v_cmp_eq_u64 s[54:55], s[50:51], v[20:21]
    s_nop 0
    s_and_b64 vcc, s[54:55], vcc
    v_cmp_eq_u64 s[54:55], s[50:51], v[22:23]
    s_nop 0
    s_and_b64 vcc, s[54:55], vcc
    s_andn2_b64 s[54:55], exec, vcc
    s_cbranch_scc0 PD_14
    s_add_u32 s53, s53, 1
    s_cmp_gt_u32 s53, 200000
    s_cbranch_scc1 PD_14
    s_sleep 4
    s_mov_b32 s33, 94208
    buffer_load_dwordx2 v[16:17], v2, s[4:7], s33 offen sc1
    s_mov_b32 s33, 102400
    buffer_load_dwordx2 v[18:19], v2, s[4:7], s33 offen sc1
    s_mov_b32 s33, 110592
    buffer_load_dwordx2 v[20:21], v2, s[4:7], s33 offen sc1
    s_mov_b32 s33, 118784
    buffer_load_dwordx2 v[22:23], v2, s[4:7], s33 offen sc1
    s_waitcnt vmcnt(0)
    s_branch PL_13
PD_14:
    s_mov_b32 s8, s84
    s_mov_b32 s9, s85
    s_mov_b32 s10, 0x100
    s_mov_b32 s11, 0x20000
    v_mov_b32 v10, 0
    v_mov_b32 v11, 0
    s_mov_b64 exec, 1
    buffer_store_dwordx2 v[10:11], v10, s[8:11], 0 offen sc1
    s_mov_b64 exec, -1
GH_exit:
    s_waitcnt lgkmcnt(0)
    s_endpgm
CONV:
    s_setprio 1
    ds_read_b128 v[80:83], v7 offset:448
    ds_read_b128 v[152:155], v7 offset:432
    ds_read_b128 v[84:87], v7 offset:960
    ds_read_b128 v[88:91], v7 offset:1472
    ds_read_b128 v[92:95], v7 offset:1984
    ds_read_b128 v[96:99], v7 offset:2496
    ds_read_b128 v[100:103], v7 offset:3008
    ds_read_b128 v[104:107], v7 offset:3520
    ds_read_b128 v[108:111], v7 offset:4032
    ds_read_b128 v[156:159], v7 offset:944
    s_lshl_b32 s32, s49, 12
    v_mov_b32 v10, 0
    s_add_u32 s28, s86, 0x1400000
    s_addc_u32 s29, s87, 0
    s_mov_b32 s30, 0x280000
    s_mov_b32 s31, 0x20000
    s_waitcnt lgkmcnt(9)
    v_mfma_f32_16x16x32_bf16 v[16:19], v[80:83], v[48:51], 0
    ds_read2_b32 v[176:177], v70 offset0:32 offset1:33
    v_mfma_f32_16x16x32_bf16 v[20:23], v[80:83], v[52:55], 0
    ds_read2_b32 v[178:179], v70 offset0:34 offset1:35
    v_mfma_f32_16x16x32_bf16 v[24:27], v[80:83], v[56:59], 0
    ds_read2_b32 v[180:181], v70 offset0:16 offset1:17
    s_waitcnt lgkmcnt(11)
    v_mfma_f32_16x16x32_bf16 v[28:31], v[152:155], v[52:55], 0
    ds_read2_b32 v[182:183], v70 offset0:18 offset1:19
    v_mfma_f32_16x16x32_bf16 v[32:35], v[80:83], v[60:63], 0
    ds_read2_b32 v[184:185], v70 offset0:0 offset1:1
    v_mfma_f32_16x16x32_bf16 v[36:39], v[152:155], v[64:67], 0
    ds_read2_b32 v[186:187], v70 offset0:2 offset1:3
    v_mfma_f32_16x16x32_bf16 v[208:211], v[40:43], v[80:83], 0
    v_cvt_pk_bf16_f32 v16, v16, v20
    s_waitcnt lgkmcnt(13)
    v_mfma_f32_16x16x32_bf16 v[212:215], v[40:43], v[84:87], 0
    v_cvt_pk_bf16_f32 v17, v17, v21
    s_waitcnt lgkmcnt(12)
    v_mfma_f32_16x16x32_bf16 v[216:219], v[40:43], v[88:91], 0
    v_cvt_pk_bf16_f32 v18, v18, v22
    s_waitcnt lgkmcnt(11)
    v_mfma_f32_16x16x32_bf16 v[220:223], v[40:43], v[92:95], 0
    v_cvt_pk_bf16_f32 v19, v19, v23
    s_waitcnt lgkmcnt(10)
    v_mfma_f32_16x16x32_bf16 v[224:227], v[40:43], v[96:99], 0
    v_cvt_pk_bf16_f32 v24, v24, v28
    s_waitcnt lgkmcnt(9)
    v_mfma_f32_16x16x32_bf16 v[228:231], v[40:43], v[100:103], 0
    v_cvt_pk_bf16_f32 v25, v25, v29
    s_waitcnt lgkmcnt(8)
    v_mfma_f32_16x16x32_bf16 v[232:235], v[40:43], v[104:107], 0
    v_cvt_pk_bf16_f32 v26, v26, v30
    s_waitcnt lgkmcnt(7)
    v_mfma_f32_16x16x32_bf16 v[236:239], v[40:43], v[108:111], 0
    v_cvt_pk_bf16_f32 v27, v27, v31
    v_mfma_f32_16x16x32_bf16 v[112:115], v[84:87], v[48:51], 0
    v_cvt_pk_bf16_f32 v32, v32, v36
    v_mfma_f32_16x16x32_bf16 v[116:119], v[84:87], v[52:55], 0
    v_cvt_pk_bf16_f32 v33, v33, v37
    v_mfma_f32_16x16x32_bf16 v[120:123], v[84:87], v[56:59], 0
    v_cvt_pk_bf16_f32 v34, v34, v38
    s_waitcnt lgkmcnt(6)
    v_mfma_f32_16x16x32_bf16 v[124:127], v[156:159], v[52:55], 0
    v_cvt_pk_bf16_f32 v35, v35, v39
    v_mfma_f32_16x16x32_bf16 v[128:131], v[84:87], v[60:63], 0
    ds_read2_b32 v[188:189], v70 offset0:80 offset1:81
    v_mfma_f32_16x16x32_bf16 v[132:135], v[156:159], v[64:67], 0
    ds_read2_b32 v[190:191], v70 offset0:82 offset1:83
    s_waitcnt lgkmcnt(6)
    v_mfma_f32_16x16x32_bf16 v[216:219], v[16:19], v[176:179], v[216:219]
    v_cvt_pk_bf16_f32 v112, v112, v116
    s_waitcnt lgkmcnt(4)
    v_mfma_f32_16x16x32_bf16 v[220:223], v[16:19], v[180:183], v[220:223]
    v_cvt_pk_bf16_f32 v113, v113, v117
    s_waitcnt lgkmcnt(2)
    v_mfma_f32_16x16x32_bf16 v[224:227], v[16:19], v[184:187], v[224:227]
    v_cvt_pk_bf16_f32 v114, v114, v118
    s_waitcnt lgkmcnt(0)
    v_mfma_f32_16x16x32_bf16 v[216:219], v[24:27], v[188:191], v[216:219]
    v_cvt_pk_bf16_f32 v115, v115, v119
    ds_read2_b32 v[192:193], v70 offset0:64 offset1:65
    ds_read2_b32 v[194:195], v70 offset0:66 offset1:67
    s_waitcnt lgkmcnt(0)
    v_mfma_f32_16x16x32_bf16 v[220:223], v[24:27], v[192:195], v[220:223]
    v_cvt_pk_bf16_f32 v120, v120, v124
    ds_read2_b32 v[196:197], v70 offset0:48 offset1:49
    ds_read2_b32 v[198:199], v70 offset0:50 offset1:51
    s_waitcnt lgkmcnt(0)
    v_mfma_f32_16x16x32_bf16 v[224:227], v[24:27], v[196:199], v[224:227]
    v_cvt_pk_bf16_f32 v121, v121, v125
    ds_read_b128 v[160:163], v7 offset:1456
    ds_read2_b32 v[200:201], v70 offset0:184 offset1:185
    ds_read2_b32 v[202:203], v70 offset0:186 offset1:187
    ds_read2_b32 v[240:241], v70 offset0:168 offset1:169
    ds_read2_b32 v[242:243], v70 offset0:170 offset1:171
    s_waitcnt lgkmcnt(0)
    v_mfma_f32_16x16x32_bf16 v[228:231], v[32:35], v[240:243], v[228:231]
    v_cvt_pk_bf16_f32 v122, v122, v126
    ds_read2_b32 v[244:245], v70 offset0:152 offset1:153
    ds_read2_b32 v[246:247], v70 offset0:154 offset1:155
    s_waitcnt lgkmcnt(0)
    v_mfma_f32_16x16x32_bf16 v[232:235], v[32:35], v[244:247], v[232:235]
    v_cvt_pk_bf16_f32 v123, v123, v127
    ds_read2_b32 v[248:249], v70 offset0:136 offset1:137
    ds_read2_b32 v[250:251], v70 offset0:138 offset1:139
    s_waitcnt lgkmcnt(0)
    v_mfma_f32_16x16x32_bf16 v[236:239], v[32:35], v[248:251], v[236:239]
    v_cvt_pk_bf16_f32 v128, v128, v132
    v_mfma_f32_16x16x32_bf16 v[224:227], v[32:35], v[200:203], v[224:227]
    v_cvt_pk_bf16_f32 v129, v129, v133
    v_mfma_f32_16x16x32_bf16 v[16:19], v[88:91], v[48:51], 0
    v_cvt_pk_bf16_f32 v130, v130, v134
    v_mfma_f32_16x16x32_bf16 v[20:23], v[88:91], v[52:55], 0
    v_cvt_pk_bf16_f32 v131, v131, v135
    v_mfma_f32_16x16x32_bf16 v[24:27], v[88:91], v[56:59], 0
    ds_read_b128 v[164:167], v7 offset:1968
    v_mfma_f32_16x16x32_bf16 v[28:31], v[160:163], v[52:55], 0
    ds_read_b128 v[168:171], v7 offset:2480
    v_mfma_f32_16x16x32_bf16 v[32:35], v[88:91], v[60:63], 0
    ds_read_b128 v[172:175], v7 offset:2992
    v_mfma_f32_16x16x32_bf16 v[36:39], v[160:163], v[64:67], 0
    ds_read2_b32 v[72:73], v68 offset0:240 offset1:241
    v_mfma_f32_16x16x32_bf16 v[220:223], v[112:115], v[176:179], v[220:223]
    v_cvt_pk_bf16_f32 v16, v16, v20
    v_mfma_f32_16x16x32_bf16 v[224:227], v[112:115], v[180:183], v[224:227]
    v_cvt_pk_bf16_f32 v17, v17, v21
    v_mfma_f32_16x16x32_bf16 v[228:231], v[112:115], v[184:187], v[228:231]
    v_cvt_pk_bf16_f32 v18, v18, v22
    v_mfma_f32_16x16x32_bf16 v[220:223], v[120:123], v[188:191], v[220:223]
    v_cvt_pk_bf16_f32 v19, v19, v23
    v_mfma_f32_16x16x32_bf16 v[224:227], v[120:123], v[192:195], v[224:227]
    v_cvt_pk_bf16_f32 v24, v24, v28
    v_mfma_f32_16x16x32_bf16 v[228:231], v[120:123], v[196:199], v[228:231]
    v_cvt_pk_bf16_f32 v25, v25, v29
    v_mfma_f32_16x16x32_bf16 v[232:235], v[128:131], v[240:243], v[232:235]
    v_cvt_pk_bf16_f32 v26, v26, v30
    v_mfma_f32_16x16x32_bf16 v[236:239], v[128:131], v[244:247], v[236:239]
    v_cvt_pk_bf16_f32 v27, v27, v31
    v_mfma_f32_16x16x32_bf16 v[228:231], v[128:131], v[200:203], v[228:231]
    v_cvt_pk_bf16_f32 v32, v32, v36
    v_mfma_f32_16x16x32_bf16 v[112:115], v[92:95], v[48:51], 0
    v_cvt_pk_bf16_f32 v33, v33, v37
    v_mfma_f32_16x16x32_bf16 v[116:119], v[92:95], v[52:55], 0
    v_cvt_pk_bf16_f32 v34, v34, v38
    v_mfma_f32_16x16x32_bf16 v[120:123], v[92:95], v[56:59], 0
    v_cvt_pk_bf16_f32 v35, v35, v39
    s_waitcnt lgkmcnt(3)
    v_mfma_f32_16x16x32_bf16 v[124:127], v[164:167], v[52:55], 0
    ds_read2_b32 v[74:75], v68 offset0:242 offset1:243
    v_mfma_f32_16x16x32_bf16 v[128:131], v[92:95], v[60:63], 0
    ds_read2_b32 v[76:77], v68 offset0:112 offset1:113
    v_mfma_f32_16x16x32_bf16 v[132:135], v[164:167], v[64:67], 0
    ds_read2_b32 v[78:79], v68 offset0:114 offset1:115
    v_mfma_f32_16x16x32_bf16 v[224:227], v[16:19], v[176:179], v[224:227]
    v_cvt_pk_bf16_f32 v112, v112, v116
    v_mfma_f32_16x16x32_bf16 v[228:231], v[16:19], v[180:183], v[228:231]
    v_cvt_pk_bf16_f32 v113, v113, v117
    v_mfma_f32_16x16x32_bf16 v[232:235], v[16:19], v[184:187], v[232:235]
    v_cvt_pk_bf16_f32 v114, v114, v118
    v_mfma_f32_16x16x32_bf16 v[224:227], v[24:27], v[188:191], v[224:227]
    v_cvt_pk_bf16_f32 v115, v115, v119
    v_mfma_f32_16x16x32_bf16 v[228:231], v[24:27], v[192:195], v[228:231]
    v_cvt_pk_bf16_f32 v120, v120, v124
    v_mfma_f32_16x16x32_bf16 v[232:235], v[24:27], v[196:199], v[232:235]
    v_cvt_pk_bf16_f32 v121, v121, v125
    v_mfma_f32_16x16x32_bf16 v[236:239], v[32:35], v[240:243], v[236:239]
    v_cvt_pk_bf16_f32 v122, v122, v126
    v_mfma_f32_16x16x32_bf16 v[232:235], v[32:35], v[200:203], v[232:235]
    v_cvt_pk_bf16_f32 v123, v123, v127
    v_mfma_f32_16x16x32_bf16 v[16:19], v[96:99], v[48:51], 0
    v_cvt_pk_bf16_f32 v128, v128, v132
    v_mfma_f32_16x16x32_bf16 v[20:23], v[96:99], v[52:55], 0
    v_cvt_pk_bf16_f32 v129, v129, v133
    v_mfma_f32_16x16x32_bf16 v[24:27], v[96:99], v[56:59], 0
    v_cvt_pk_bf16_f32 v130, v130, v134
    s_waitcnt lgkmcnt(5)
    v_mfma_f32_16x16x32_bf16 v[28:31], v[168:171], v[52:55], 0
    v_cvt_pk_bf16_f32 v131, v131, v135
    v_mfma_f32_16x16x32_bf16 v[228:231], v[112:115], v[176:179], v[228:231]
    ds_read2_b32 v[44:45], v69 offset0:128 offset1:129
    v_mfma_f32_16x16x32_bf16 v[232:235], v[112:115], v[180:183], v[232:235]
    ds_read2_b32 v[46:47], v69 offset0:130 offset1:131
    v_mfma_f32_16x16x32_bf16 v[236:239], v[112:115], v[184:187], v[236:239]
    v_cvt_pk_bf16_f32 v16, v16, v20
    v_mfma_f32_16x16x32_bf16 v[228:231], v[120:123], v[188:191], v[228:231]
    v_cvt_pk_bf16_f32 v17, v17, v21
    v_mfma_f32_16x16x32_bf16 v[232:235], v[120:123], v[192:195], v[232:235]
    v_cvt_pk_bf16_f32 v18, v18, v22
    v_mfma_f32_16x16x32_bf16 v[236:239], v[120:123], v[196:199], v[236:239]
    v_cvt_pk_bf16_f32 v19, v19, v23
    v_mfma_f32_16x16x32_bf16 v[236:239], v[128:131], v[200:203], v[236:239]
    v_cvt_pk_bf16_f32 v24, v24, v28
    v_mfma_f32_16x16x32_bf16 v[112:115], v[100:103], v[48:51], 0
    v_cvt_pk_bf16_f32 v25, v25, v29
    v_mfma_f32_16x16x32_bf16 v[116:119], v[100:103], v[52:55], 0
    v_cvt_pk_bf16_f32 v26, v26, v30
    v_mfma_f32_16x16x32_bf16 v[120:123], v[100:103], v[56:59], 0
    v_cvt_pk_bf16_f32 v27, v27, v31
    s_waitcnt lgkmcnt(6)
    v_mfma_f32_16x16x32_bf16 v[124:127], v[172:175], v[52:55], 0
    ds_read2_b32 v[252:253], v69 offset0:0 offset1:1
    v_mfma_f32_16x16x32_bf16 v[232:235], v[16:19], v[176:179], v[232:235]
    ds_read2_b32 v[254:255], v69 offset0:2 offset1:3
    v_mfma_f32_16x16x32_bf16 v[236:239], v[16:19], v[180:183], v[236:239]
    ds_read_b128 v[136:139], v7 offset:2432
    v_mfma_f32_16x16x32_bf16 v[232:235], v[24:27], v[188:191], v[232:235]
    v_cvt_pk_bf16_f32 v112, v112, v116
    v_mfma_f32_16x16x32_bf16 v[236:239], v[24:27], v[192:195], v[236:239]
    v_cvt_pk_bf16_f32 v113, v113, v117
    s_waitcnt lgkmcnt(7)
    v_mfma_f32_16x16x32_bf16 v[208:211], v[72:75], v[80:83], v[208:211]
    v_cvt_pk_bf16_f32 v114, v114, v118
    v_mfma_f32_16x16x32_bf16 v[212:215], v[72:75], v[84:87], v[212:215]
    v_cvt_pk_bf16_f32 v115, v115, v119
    v_mfma_f32_16x16x32_bf16 v[216:219], v[72:75], v[88:91], v[216:219]
    v_cvt_pk_bf16_f32 v120, v120, v124
    v_mfma_f32_16x16x32_bf16 v[236:239], v[112:115], v[176:179], v[236:239]
    v_cvt_pk_bf16_f32 v121, v121, v125
    v_cvt_pk_bf16_f32 v122, v122, v126
    v_cvt_pk_bf16_f32 v123, v123, v127
    s_nop 1
    v_mfma_f32_16x16x32_bf16 v[236:239], v[120:123], v[188:191], v[236:239]
    ds_read_b128 v[140:143], v7 offset:2944
    v_mfma_f32_16x16x32_bf16 v[220:223], v[72:75], v[92:95], v[220:223]
    ds_read_b128 v[144:147], v7 offset:3456
    v_mfma_f32_16x16x32_bf16 v[224:227], v[72:75], v[96:99], v[224:227]
    ds_read_b128 v[148:151], v7 offset:3968
    v_mfma_f32_16x16x32_bf16 v[228:231], v[72:75], v[100:103], v[228:231]
    ds_read2_b32 v[112:113], v68 offset0:224 offset1:225
    v_mfma_f32_16x16x32_bf16 v[232:235], v[72:75], v[104:107], v[232:235]
    ds_read2_b32 v[114:115], v68 offset0:226 offset1:227
    v_mfma_f32_16x16x32_bf16 v[236:239], v[72:75], v[108:111], v[236:239]
    ds_read_b128 v[120:123], v7 offset:384
    s_waitcnt lgkmcnt(11)
    v_mfma_f32_16x16x32_bf16 v[212:215], v[76:79], v[80:83], v[212:215]
    ds_read_b128 v[124:127], v7 offset:896
    v_mfma_f32_16x16x32_bf16 v[216:219], v[76:79], v[84:87], v[216:219]
    ds_read_b128 v[128:131], v7 offset:1408
    v_mfma_f32_16x16x32_bf16 v[220:223], v[76:79], v[88:91], v[220:223]
    ds_read_b128 v[132:135], v7 offset:1920
    v_mfma_f32_16x16x32_bf16 v[224:227], v[76:79], v[92:95], v[224:227]
    ds_read2_b32 v[116:117], v68 offset0:96 offset1:97
    v_mfma_f32_16x16x32_bf16 v[228:231], v[76:79], v[96:99], v[228:231]
    ds_read2_b32 v[118:119], v68 offset0:98 offset1:99
    v_mfma_f32_16x16x32_bf16 v[232:235], v[76:79], v[100:103], v[232:235]
    v_mfma_f32_16x16x32_bf16 v[236:239], v[76:79], v[104:107], v[236:239]
    s_waitcnt lgkmcnt(14)
    v_mfma_f32_16x16x32_bf16 v[216:219], v[44:47], v[80:83], v[216:219]
    v_mfma_f32_16x16x32_bf16 v[220:223], v[44:47], v[84:87], v[220:223]
    v_mfma_f32_16x16x32_bf16 v[224:227], v[44:47], v[88:91], v[224:227]
    v_mfma_f32_16x16x32_bf16 v[228:231], v[44:47], v[92:95], v[228:231]
    v_mfma_f32_16x16x32_bf16 v[232:235], v[44:47], v[96:99], v[232:235]
    v_mfma_f32_16x16x32_bf16 v[236:239], v[44:47], v[100:103], v[236:239]
    s_waitcnt lgkmcnt(12)
    v_mfma_f32_16x16x32_bf16 v[224:227], v[252:255], v[80:83], v[224:227]
    v_mfma_f32_16x16x32_bf16 v[228:231], v[252:255], v[84:87], v[228:231]
    v_mfma_f32_16x16x32_bf16 v[232:235], v[252:255], v[88:91], v[232:235]
    v_mfma_f32_16x16x32_bf16 v[236:239], v[252:255], v[92:95], v[236:239]
    ds_read2_b32 v[72:73], v68 offset0:208 offset1:209
    s_and_b32 s33, s58, 3
    s_cbranch_scc0 CV_m0
    v_mov_b32 v5, 163812
    s_mov_b32 s53, 0
LS_15:
    ds_read_b32 v6, v5
    s_waitcnt lgkmcnt(0)
    v_readfirstlane_b32 s54, v6
    s_nop 0
    s_cmp_ge_u32 s54, 2
    s_cbranch_scc1 LD_16
    s_add_u32 s53, s53, 1
    s_cmp_gt_u32 s53, 3200000
    s_cbranch_scc1 LD_16
    s_sleep 1
    s_branch LS_15
LD_16:
    s_cmp_eq_u32 s58, 2
    s_cbranch_scc1 CV_mid
    s_waitcnt vmcnt(0)
    v_mov_b32 v5, 163828
    v_mov_b32 v6, 1
    s_waitcnt lgkmcnt(0)
    s_mov_b64 exec, 1
    ds_add_u32 v5, v6
    s_mov_b64 exec, -1
    s_branch CV_mid
CV_m0:
    s_waitcnt vmcnt(0)
    s_bitcmp0_b32 s3, 0
    s_cbranch_scc1 CV_nz
    s_mov_b64 s[56:57], -1
    s_mov_b32 s53, 0
    s_waitcnt vmcnt(0)
PL_17:
    v_cmp_eq_u64 vcc, s[50:51], v[8:9]
    s_nop 0
    s_andn2_b64 s[54:55], s[56:57], vcc
    s_cbranch_scc0 PD_18
    s_add_u32 s53, s53, 1
    s_cmp_gt_u32 s53, 200000
    s_cbranch_scc1 PD_18
    s_sleep 2
    buffer_load_dwordx2 v[8:9], v13, s[4:7], 0 offen offset:0 sc1
    s_waitcnt vmcnt(0)
    s_branch PL_17
PD_18:
    s_cmp_lt_u32 s2, 32
    s_cselect_b32 s33, 0x1c3dc, 0
    s_add_u32 s33, s33, 0xbc20
    v_mov_b32 v5, s33
    v_mov_b32 v6, 1
    s_waitcnt lgkmcnt(0)
    s_mov_b64 exec, 1
    ds_add_u32 v5, v6
    s_mov_b64 exec, -1
CV_nz:
    s_cmp_eq_u32 s58, 0
    s_cbranch_scc1 CV_m1
    s_mov_b32 s43, s32
    s_cmp_lt_u32 s2, 32
    s_cselect_b32 s33, 0x1c3bc, 0
    s_add_u32 s33, s33, 0xbc10
    s_cmp_lt_u32 s2, 32
    s_cselect_b32 s35, 0x4, 0
    s_add_u32 s35, s35, 0x1
    v_mov_b32 v46, s33
    v_mov_b32 v47, 1
    s_mov_b64 exec, 1
    ds_add_rtn_u32 v47, v46, v47
    s_cmp_lt_u32 s2, 32
    s_cselect_b32 s33, 0x7000, 0
    s_add_u32 s33, s33, 0x17000
    s_lshl_b32 s32, s46, 7
    s_add_u32 s33, s33, s32
    s_waitcnt lgkmcnt(0)
    v_readfirstlane_b32 s32, v47
    s_nop 0
    s_cmp_lg_u32 s32, s35
    s_cbranch_scc1 CF_19
    v_mov_b32 v44, s50
    v_mov_b32 v45, s51
    buffer_store_dwordx2 v[44:45], v10, s[4:7], s33 offen offset:0 sc1
CF_19:
    s_mov_b64 exec, -1
    s_mov_b32 s32, s43
    s_branch CV_mid
CV_m1:
    v_mov_b32 v5, 48140
    v_mov_b32 v6, 1
    s_waitcnt lgkmcnt(0)
    s_mov_b64 exec, 1
    ds_add_u32 v5, v6
    s_mov_b64 exec, -1
CV_mid:
    s_waitcnt lgkmcnt(6)
    v_mfma_f32_16x16x32_bf16 v[208:211], v[112:115], v[120:123], v[208:211]
    ds_read2_b32 v[74:75], v68 offset0:210 offset1:211
    s_waitcnt lgkmcnt(6)
    v_mfma_f32_16x16x32_bf16 v[212:215], v[112:115], v[124:127], v[212:215]
    ds_read_b128 v[80:83], v7 offset:320
    s_waitcnt lgkmcnt(6)
    v_mfma_f32_16x16x32_bf16 v[216:219], v[112:115], v[128:131], v[216:219]
    ds_read_b128 v[84:87], v7 offset:832
    s_waitcnt lgkmcnt(6)
    v_mfma_f32_16x16x32_bf16 v[220:223], v[112:115], v[132:135], v[220:223]
    ds_read_b128 v[88:91], v7 offset:1344
    v_mfma_f32_16x16x32_bf16 v[224:227], v[112:115], v[136:139], v[224:227]
    ds_read_b128 v[92:95], v7 offset:1856
    v_mfma_f32_16x16x32_bf16 v[228:231], v[112:115], v[140:143], v[228:231]
    ds_read_b128 v[96:99], v7 offset:2368
    v_mfma_f32_16x16x32_bf16 v[232:235], v[112:115], v[144:147], v[232:235]
    ds_read_b128 v[100:103], v7 offset:2880
    v_mfma_f32_16x16x32_bf16 v[236:239], v[112:115], v[148:151], v[236:239]
    ds_read_b128 v[104:107], v7 offset:3392
    s_waitcnt lgkmcnt(9)
    v_mfma_f32_16x16x32_bf16 v[212:215], v[116:119], v[120:123], v[212:215]
    ds_read_b128 v[108:111], v7 offset:3904
    v_mfma_f32_16x16x32_bf16 v[216:219], v[116:119], v[124:127], v[216:219]
    ds_read2_b32 v[76:77], v68 offset0:80 offset1:81
    v_mfma_f32_16x16x32_bf16 v[220:223], v[116:119], v[128:131], v[220:223]
    ds_read2_b32 v[78:79], v68 offset0:82 offset1:83
    v_mfma_f32_16x16x32_bf16 v[224:227], v[116:119], v[132:135], v[224:227]
    v_mfma_f32_16x16x32_bf16 v[228:231], v[116:119], v[136:139], v[228:231]
    v_mfma_f32_16x16x32_bf16 v[232:235], v[116:119], v[140:143], v[232:235]
    v_mfma_f32_16x16x32_bf16 v[236:239], v[116:119], v[144:147], v[236:239]
    ds_read2_b32 v[112:113], v68 offset0:192 offset1:193
    s_waitcnt lgkmcnt(10)
    v_mfma_f32_16x16x32_bf16 v[208:211], v[72:75], v[80:83], v[208:211]
    ds_read2_b32 v[114:115], v68 offset0:194 offset1:195
    s_waitcnt lgkmcnt(10)
    v_mfma_f32_16x16x32_bf16 v[212:215], v[72:75], v[84:87], v[212:215]
    ds_read_b128 v[120:123], v7 offset:256
    s_waitcnt lgkmcnt(10)
    v_mfma_f32_16x16x32_bf16 v[216:219], v[72:75], v[88:91], v[216:219]
    ds_read_b128 v[124:127], v7 offset:768
    s_waitcnt lgkmcnt(10)
    v_mfma_f32_16x16x32_bf16 v[220:223], v[72:75], v[92:95], v[220:223]
    ds_read_b128 v[128:131], v7 offset:1280
    s_waitcnt lgkmcnt(10)
    v_mfma_f32_16x16x32_bf16 v[224:227], v[72:75], v[96:99], v[224:227]
    ds_read_b128 v[132:135], v7 offset:1792
    s_waitcnt lgkmcnt(10)
    v_mfma_f32_16x16x32_bf16 v[228:231], v[72:75], v[100:103], v[228:231]
    ds_read_b128 v[136:139], v7 offset:2304
    s_waitcnt lgkmcnt(10)
    v_mfma_f32_16x16x32_bf16 v[232:235], v[72:75], v[104:107], v[232:235]
    ds_read_b128 v[140:143], v7 offset:2816
    s_waitcnt lgkmcnt(10)
    v_mfma_f32_16x16x32_bf16 v[236:239], v[72:75], v[108:111], v[236:239]
    ds_read_b128 v[144:147], v7 offset:3328
    s_waitcnt lgkmcnt(9)
    v_mfma_f32_16x16x32_bf16 v[212:215], v[76:79], v[80:83], v[212:215]
    ds_read_b128 v[148:151], v7 offset:3840
    v_mfma_f32_16x16x32_bf16 v[216:219], v[76:79], v[84:87], v[216:219]
    ds_read2_b32 v[116:117], v68 offset0:64 offset1:65
    v_mfma_f32_16x16x32_bf16 v[220:223], v[76:79], v[88:91], v[220:223]
    ds_read2_b32 v[118:119], v68 offset0:66 offset1:67
    v_mfma_f32_16x16x32_bf16 v[224:227], v[76:79], v[92:95], v[224:227]
    v_mfma_f32_16x16x32_bf16 v[228:231], v[76:79], v[96:99], v[228:231]
    v_mfma_f32_16x16x32_bf16 v[232:235], v[76:79], v[100:103], v[232:235]
    v_mfma_f32_16x16x32_bf16 v[236:239], v[76:79], v[104:107], v[236:239]
    ds_read2_b32 v[72:73], v68 offset0:176 offset1:177
    s_waitcnt lgkmcnt(10)
    v_mfma_f32_16x16x32_bf16 v[208:211], v[112:115], v[120:123], v[208:211]
    ds_read2_b32 v[74:75], v68 offset0:178 offset1:179
    s_waitcnt lgkmcnt(10)
    v_mfma_f32_16x16x32_bf16 v[212:215], v[112:115], v[124:127], v[212:215]
    ds_read_b128 v[80:83], v7 offset:192
    s_waitcnt lgkmcnt(10)
    v_mfma_f32_16x16x32_bf16 v[216:219], v[112:115], v[128:131], v[216:219]
    ds_read_b128 v[84:87], v7 offset:704
    s_waitcnt lgkmcnt(10)
    v_mfma_f32_16x16x32_bf16 v[220:223], v[112:115], v[132:135], v[220:223]
    ds_read_b128 v[88:91], v7 offset:1216
    s_waitcnt lgkmcnt(10)
    v_mfma_f32_16x16x32_bf16 v[224:227], v[112:115], v[136:139], v[224:227]
    ds_read_b128 v[92:95], v7 offset:1728
    s_waitcnt lgkmcnt(10)
    v_mfma_f32_16x16x32_bf16 v[228:231], v[112:115], v[140:143], v[228:231]
    ds_read_b128 v[96:99], v7 offset:2240
    s_waitcnt lgkmcnt(10)
    v_mfma_f32_16x16x32_bf16 v[232:235], v[112:115], v[144:147], v[232:235]
    ds_read_b128 v[100:103], v7 offset:2752
    s_waitcnt lgkmcnt(10)
    v_mfma_f32_16x16x32_bf16 v[236:239], v[112:115], v[148:151], v[236:239]
    ds_read_b128 v[104:107], v7 offset:3264
    s_waitcnt lgkmcnt(9)
    v_mfma_f32_16x16x32_bf16 v[212:215], v[116:119], v[120:123], v[212:215]
    ds_read_b128 v[108:111], v7 offset:3776
    v_mfma_f32_16x16x32_bf16 v[216:219], v[116:119], v[124:127], v[216:219]
    ds_read2_b32 v[76:77], v68 offset0:48 offset1:49
    v_mfma_f32_16x16x32_bf16 v[220:223], v[116:119], v[128:131], v[220:223]
    ds_read2_b32 v[78:79], v68 offset0:50 offset1:51
    v_mfma_f32_16x16x32_bf16 v[224:227], v[116:119], v[132:135], v[224:227]
    v_mfma_f32_16x16x32_bf16 v[228:231], v[116:119], v[136:139], v[228:231]
    v_mfma_f32_16x16x32_bf16 v[232:235], v[116:119], v[140:143], v[232:235]
    v_mfma_f32_16x16x32_bf16 v[236:239], v[116:119], v[144:147], v[236:239]
    ds_read2_b32 v[112:113], v68 offset0:160 offset1:161
    s_waitcnt lgkmcnt(10)
    v_mfma_f32_16x16x32_bf16 v[208:211], v[72:75], v[80:83], v[208:211]
    ds_read2_b32 v[114:115], v68 offset0:162 offset1:163
    s_waitcnt lgkmcnt(10)
    v_mfma_f32_16x16x32_bf16 v[212:215], v[72:75], v[84:87], v[212:215]
    ds_read_b128 v[120:123], v7 offset:128
    s_waitcnt lgkmcnt(10)
    v_mfma_f32_16x16x32_bf16 v[216:219], v[72:75], v[88:91], v[216:219]
    ds_read_b128 v[124:127], v7 offset:640
    s_waitcnt lgkmcnt(10)
    v_mfma_f32_16x16x32_bf16 v[220:223], v[72:75], v[92:95], v[220:223]
    ds_read_b128 v[128:131], v7 offset:1152
    s_waitcnt lgkmcnt(10)
    v_mfma_f32_16x16x32_bf16 v[224:227], v[72:75], v[96:99], v[224:227]
    ds_read_b128 v[132:135], v7 offset:1664
    s_waitcnt lgkmcnt(10)
    v_mfma_f32_16x16x32_bf16 v[228:231], v[72:75], v[100:103], v[228:231]
    ds_read_b128 v[136:139], v7 offset:2176
    s_waitcnt lgkmcnt(10)
    v_mfma_f32_16x16x32_bf16 v[232:235], v[72:75], v[104:107], v[232:235]
    ds_read_b128 v[140:143], v7 offset:2688
    s_waitcnt lgkmcnt(10)
    v_mfma_f32_16x16x32_bf16 v[236:239], v[72:75], v[108:111], v[236:239]
    ds_read_b128 v[144:147], v7 offset:3200
    s_waitcnt lgkmcnt(9)
    v_mfma_f32_16x16x32_bf16 v[212:215], v[76:79], v[80:83], v[212:215]
    ds_read_b128 v[148:151], v7 offset:3712
    v_mfma_f32_16x16x32_bf16 v[216:219], v[76:79], v[84:87], v[216:219]
    ds_read2_b32 v[116:117], v68 offset0:32 offset1:33
    v_mfma_f32_16x16x32_bf16 v[220:223], v[76:79], v[88:91], v[220:223]
    ds_read2_b32 v[118:119], v68 offset0:34 offset1:35
    v_mfma_f32_16x16x32_bf16 v[224:227], v[76:79], v[92:95], v[224:227]
    v_mfma_f32_16x16x32_bf16 v[228:231], v[76:79], v[96:99], v[228:231]
    v_mfma_f32_16x16x32_bf16 v[232:235], v[76:79], v[100:103], v[232:235]
    v_mfma_f32_16x16x32_bf16 v[236:239], v[76:79], v[104:107], v[236:239]
    ds_read2_b32 v[72:73], v68 offset0:144 offset1:145
    s_waitcnt lgkmcnt(10)
    v_mfma_f32_16x16x32_bf16 v[208:211], v[112:115], v[120:123], v[208:211]
    ds_read2_b32 v[74:75], v68 offset0:146 offset1:147
    s_waitcnt lgkmcnt(10)
    v_mfma_f32_16x16x32_bf16 v[212:215], v[112:115], v[124:127], v[212:215]
    ds_read_b128 v[80:83], v7 offset:64
    s_waitcnt lgkmcnt(10)
    v_mfma_f32_16x16x32_bf16 v[216:219], v[112:115], v[128:131], v[216:219]
    ds_read_b128 v[84:87], v7 offset:576
    s_waitcnt lgkmcnt(10)
    v_mfma_f32_16x16x32_bf16 v[220:223], v[112:115], v[132:135], v[220:223]
    ds_read_b128 v[88:91], v7 offset:1088
    s_waitcnt lgkmcnt(10)
    v_mfma_f32_16x16x32_bf16 v[224:227], v[112:115], v[136:139], v[224:227]
    ds_read_b128 v[92:95], v7 offset:1600
    s_waitcnt lgkmcnt(10)
    v_mfma_f32_16x16x32_bf16 v[228:231], v[112:115], v[140:143], v[228:231]
    ds_read_b128 v[96:99], v7 offset:2112
    s_waitcnt lgkmcnt(10)
    v_mfma_f32_16x16x32_bf16 v[232:235], v[112:115], v[144:147], v[232:235]
    ds_read_b128 v[100:103], v7 offset:2624
    s_waitcnt lgkmcnt(10)
    v_mfma_f32_16x16x32_bf16 v[236:239], v[112:115], v[148:151], v[236:239]
    ds_read_b128 v[104:107], v7 offset:3136
    s_waitcnt lgkmcnt(9)
    v_mfma_f32_16x16x32_bf16 v[212:215], v[116:119], v[120:123], v[212:215]
    ds_read_b128 v[108:111], v7 offset:3648
    v_mfma_f32_16x16x32_bf16 v[216:219], v[116:119], v[124:127], v[216:219]
    ds_read2_b32 v[76:77], v68 offset0:16 offset1:17
    v_mfma_f32_16x16x32_bf16 v[220:223], v[116:119], v[128:131], v[220:223]
    ds_read2_b32 v[78:79], v68 offset0:18 offset1:19
    v_mfma_f32_16x16x32_bf16 v[224:227], v[116:119], v[132:135], v[224:227]
    v_mfma_f32_16x16x32_bf16 v[228:231], v[116:119], v[136:139], v[228:231]
    v_mfma_f32_16x16x32_bf16 v[232:235], v[116:119], v[140:143], v[232:235]
    v_mfma_f32_16x16x32_bf16 v[236:239], v[116:119], v[144:147], v[236:239]
    ds_read2_b32 v[112:113], v68 offset0:128 offset1:129
    s_waitcnt lgkmcnt(10)
    v_mfma_f32_16x16x32_bf16 v[208:211], v[72:75], v[80:83], v[208:211]
    ds_read2_b32 v[114:115], v68 offset0:130 offset1:131
    s_waitcnt lgkmcnt(10)
    v_mfma_f32_16x16x32_bf16 v[212:215], v[72:75], v[84:87], v[212:215]
    ds_read_b128 v[120:123], v7 offset:0
    s_waitcnt lgkmcnt(10)
    v_mfma_f32_16x16x32_bf16 v[216:219], v[72:75], v[88:91], v[216:219]
    ds_read_b128 v[124:127], v7 offset:512
    s_waitcnt lgkmcnt(10)
    v_mfma_f32_16x16x32_bf16 v[220:223], v[72:75], v[92:95], v[220:223]
    ds_read_b128 v[128:131], v7 offset:1024
    s_waitcnt lgkmcnt(10)
    v_mfma_f32_16x16x32_bf16 v[224:227], v[72:75], v[96:99], v[224:227]
    ds_read_b128 v[132:135], v7 offset:1536
    s_waitcnt lgkmcnt(10)
    v_mfma_f32_16x16x32_bf16 v[228:231], v[72:75], v[100:103], v[228:231]
    ds_read_b128 v[136:139], v7 offset:2048
    s_waitcnt lgkmcnt(10)
    v_mfma_f32_16x16x32_bf16 v[232:235], v[72:75], v[104:107], v[232:235]
    ds_read_b128 v[140:143], v7 offset:2560
    s_waitcnt lgkmcnt(10)
    v_mfma_f32_16x16x32_bf16 v[236:239], v[72:75], v[108:111], v[236:239]
    ds_read_b128 v[144:147], v7 offset:3072
    s_waitcnt lgkmcnt(9)
    v_mfma_f32_16x16x32_bf16 v[212:215], v[76:79], v[80:83], v[212:215]
    ds_read_b128 v[148:151], v7 offset:3584
    v_mfma_f32_16x16x32_bf16 v[216:219], v[76:79], v[84:87], v[216:219]
    ds_read2_b32 v[116:117], v68 offset0:0 offset1:1
    v_mfma_f32_16x16x32_bf16 v[220:223], v[76:79], v[88:91], v[220:223]
    ds_read2_b32 v[118:119], v68 offset0:2 offset1:3
    v_mfma_f32_16x16x32_bf16 v[224:227], v[76:79], v[92:95], v[224:227]
    v_mfma_f32_16x16x32_bf16 v[228:231], v[76:79], v[96:99], v[228:231]
    v_mfma_f32_16x16x32_bf16 v[232:235], v[76:79], v[100:103], v[232:235]
    v_mfma_f32_16x16x32_bf16 v[236:239], v[76:79], v[104:107], v[236:239]
    s_waitcnt lgkmcnt(9)
    v_mfma_f32_16x16x32_bf16 v[208:211], v[112:115], v[120:123], v[208:211]
    s_waitcnt lgkmcnt(8)
    v_mfma_f32_16x16x32_bf16 v[212:215], v[112:115], v[124:127], v[212:215]
    s_waitcnt lgkmcnt(7)
    v_mfma_f32_16x16x32_bf16 v[216:219], v[112:115], v[128:131], v[216:219]
    s_waitcnt lgkmcnt(6)
    v_mfma_f32_16x16x32_bf16 v[220:223], v[112:115], v[132:135], v[220:223]
    s_waitcnt lgkmcnt(5)
    v_mfma_f32_16x16x32_bf16 v[224:227], v[112:115], v[136:139], v[224:227]
    s_waitcnt lgkmcnt(4)
    v_mfma_f32_16x16x32_bf16 v[228:231], v[112:115], v[140:143], v[228:231]
    s_waitcnt lgkmcnt(3)
    v_mfma_f32_16x16x32_bf16 v[232:235], v[112:115], v[144:147], v[232:235]
    s_waitcnt lgkmcnt(2)
    v_mfma_f32_16x16x32_bf16 v[236:239], v[112:115], v[148:151], v[236:239]
    s_waitcnt lgkmcnt(0)
    v_mfma_f32_16x16x32_bf16 v[212:215], v[116:119], v[120:123], v[212:215]
    v_mfma_f32_16x16x32_bf16 v[216:219], v[116:119], v[124:127], v[216:219]
    v_mfma_f32_16x16x32_bf16 v[220:223], v[116:119], v[128:131], v[220:223]
    v_mfma_f32_16x16x32_bf16 v[224:227], v[116:119], v[132:135], v[224:227]
    v_mfma_f32_16x16x32_bf16 v[228:231], v[116:119], v[136:139], v[228:231]
    v_mfma_f32_16x16x32_bf16 v[232:235], v[116:119], v[140:143], v[232:235]
    v_mfma_f32_16x16x32_bf16 v[236:239], v[116:119], v[144:147], v[236:239]
    s_and_b32 s33, s58, 3
    s_cbranch_scc1 CV_post
    s_cmp_lt_u32 s2, 32
    s_cselect_b32 s33, 0x1c3b8, 0
    s_add_u32 s33, s33, 0xbc40
    v_mov_b32 v5, s33
    s_lshl_b32 s33, 1, s3
    v_mov_b32 v6, s33
    s_mov_b64 exec, 1
    ds_add_u32 v5, v6
    s_mov_b64 exec, -1
    s_cmp_lt_u32 s2, 32
    s_cselect_b32 s33, 0x1c3dc, 0
    s_add_u32 s33, s33, 0xbc20
    v_mov_b32 v5, s33
    s_mov_b32 s53, 0
LS_20:
    ds_read_b32 v6, v5
    s_waitcnt lgkmcnt(0)
    v_readfirstlane_b32 s54, v6
    s_nop 0
    s_cmp_ge_u32 s54, 1
    s_cbranch_scc1 LD_21
    s_add_u32 s53, s53, 1
    s_cmp_gt_u32 s53, 3200000
    s_cbranch_scc1 LD_21
    s_sleep 1
    s_branch LS_20
LD_21:
CV_post:
    v_cvt_pk_bf16_f32 v16, v208, v209
    v_cvt_pk_bf16_f32 v17, v210, v211
    v_cvt_pk_bf16_f32 v18, v212, v213
    v_cvt_pk_bf16_f32 v19, v214, v215
    v_cvt_pk_bf16_f32 v20, v216, v217
    v_cvt_pk_bf16_f32 v21, v218, v219
    v_cvt_pk_bf16_f32 v22, v220, v221
    v_cvt_pk_bf16_f32 v23, v222, v223
    v_cvt_pk_bf16_f32 v24, v224, v225
    v_cvt_pk_bf16_f32 v25, v226, v227
    v_cvt_pk_bf16_f32 v26, v228, v229
    v_cvt_pk_bf16_f32 v27, v230, v231
    v_cvt_pk_bf16_f32 v28, v232, v233
    v_cvt_pk_bf16_f32 v29, v234, v235
    v_cvt_pk_bf16_f32 v30, v236, v237
    v_cvt_pk_bf16_f32 v31, v238, v239
    v_permlane16_swap_b32 v16, v18
    v_permlane16_swap_b32 v17, v19
    buffer_store_dwordx4 v[16:19], v15, s[28:31], s32 offen offset:0 sc1
    v_permlane16_swap_b32 v20, v22
    v_permlane16_swap_b32 v21, v23
    buffer_store_dwordx4 v[20:23], v15, s[28:31], s32 offen offset:1024 sc1
    v_permlane16_swap_b32 v24, v26
    v_permlane16_swap_b32 v25, v27
    buffer_store_dwordx4 v[24:27], v15, s[28:31], s32 offen offset:2048 sc1
    v_permlane16_swap_b32 v28, v30
    v_permlane16_swap_b32 v29, v31
    buffer_store_dwordx4 v[28:31], v15, s[28:31], s32 offen offset:3072 sc1
    s_cmp_eq_u32 s58, 1
    s_cbranch_scc1 CV_help
    s_cmp_lg_u32 s58, 2
    s_cbranch_scc1 FIN7
    s_add_u32 s49, s49, 2
    s_mov_b32 s58, 4
    s_movk_i32 s32, 1280
    v_add_u32 v37, 0, v1
    v_mul_u32_u24 v38, 205, v37
    v_lshrrev_b32 v38, 11, v38
    v_mul_u32_u24 v32, 10, v38
    v_sub_u32 v37, v37, v32
    v_lshlrev_b32 v37, 4, v37
    v_mad_u32_u24 v32, v38, s32, v37
    v_add_u32 v37, 64, v1
    v_mul_u32_u24 v38, 205, v37
    v_lshrrev_b32 v38, 11, v38
    v_mul_u32_u24 v33, 10, v38
    v_sub_u32 v37, v37, v33
    v_lshlrev_b32 v37, 4, v37
    v_mad_u32_u24 v33, v38, s32, v37
    v_add_u32 v37, 128, v1
    v_mul_u32_u24 v38, 205, v37
    v_lshrrev_b32 v38, 11, v38
    v_mul_u32_u24 v34, 10, v38
    v_sub_u32 v37, v37, v34
    v_lshlrev_b32 v37, 4, v37
    v_mad_u32_u24 v34, v38, s32, v37
    v_add_u32 v37, 192, v1
    v_mul_u32_u24 v38, 205, v37
    v_lshrrev_b32 v38, 11, v38
    v_mul_u32_u24 v35, 10, v38
    v_sub_u32 v37, v37, v35
    v_lshlrev_b32 v37, 4, v37
    v_mad_u32_u24 v35, v38, s32, v37
    v_add_u32 v37, 256, v1
    v_mul_u32_u24 v38, 205, v37
    v_lshrrev_b32 v38, 11, v38
    v_mul_u32_u24 v36, 10, v38
    v_sub_u32 v37, v37, v36
    v_lshlrev_b32 v37, 4, v37
    v_mad_u32_u24 v36, v38, s32, v37
    s_mov_b32 s8, s60
    s_mov_b32 s9, s61
    s_mov_b32 s10, 0x280000
    s_mov_b32 s11, 0x20000
    s_lshl_b32 s32, s47, 1
    s_and_b32 s33, s3, 1
    s_add_u32 s32, s32, s33
    s_mul_i32 s32, s32, 40960
    s_mul_i32 s33, s48, 160
    s_add_u32 s32, s32, s33
    s_add_u32 m0, s44, 0
    s_nop 0
    buffer_load_dwordx4 v32, s[8:11], s32 offen lds
    s_add_u32 m0, s44, 1024
    s_nop 0
    buffer_load_dwordx4 v33, s[8:11], s32 offen lds
    s_add_u32 m0, s44, 2048
    s_nop 0
    buffer_load_dwordx4 v34, s[8:11], s32 offen lds
    s_add_u32 m0, s44, 3072
    s_nop 0
    buffer_load_dwordx4 v35, s[8:11], s32 offen lds
    s_add_u32 m0, s44, 4096
    s_nop 0
    buffer_load_dwordx4 v36, s[8:11], s32 offen lds
    s_lshl_b32 s33, s48, 3
    s_mov_b32 s40, 0xe2d6cbc0
    s_mov_b32 s41, 0xf2e5e0ed
    s_lshr_b64 s[40:41], s[40:41], s33
    s_and_b32 s32, s40, 0xff
    v_add_u32 v13, s32, v1
    s_mov_b32 s40, 0xede2d6cb
    s_mov_b32 s41, 0xfff2fff9
    s_lshr_b64 s[40:41], s[40:41], s33
    s_and_b32 s32, s40, 0xff
    v_min_u32 v13, s32, v13
    v_lshlrev_b32 v13, 7, v13
    v_add_u32 v13, 126976, v13
    s_bitcmp0_b32 s3, 0
    s_cbranch_scc1 CV_np
    buffer_load_dwordx2 v[8:9], v13, s[4:7], 0 offen offset:0 sc1
CV_np:
    s_add_u32 s36, s44, 12928
    v_mov_b32 v40, 0
    v_mov_b32 v41, 0
    v_lshlrev_b32 v42, 3, v1
    v_add_u32 v42, s37, v42
    ds_write_b64 v42, v[40:41]
    v_and_b32 v2, 15, v1
    v_lshrrev_b32 v3, 4, v1
    v_lshlrev_b32 v15, 5, v2
    v_lshl_add_u32 v7, v3, 4, v15
    s_add_u32 s33, s37, 32
    v_add_u32 v7, s33, v7
    v_and_b32 v44, 1, v1
    v_mul_u32_u24 v4, 4160, v44
    v_lshlrev_b32 v68, 4, v3
    v_sub_u32 v68, v68, v4
    v_add_u32 v4, 1, v2
    v_lshrrev_b32 v4, 1, v4
    v_lshlrev_b32 v4, 2, v4
    v_sub_u32 v68, v68, v4
    s_add_u32 s33, s36, 7264
    v_add_u32 v68, s33, v68
    v_subrev_u32 v69, 576, v68
    v_lshlrev_b32 v4, 2, v3
    v_sub_u32 v4, v4, v2
    s_add_u32 s33, s36, 2108
    v_lshl_add_u32 v70, v4, 2, s33
    v_lshrrev_b32 v4, 2, v2
    v_lshlrev_b32 v15, 7, v4
    v_and_b32 v4, 3, v2
    v_lshl_add_u32 v15, v4, 4, v15
    v_lshrrev_b32 v4, 1, v3
    v_lshl_add_u32 v15, v4, 6, v15
    v_and_b32 v4, 1, v3
    v_lshl_add_u32 v15, v4, 9, v15
    v_lshlrev_b32 v4, 3, v3
    v_sub_u32 v4, v2, v4
    v_add_u32 v4, 16, v4
    v_ashrrev_i32 v4, 1, v4
    v_lshlrev_b32 v44, 4, v44
    s_waitcnt vmcnt(9)
    v_lshlrev_b32 v44, v44, v206
    v_cmp_eq_u32 vcc, 0, v4
    s_nop 1
    v_cndmask_b32 v40, 0, v44, vcc
    v_cmp_eq_u32 vcc, 1, v4
    s_nop 1
    v_cndmask_b32 v41, 0, v44, vcc
    v_cmp_eq_u32 vcc, 2, v4
    s_nop 1
    v_cndmask_b32 v42, 0, v44, vcc
    v_cmp_eq_u32 vcc, 3, v4
    s_nop 1
    v_cndmask_b32 v43, 0, v44, vcc
    v_mov_b32 v5, 163804
    s_mov_b32 s53, 0
LS_22:
    ds_read_b32 v6, v5
    s_waitcnt lgkmcnt(0)
    v_readfirstlane_b32 s54, v6
    s_nop 0
    s_cmp_ge_u32 s54, 6
    s_cbranch_scc1 LD_23
    s_add_u32 s53, s53, 1
    s_cmp_gt_u32 s53, 3200000
    s_cbranch_scc1 LD_23
    s_sleep 1
    s_branch LS_22
LD_23:
    v_mov_b32 v5, 163828
    s_mov_b32 s53, 0
LS_24:
    ds_read_b32 v6, v5
    s_waitcnt lgkmcnt(0)
    v_readfirstlane_b32 s54, v6
    s_nop 0
    s_cmp_ge_u32 s54, 2
    s_cbranch_scc1 LD_25
    s_add_u32 s53, s53, 1
    s_cmp_gt_u32 s53, 3200000
    s_cbranch_scc1 LD_25
    s_sleep 1
    s_branch LS_24
LD_25:
    s_branch CONV
CV_help:
    s_mul_i32 s34, s48, 276480
    s_add_u32 s34, s34, 0x900000
    s_add_u32 s20, s86, s34
    s_addc_u32 s21, s87, 0
    s_mov_b32 s22, 276480
    s_mov_b32 s23, 0x20000
    s_and_b32 s49, s3, 1
    s_and_b32 s62, s47, 3
    s_lshl_b32 s62, s62, 1
    s_add_u32 s62, s62, s48
    s_and_b32 s62, s62, 7
    s_mul_i32 s62, s62, 7
    s_add_u32 s62, s62, s49
    s_add_u32 s62, s62, 44
    s_cmp_ge_u32 s62, 54
    s_cselect_b32 s63, 54, 0
    s_sub_u32 s62, s62, s63
    s_mul_i32 s62, s62, 5120
    v_lshlrev_b32 v12, 4, v1
    v_add_u32 v13, 4096, v12
    s_and_b32 s36, s47, 3
    s_lshl_b32 s36, s36, 1
    s_add_u32 s36, s36, s48
    s_and_b32 s36, s36, 7
    s_mul_i32 s36, s36, 7
    s_lshl_b32 s33, s49, 1
    s_sub_u32 s36, s36, s33
    s_add_u32 s36, s36, 38
    s_waitcnt vmcnt(0)
    s_cmp_lt_u32 s2, 32
    s_cselect_b32 s33, 0x1c3bc, 0
    s_add_u32 s33, s33, 0xbc10
    s_cmp_lt_u32 s2, 32
    s_cselect_b32 s35, 0x4, 0
    s_add_u32 s35, s35, 0x1
    v_mov_b32 v46, s33
    v_mov_b32 v47, 1
    s_mov_b64 exec, 1
    ds_add_rtn_u32 v47, v46, v47
    s_cmp_lt_u32 s2, 32
    s_cselect_b32 s33, 0x7000, 0
    s_add_u32 s33, s33, 0x17000
    s_lshl_b32 s32, s46, 7
    s_add_u32 s33, s33, s32
    s_waitcnt lgkmcnt(0)
    v_readfirstlane_b32 s32, v47
    s_nop 0
    s_cmp_lg_u32 s32, s35
    s_cbranch_scc1 CF_26
    v_mov_b32 v44, s50
    v_mov_b32 v45, s51
    buffer_store_dwordx2 v[44:45], v10, s[4:7], s33 offen offset:0 sc1
CF_26:
    s_mov_b64 exec, -1
    v_mov_b32 v5, 163820
    s_mov_b32 s53, 0
LS_27:
    ds_read_b32 v6, v5
    s_waitcnt lgkmcnt(0)
    v_readfirstlane_b32 s54, v6
    s_nop 0
    s_cmp_ge_u32 s54, 1
    s_cbranch_scc1 LD_28
    s_add_u32 s53, s53, 1
    s_cmp_gt_u32 s53, 3200000
    s_cbranch_scc1 LD_28
    s_sleep 1
    s_branch LS_27
LD_28:
    s_add_u32 s33, s36, 0
    s_cmp_ge_u32 s33, 54
    s_cselect_b32 s32, 54, 0
    s_sub_u32 s33, s33, s32
    s_mul_i32 s33, s33, 5120
    s_add_u32 m0, s44, 0
    s_nop 0
    buffer_load_dwordx4 v12, s[20:23], s33 offen offset:0 sc1 lds
    buffer_load_dwordx4 v12, s[20:23], s33 offen offset:1024 sc1 lds
    buffer_load_dwordx4 v12, s[20:23], s33 offen offset:2048 sc1 lds
    buffer_load_dwordx4 v12, s[20:23], s33 offen offset:3072 sc1 lds
    s_add_u32 m0, s44, 4096
    s_nop 0
    buffer_load_dwordx4 v13, s[20:23], s33 offen sc1 lds
    s_add_u32 s33, s36, 1
    s_cmp_ge_u32 s33, 54
    s_cselect_b32 s32, 54, 0
    s_sub_u32 s33, s33, s32
    s_mul_i32 s33, s33, 5120
    s_add_u32 m0, s44, 5120
    s_nop 0
    buffer_load_dwordx4 v12, s[20:23], s33 offen offset:0 sc1 lds
    buffer_load_dwordx4 v12, s[20:23], s33 offen offset:1024 sc1 lds
    buffer_load_dwordx4 v12, s[20:23], s33 offen offset:2048 sc1 lds
    buffer_load_dwordx4 v12, s[20:23], s33 offen offset:3072 sc1 lds
    s_add_u32 m0, s44, 9216
    s_nop 0
    buffer_load_dwordx4 v13, s[20:23], s33 offen sc1 lds
    buffer_load_dwordx4 v[16:19], v12, s[20:23], s62 offen offset:0 sc1
    buffer_load_dwordx4 v[20:23], v12, s[20:23], s62 offen offset:1024 sc1
    buffer_load_dwordx4 v[24:27], v12, s[20:23], s62 offen offset:2048 sc1
    buffer_load_dwordx4 v[28:31], v12, s[20:23], s62 offen offset:3072 sc1
    buffer_load_dwordx4 v[32:35], v13, s[20:23], s62 offen sc1
    s_add_u32 s62, s62, 10240
    s_cmp_ge_u32 s62, 276480
    s_cselect_b32 s63, 276480, 0
    s_sub_u32 s62, s62, s63
    buffer_load_dwordx4 v[36:39], v12, s[20:23], s62 offen offset:0 sc1
    buffer_load_dwordx4 v[40:43], v12, s[20:23], s62 offen offset:1024 sc1
    buffer_load_dwordx4 v[44:47], v12, s[20:23], s62 offen offset:2048 sc1
    buffer_load_dwordx4 v[48:51], v12, s[20:23], s62 offen offset:3072 sc1
    buffer_load_dwordx4 v[52:55], v13, s[20:23], s62 offen sc1
    s_add_u32 s62, s62, 10240
    s_cmp_ge_u32 s62, 276480
    s_cselect_b32 s63, 276480, 0
    s_sub_u32 s62, s62, s63
    buffer_load_dwordx4 v[56:59], v12, s[20:23], s62 offen offset:0 sc1
    buffer_load_dwordx4 v[60:63], v12, s[20:23], s62 offen offset:1024 sc1
    buffer_load_dwordx4 v[64:67], v12, s[20:23], s62 offen offset:2048 sc1
    buffer_load_dwordx4 v[68:71], v12, s[20:23], s62 offen offset:3072 sc1
    buffer_load_dwordx4 v[72:75], v13, s[20:23], s62 offen sc1
    s_add_u32 s62, s62, 10240
    s_cmp_ge_u32 s62, 276480
    s_cselect_b32 s63, 276480, 0
    s_sub_u32 s62, s62, s63
    buffer_load_dwordx4 v[76:79], v12, s[20:23], s62 offen offset:0 sc1
    buffer_load_dwordx4 v[80:83], v12, s[20:23], s62 offen offset:1024 sc1
    buffer_load_dwordx4 v[84:87], v12, s[20:23], s62 offen offset:2048 sc1
    buffer_load_dwordx4 v[88:91], v12, s[20:23], s62 offen offset:3072 sc1
    buffer_load_dwordx4 v[92:95], v13, s[20:23], s62 offen sc1
    s_add_u32 s62, s62, 10240
    s_cmp_ge_u32 s62, 276480
    s_cselect_b32 s63, 276480, 0
    s_sub_u32 s62, s62, s63
    buffer_load_dwordx4 v[96:99], v12, s[20:23], s62 offen offset:0 sc1
    buffer_load_dwordx4 v[100:103], v12, s[20:23], s62 offen offset:1024 sc1
    buffer_load_dwordx4 v[104:107], v12, s[20:23], s62 offen offset:2048 sc1
    buffer_load_dwordx4 v[108:111], v12, s[20:23], s62 offen offset:3072 sc1
    buffer_load_dwordx4 v[112:115], v13, s[20:23], s62 offen sc1
    s_add_u32 s62, s62, 10240
    s_cmp_ge_u32 s62, 276480
    s_cselect_b32 s63, 276480, 0
    s_sub_u32 s62, s62, s63
    s_waitcnt vmcnt(25)
    v_mov_b32 v5, 163784
    v_mov_b32 v6, 1
    s_waitcnt lgkmcnt(0)
    s_mov_b64 exec, 1
    ds_add_u32 v5, v6
    s_mov_b64 exec, -1
    v_mov_b32 v3, 163792
    s_branch G2H
KGEN:
    s_sub_u32 s35, s3, 6
    s_lshl_b32 s34, s35, 13
    s_add_u32 s34, s34, 147456
    v_lshlrev_b32 v208, 3, v1
    v_xor_b32 v209, 16, v208
    v_xor_b32 v210, 32, v208
    v_xor_b32 v211, 48, v208
    v_xor_b32 v212, 64, v208
    v_xor_b32 v213, 80, v208
    v_xor_b32 v214, 96, v208
    v_xor_b32 v215, 112, v208
    v_xor_b32 v216, 128, v208
    v_xor_b32 v217, 144, v208
    v_xor_b32 v218, 160, v208
    v_xor_b32 v219, 176, v208
    v_xor_b32 v220, 192, v208
    v_xor_b32 v221, 208, v208
    v_xor_b32 v222, 224, v208
    v_xor_b32 v223, 240, v208
    v_add_u32 v208, s34, v208
    v_add_u32 v209, s34, v209
    v_add_u32 v210, s34, v210
    v_add_u32 v211, s34, v211
    v_add_u32 v212, s34, v212
    v_add_u32 v213, s34, v213
    v_add_u32 v214, s34, v214
    v_add_u32 v215, s34, v215
    v_add_u32 v216, s34, v216
    v_add_u32 v217, s34, v217
    v_add_u32 v218, s34, v218
    v_add_u32 v219, s34, v219
    v_add_u32 v220, s34, v220
    v_add_u32 v221, s34, v221
    v_add_u32 v222, s34, v222
    v_add_u32 v223, s34, v223
    v_and_b32 v2, 15, v1
    v_lshrrev_b32 v3, 5, v1
    v_xor_b32 v3, v3, v2
    v_lshlrev_b32 v3, 4, v3
    v_lshl_add_u32 v224, v2, 9, v3
    v_xor_b32 v225, 32, v224
    v_xor_b32 v226, 64, v224
    v_xor_b32 v227, 96, v224
    v_xor_b32 v228, 128, v224
    v_xor_b32 v229, 160, v224
    v_xor_b32 v230, 192, v224
    v_xor_b32 v231, 224, v224
    v_add_u32 v224, s34, v224
    v_add_u32 v225, s34, v225
    v_add_u32 v226, s34, v226
    v_add_u32 v227, s34, v227
    v_add_u32 v228, s34, v228
    v_add_u32 v229, s34, v229
    v_add_u32 v230, s34, v230
    v_add_u32 v231, s34, v231
    s_mov_b32 s36, 0x3fb8aa3b
    s_mov_b32 s37, 0x32a57060
    s_mov_b32 s38, 0x3f317218
    s_mov_b32 s39, 0x31dc9c88
    s_lshl_b32 s49, s46, 1
    s_add_u32 s49, s49, s35
    s_lshl_b32 s56, s45, 4
    s_add_u32 s56, s56, s44
    s_lshl_b32 s56, s56, 7
    s_waitcnt lgkmcnt(0)
    s_mov_b32 s28, s62
    s_mov_b32 s29, s63
    s_mov_b32 s30, 0x28000
    s_mov_b32 s31, 0x20000
    s_mov_b32 s8, s64
    s_mov_b32 s9, s65
    s_mov_b32 s10, 0x28000
    s_mov_b32 s11, 0x20000
    s_mov_b32 s12, s66
    s_mov_b32 s13, s67
    s_mov_b32 s14, 0x28000
    s_mov_b32 s15, 0x20000
    s_mov_b32 s16, s68
    s_mov_b32 s17, s69
    s_mov_b32 s18, 0x28000
    s_mov_b32 s19, 0x20000
    s_mov_b32 s24, s70
    s_mov_b32 s25, s71
    s_mov_b32 s26, 0x500
    s_mov_b32 s27, 0x20000
    v_lshlrev_b32 v2, 2, v1
    s_lshl_b32 s32, s49, 8
    s_lshl_b32 s33, s49, 1
    v_mov_b32 v11, 0
    buffer_load_ushort v9, v11, s[24:27], s33 offen
    buffer_load_dword v5, v2, s[28:31], s32 offen nt
    buffer_load_dword v6, v2, s[8:11], s32 offen nt
    buffer_load_dword v7, v2, s[12:15], s32 offen nt
    buffer_load_dword v8, v2, s[16:19], s32 offen nt
    s_mov_b32 s70, s34
    s_mul_i32 s34, s35, 21504
    s_add_u32 s44, s34, 100352
    s_lshl_b32 s57, s35, 13
    s_sub_u32 s57, s44, s57
    s_sub_u32 s57, s57, 142848
    s_add_u32 s34, s44, 4608
    s_mov_b32 s58, 0
    v_mov_b32 v200, 0
    v_mov_b32 v201, 0
    v_mov_b32 v205, 0
    s_add_u32 s24, s86, 0x1400000
    s_addc_u32 s25, s87, 0
    s_mov_b32 s26, 0x280000
    s_mov_b32 s27, 0x20000
    v_lshlrev_b32 v204, 4, v1
    s_lshl_b32 s71, s46, 13
    s_mov_b32 s20, s84
    s_mov_b32 s21, s85
    s_mov_b32 s22, 0x100
    s_mov_b32 s23, 0x20000
    s_add_u32 s4, s86, 0x1800000
    s_addc_u32 s5, s87, 0
    s_mov_b32 s6, 0x4b000
    s_mov_b32 s7, 0x20000
    s_waitcnt vmcnt(0)
    v_lshlrev_b32 v9, 16, v9
    v_mul_f32 v11, s36, v9
    v_fma_f32 v12, v9, s36, -v11
    v_fma_f32 v12, v9, s37, v12
    v_exp_f32 v11, v11
    v_mul_f32 v12, s38, v12
    v_fma_f32 v10, v11, v12, v11
    v_cvt_pk_bf16_f32 v10, v10, v10
    v_and_b32 v10, 0xffff0000, v10
    v_lshlrev_b32 v60, 16, v5
    v_and_b32 v61, 0xffff0000, v5
    v_lshlrev_b32 v62, 16, v6
    v_and_b32 v63, 0xffff0000, v6
    v_mul_f32 v11, s36, v60
    v_fma_f32 v12, v60, s36, -v11
    v_fma_f32 v12, v60, s37, v12
    v_exp_f32 v11, v11
    v_mul_f32 v12, s38, v12
    v_fma_f32 v60, v11, v12, v11
    v_cvt_pk_bf16_f32 v60, v60, v60
    v_and_b32 v60, 0xffff0000, v60
    v_mul_f32_e64 v60, -v60, v10
    v_mul_f32 v62, v62, v10
    v_mul_f32 v11, s36, v61
    v_fma_f32 v12, v61, s36, -v11
    v_fma_f32 v12, v61, s37, v12
    v_exp_f32 v11, v11
    v_mul_f32 v12, s38, v12
    v_fma_f32 v61, v11, v12, v11
    v_cvt_pk_bf16_f32 v61, v61, v61
    v_and_b32 v61, 0xffff0000, v61
    v_mul_f32_e64 v61, -v61, v10
    v_mul_f32 v63, v63, v10
    s_mov_b32 s40, 0x4138aa3b
    s_mov_b32 s41, 0x41000000
    v_mul_f32 v52, s40, v60
    v_mul_f32 v54, s40, v61
    v_mul_f32 v56, s41, v62
    v_mul_f32 v58, s41, v63
    v_exp_f32 v52, v52
    v_exp_f32 v54, v54
    v_mul_f32 v57, 0.15915494, v56
    v_mul_f32 v59, 0.15915494, v58
    v_fma_f32 v53, v56, 0.15915494, -v57
    v_fma_f32 v55, v58, 0.15915494, -v59
    v_fma_f32 v53, v56, s39, v53
    v_fma_f32 v55, v58, s39, v55
    v_fract_f32 v57, v57
    v_fract_f32 v59, v59
    v_add_f32 v57, v57, v53
    v_add_f32 v59, v59, v55
    v_cos_f32 v20, v57
    v_cos_f32 v22, v59
    v_sin_f32 v21, v57
    v_sin_f32 v23, v59
    v_mul_f32 v20, v20, v52
    v_mul_f32 v22, v22, v54
    v_mul_f32 v21, v21, v52
    v_mul_f32 v23, v23, v54
    s_mov_b32 s40, 0x3fb8aa3b
    s_mov_b32 s41, 0x3f800000
    v_mul_f32 v52, s40, v60
    v_mul_f32 v54, s40, v61
    v_mul_f32 v56, s41, v62
    v_mul_f32 v58, s41, v63
    v_exp_f32 v52, v52
    v_exp_f32 v54, v54
    v_mul_f32 v57, 0.15915494, v56
    v_mul_f32 v59, 0.15915494, v58
    v_fma_f32 v53, v56, 0.15915494, -v57
    v_fma_f32 v55, v58, 0.15915494, -v59
    v_fma_f32 v53, v56, s39, v53
    v_fma_f32 v55, v58, s39, v55
    v_fract_f32 v57, v57
    v_fract_f32 v59, v59
    v_add_f32 v57, v57, v53
    v_add_f32 v59, v59, v55
    v_cos_f32 v16, v57
    v_cos_f32 v18, v59
    v_sin_f32 v17, v57
    v_sin_f32 v19, v59
    v_mul_f32 v16, v16, v52
    v_mul_f32 v18, v18, v54
    v_mul_f32 v17, v17, v52
    v_mul_f32 v19, v19, v54
    s_mov_b32 s40, 0x43b8aa3b
    s_mov_b32 s41, 0x43800000
    v_mul_f32 v52, s40, v60
    v_mul_f32 v54, s40, v61
    v_mul_f32 v56, s41, v62
    v_mul_f32 v58, s41, v63
    v_exp_f32 v52, v52
    v_exp_f32 v54, v54
    v_mul_f32 v57, 0.15915494, v56
    v_mul_f32 v59, 0.15915494, v58
    v_fma_f32 v53, v56, 0.15915494, -v57
    v_fma_f32 v55, v58, 0.15915494, -v59
    v_fma_f32 v53, v56, s39, v53
    v_fma_f32 v55, v58, s39, v55
    v_fract_f32 v57, v57
    v_fract_f32 v59, v59
    v_add_f32 v57, v57, v53
    v_add_f32 v59, v59, v55
    v_cos_f32 v24, v57
    v_cos_f32 v26, v59
    v_sin_f32 v25, v57
    v_sin_f32 v27, v59
    v_mul_f32 v24, v24, v52
    v_mul_f32 v26, v26, v54
    v_mul_f32 v25, v25, v52
    v_mul_f32 v27, v27, v54
    v_mov_b32 v70, 0x3c00
    v_mov_b32 v71, 0x3c00
    ds_write_b64 v208, v[70:71]
    v_cvt_pk_f16_f32 v232, v20, v21
    v_cvt_pk_f16_f32 v233, v22, v23
    ds_write_b64 v209, v[232:233] offset:512
    v_mul_f32 v28, v20, v20
    v_mul_f32 v29, v21, v20
    v_mul_f32 v30, v22, v22
    v_mul_f32 v31, v23, v22
    v_fma_f32 v28, -v21, v21, v28
    v_fmac_f32 v29, v20, v21
    v_fma_f32 v30, -v23, v23, v30
    v_fmac_f32 v31, v22, v23
    v_cvt_pk_f16_f32 v234, v28, v29
    v_cvt_pk_f16_f32 v235, v30, v31
    ds_write_b64 v210, v[234:235] offset:1024
    v_mul_f32 v44, v28, v20
    v_mul_f32 v45, v29, v20
    v_mul_f32 v46, v30, v22
    v_mul_f32 v47, v31, v22
    v_fma_f32 v44, -v29, v21, v44
    v_fmac_f32 v45, v28, v21
    v_fma_f32 v46, -v31, v23, v46
    v_fmac_f32 v47, v30, v23
    v_cvt_pk_f16_f32 v236, v44, v45
    v_cvt_pk_f16_f32 v237, v46, v47
    ds_write_b64 v211, v[236:237] offset:1536
    v_mul_f32 v32, v28, v28
    v_mul_f32 v33, v29, v28
    v_mul_f32 v34, v30, v30
    v_mul_f32 v35, v31, v30
    v_fma_f32 v32, -v29, v29, v32
    v_fmac_f32 v33, v28, v29
    v_fma_f32 v34, -v31, v31, v34
    v_fmac_f32 v35, v30, v31
    v_cvt_pk_f16_f32 v250, v32, v33
    v_cvt_pk_f16_f32 v251, v34, v35
    ds_write_b64 v212, v[250:251] offset:2048
    v_pk_mul_f16 v64, v250, v232 op_sel_hi:[1,0]
    v_pk_mul_f16 v65, v251, v233 op_sel_hi:[1,0]
    v_pk_fma_f16 v64, v250, v232, v64 op_sel:[1,1,0] op_sel_hi:[0,1,1] neg_lo:[1,0,0]
    v_pk_fma_f16 v65, v251, v233, v65 op_sel:[1,1,0] op_sel_hi:[0,1,1] neg_lo:[1,0,0]
    ds_write_b64 v213, v[64:65] offset:2560
    v_pk_mul_f16 v66, v250, v234 op_sel_hi:[1,0]
    v_pk_mul_f16 v67, v251, v235 op_sel_hi:[1,0]
    v_pk_fma_f16 v66, v250, v234, v66 op_sel:[1,1,0] op_sel_hi:[0,1,1] neg_lo:[1,0,0]
    v_pk_fma_f16 v67, v251, v235, v67 op_sel:[1,1,0] op_sel_hi:[0,1,1] neg_lo:[1,0,0]
    ds_write_b64 v214, v[66:67] offset:3072
    v_pk_mul_f16 v68, v250, v236 op_sel_hi:[1,0]
    v_pk_mul_f16 v69, v251, v237 op_sel_hi:[1,0]
    v_pk_fma_f16 v68, v250, v236, v68 op_sel:[1,1,0] op_sel_hi:[0,1,1] neg_lo:[1,0,0]
    v_pk_fma_f16 v69, v251, v237, v69 op_sel:[1,1,0] op_sel_hi:[0,1,1] neg_lo:[1,0,0]
    ds_write_b64 v215, v[68:69] offset:3584
    s_barrier
    v_mul_f32 v44, v32, v32
    v_mul_f32 v45, v33, v32
    v_mul_f32 v46, v34, v34
    v_mul_f32 v47, v35, v34
    v_fma_f32 v44, -v33, v33, v44
    v_fmac_f32 v45, v32, v33
    v_fma_f32 v46, -v35, v35, v46
    v_fmac_f32 v47, v34, v35
    v_cvt_pk_f16_f32 v248, v44, v45
    v_cvt_pk_f16_f32 v249, v46, v47
    ds_write_b64 v216, v[248:249] offset:4096
    v_pk_mul_f16 v70, v248, v232 op_sel_hi:[1,0]
    v_pk_mul_f16 v71, v249, v233 op_sel_hi:[1,0]
    v_pk_fma_f16 v70, v248, v232, v70 op_sel:[1,1,0] op_sel_hi:[0,1,1] neg_lo:[1,0,0]
    v_pk_fma_f16 v71, v249, v233, v71 op_sel:[1,1,0] op_sel_hi:[0,1,1] neg_lo:[1,0,0]
    ds_write_b64 v217, v[70:71] offset:4608
    v_pk_mul_f16 v64, v248, v234 op_sel_hi:[1,0]
    v_pk_mul_f16 v65, v249, v235 op_sel_hi:[1,0]
    v_pk_fma_f16 v64, v248, v234, v64 op_sel:[1,1,0] op_sel_hi:[0,1,1] neg_lo:[1,0,0]
    v_pk_fma_f16 v65, v249, v235, v65 op_sel:[1,1,0] op_sel_hi:[0,1,1] neg_lo:[1,0,0]
    ds_write_b64 v218, v[64:65] offset:5120
    v_pk_mul_f16 v66, v248, v236 op_sel_hi:[1,0]
    v_pk_mul_f16 v67, v249, v237 op_sel_hi:[1,0]
    v_pk_fma_f16 v66, v248, v236, v66 op_sel:[1,1,0] op_sel_hi:[0,1,1] neg_lo:[1,0,0]
    v_pk_fma_f16 v67, v249, v237, v67 op_sel:[1,1,0] op_sel_hi:[0,1,1] neg_lo:[1,0,0]
    ds_write_b64 v219, v[66:67] offset:5632
    v_mul_f32 v48, v44, v32
    v_mul_f32 v49, v45, v32
    v_mul_f32 v50, v46, v34
    v_mul_f32 v51, v47, v34
    v_fma_f32 v48, -v45, v33, v48
    v_fmac_f32 v49, v44, v33
    v_fma_f32 v50, -v47, v35, v50
    v_fmac_f32 v51, v46, v35
    v_cvt_pk_f16_f32 v250, v48, v49
    v_cvt_pk_f16_f32 v251, v50, v51
    ds_write_b64 v220, v[250:251] offset:6144
    v_pk_mul_f16 v68, v250, v232 op_sel_hi:[1,0]
    v_pk_mul_f16 v69, v251, v233 op_sel_hi:[1,0]
    v_pk_fma_f16 v68, v250, v232, v68 op_sel:[1,1,0] op_sel_hi:[0,1,1] neg_lo:[1,0,0]
    v_pk_fma_f16 v69, v251, v233, v69 op_sel:[1,1,0] op_sel_hi:[0,1,1] neg_lo:[1,0,0]
    ds_write_b64 v221, v[68:69] offset:6656
    v_pk_mul_f16 v70, v250, v234 op_sel_hi:[1,0]
    v_pk_mul_f16 v71, v251, v235 op_sel_hi:[1,0]
    v_pk_fma_f16 v70, v250, v234, v70 op_sel:[1,1,0] op_sel_hi:[0,1,1] neg_lo:[1,0,0]
    v_pk_fma_f16 v71, v251, v235, v71 op_sel:[1,1,0] op_sel_hi:[0,1,1] neg_lo:[1,0,0]
    ds_write_b64 v222, v[70:71] offset:7168
    v_pk_mul_f16 v64, v250, v236 op_sel_hi:[1,0]
    v_pk_mul_f16 v65, v251, v237 op_sel_hi:[1,0]
    v_pk_fma_f16 v64, v250, v236, v64 op_sel:[1,1,0] op_sel_hi:[0,1,1] neg_lo:[1,0,0]
    v_pk_fma_f16 v65, v251, v237, v65 op_sel:[1,1,0] op_sel_hi:[0,1,1] neg_lo:[1,0,0]
    ds_write_b64 v223, v[64:65] offset:7680
    v_mul_f32 v44, v48, v32
    v_mul_f32 v45, v49, v32
    v_mul_f32 v46, v50, v34
    v_mul_f32 v47, v51, v34
    v_fma_f32 v44, -v49, v33, v44
    v_fmac_f32 v45, v48, v33
    v_fma_f32 v46, -v51, v35, v46
    v_fmac_f32 v47, v50, v35
    s_mov_b32 exec_lo, 0x0000ffff
    s_mov_b32 exec_hi, 0x0000ffff
    ds_read_b128 v[72:75], v224 offset:0
    ds_read_b128 v[76:79], v225 offset:0
    ds_read_b128 v[80:83], v226 offset:0
    ds_read_b128 v[84:87], v227 offset:0
    ds_read_b128 v[88:91], v228 offset:0
    ds_read_b128 v[92:95], v229 offset:0
    ds_read_b128 v[96:99], v230 offset:0
    ds_read_b128 v[100:103], v231 offset:0
    s_mov_b64 exec, -1
    s_mov_b32 exec_lo, 0x0000ffff
    s_mov_b32 exec_hi, 0x0000ffff
    ds_read_b128 v[104:107], v224 offset:256
    ds_read_b128 v[108:111], v225 offset:256
    ds_read_b128 v[112:115], v226 offset:256
    ds_read_b128 v[116:119], v227 offset:256
    ds_read_b128 v[120:123], v228 offset:256
    ds_read_b128 v[124:127], v229 offset:256
    ds_read_b128 v[128:131], v230 offset:256
    ds_read_b128 v[132:135], v231 offset:256
    s_mov_b64 exec, -1
    v_cvt_pk_f16_f32 v248, v44, v45
    v_cvt_pk_f16_f32 v249, v46, v47
    ds_write_b64 v208, v[248:249] offset:0
    v_pk_mul_f16 v66, v248, v232 op_sel_hi:[1,0]
    v_pk_mul_f16 v67, v249, v233 op_sel_hi:[1,0]
    v_pk_fma_f16 v66, v248, v232, v66 op_sel:[1,1,0] op_sel_hi:[0,1,1] neg_lo:[1,0,0]
    v_pk_fma_f16 v67, v249, v233, v67 op_sel:[1,1,0] op_sel_hi:[0,1,1] neg_lo:[1,0,0]
    ds_write_b64 v209, v[66:67] offset:512
    v_pk_mul_f16 v68, v248, v234 op_sel_hi:[1,0]
    v_pk_mul_f16 v69, v249, v235 op_sel_hi:[1,0]
    v_pk_fma_f16 v68, v248, v234, v68 op_sel:[1,1,0] op_sel_hi:[0,1,1] neg_lo:[1,0,0]
    v_pk_fma_f16 v69, v249, v235, v69 op_sel:[1,1,0] op_sel_hi:[0,1,1] neg_lo:[1,0,0]
    ds_write_b64 v210, v[68:69] offset:1024
    v_pk_mul_f16 v70, v248, v236 op_sel_hi:[1,0]
    v_pk_mul_f16 v71, v249, v237 op_sel_hi:[1,0]
    v_pk_fma_f16 v70, v248, v236, v70 op_sel:[1,1,0] op_sel_hi:[0,1,1] neg_lo:[1,0,0]
    v_pk_fma_f16 v71, v249, v237, v71 op_sel:[1,1,0] op_sel_hi:[0,1,1] neg_lo:[1,0,0]
    ds_write_b64 v211, v[70:71] offset:1536
    v_mul_f32 v48, v44, v32
    v_mul_f32 v49, v45, v32
    v_mul_f32 v50, v46, v34
    v_mul_f32 v51, v47, v34
    v_fma_f32 v48, -v45, v33, v48
    v_fmac_f32 v49, v44, v33
    v_fma_f32 v50, -v47, v35, v50
    v_fmac_f32 v51, v46, v35
    v_cvt_pk_f16_f32 v250, v48, v49
    v_cvt_pk_f16_f32 v251, v50, v51
    ds_write_b64 v212, v[250:251] offset:2048
    v_pk_mul_f16 v64, v250, v232 op_sel_hi:[1,0]
    v_pk_mul_f16 v65, v251, v233 op_sel_hi:[1,0]
    v_pk_fma_f16 v64, v250, v232, v64 op_sel:[1,1,0] op_sel_hi:[0,1,1] neg_lo:[1,0,0]
    v_pk_fma_f16 v65, v251, v233, v65 op_sel:[1,1,0] op_sel_hi:[0,1,1] neg_lo:[1,0,0]
    ds_write_b64 v213, v[64:65] offset:2560
    v_pk_mul_f16 v66, v250, v234 op_sel_hi:[1,0]
    v_pk_mul_f16 v67, v251, v235 op_sel_hi:[1,0]
    v_pk_fma_f16 v66, v250, v234, v66 op_sel:[1,1,0] op_sel_hi:[0,1,1] neg_lo:[1,0,0]
    v_pk_fma_f16 v67, v251, v235, v67 op_sel:[1,1,0] op_sel_hi:[0,1,1] neg_lo:[1,0,0]
    ds_write_b64 v214, v[66:67] offset:3072
    v_pk_mul_f16 v68, v250, v236 op_sel_hi:[1,0]
    v_pk_mul_f16 v69, v251, v237 op_sel_hi:[1,0]
    v_pk_fma_f16 v68, v250, v236, v68 op_sel:[1,1,0] op_sel_hi:[0,1,1] neg_lo:[1,0,0]
    v_pk_fma_f16 v69, v251, v237, v69 op_sel:[1,1,0] op_sel_hi:[0,1,1] neg_lo:[1,0,0]
    ds_write_b64 v215, v[68:69] offset:3584
    v_mul_f32 v44, v48, v32
    v_mul_f32 v45, v49, v32
    v_mul_f32 v46, v50, v34
    v_mul_f32 v47, v51, v34
    v_fma_f32 v44, -v49, v33, v44
    v_fmac_f32 v45, v48, v33
    v_fma_f32 v46, -v51, v35, v46
    v_fmac_f32 v47, v50, v35
    v_cvt_pk_f16_f32 v248, v44, v45
    v_cvt_pk_f16_f32 v249, v46, v47
    ds_write_b64 v216, v[248:249] offset:4096
    s_barrier
    buffer_load_dwordx2 v[206:207], v205, s[20:23], 0 offen sc1
    v_pk_mul_f16 v70, v248, v232 op_sel_hi:[1,0]
    v_pk_mul_f16 v71, v249, v233 op_sel_hi:[1,0]
    v_pk_fma_f16 v70, v248, v232, v70 op_sel:[1,1,0] op_sel_hi:[0,1,1] neg_lo:[1,0,0]
    v_pk_fma_f16 v71, v249, v233, v71 op_sel:[1,1,0] op_sel_hi:[0,1,1] neg_lo:[1,0,0]
    ds_write_b64 v217, v[70:71] offset:4608
    v_pk_mul_f16 v64, v248, v234 op_sel_hi:[1,0]
    v_pk_mul_f16 v65, v249, v235 op_sel_hi:[1,0]
    v_pk_fma_f16 v64, v248, v234, v64 op_sel:[1,1,0] op_sel_hi:[0,1,1] neg_lo:[1,0,0]
    v_pk_fma_f16 v65, v249, v235, v65 op_sel:[1,1,0] op_sel_hi:[0,1,1] neg_lo:[1,0,0]
    ds_write_b64 v218, v[64:65] offset:5120
    v_pk_mul_f16 v66, v248, v236 op_sel_hi:[1,0]
    v_pk_mul_f16 v67, v249, v237 op_sel_hi:[1,0]
    v_pk_fma_f16 v66, v248, v236, v66 op_sel:[1,1,0] op_sel_hi:[0,1,1] neg_lo:[1,0,0]
    v_pk_fma_f16 v67, v249, v237, v67 op_sel:[1,1,0] op_sel_hi:[0,1,1] neg_lo:[1,0,0]
    ds_write_b64 v219, v[66:67] offset:5632
    v_mul_f32 v48, v44, v32
    v_mul_f32 v49, v45, v32
    v_mul_f32 v50, v46, v34
    v_mul_f32 v51, v47, v34
    v_fma_f32 v48, -v45, v33, v48
    v_fmac_f32 v49, v44, v33
    v_fma_f32 v50, -v47, v35, v50
    v_fmac_f32 v51, v46, v35
    v_cvt_pk_f16_f32 v250, v48, v49
    v_cvt_pk_f16_f32 v251, v50, v51
    ds_write_b64 v220, v[250:251] offset:6144
    v_pk_mul_f16 v68, v250, v232 op_sel_hi:[1,0]
    v_pk_mul_f16 v69, v251, v233 op_sel_hi:[1,0]
    v_pk_fma_f16 v68, v250, v232, v68 op_sel:[1,1,0] op_sel_hi:[0,1,1] neg_lo:[1,0,0]
    v_pk_fma_f16 v69, v251, v233, v69 op_sel:[1,1,0] op_sel_hi:[0,1,1] neg_lo:[1,0,0]
    ds_write_b64 v221, v[68:69] offset:6656
    v_pk_mul_f16 v70, v250, v234 op_sel_hi:[1,0]
    v_pk_mul_f16 v71, v251, v235 op_sel_hi:[1,0]
    v_pk_fma_f16 v70, v250, v234, v70 op_sel:[1,1,0] op_sel_hi:[0,1,1] neg_lo:[1,0,0]
    v_pk_fma_f16 v71, v251, v235, v71 op_sel:[1,1,0] op_sel_hi:[0,1,1] neg_lo:[1,0,0]
    ds_write_b64 v222, v[70:71] offset:7168
    v_pk_mul_f16 v64, v250, v236 op_sel_hi:[1,0]
    v_pk_mul_f16 v65, v251, v237 op_sel_hi:[1,0]
    v_pk_fma_f16 v64, v250, v236, v64 op_sel:[1,1,0] op_sel_hi:[0,1,1] neg_lo:[1,0,0]
    v_pk_fma_f16 v65, v251, v237, v65 op_sel:[1,1,0] op_sel_hi:[0,1,1] neg_lo:[1,0,0]
    ds_write_b64 v223, v[64:65] offset:7680
    s_mov_b32 exec_lo, 0xffff0000
    s_mov_b32 exec_hi, 0xffff0000
    ds_read_b128 v[72:75], v224 offset:0
    ds_read_b128 v[76:79], v225 offset:0
    ds_read_b128 v[80:83], v226 offset:0
    ds_read_b128 v[84:87], v227 offset:0
    ds_read_b128 v[88:91], v228 offset:0
    ds_read_b128 v[92:95], v229 offset:0
    ds_read_b128 v[96:99], v230 offset:0
    ds_read_b128 v[100:103], v231 offset:0
    s_mov_b64 exec, -1
    s_mov_b32 exec_lo, 0xffff0000
    s_mov_b32 exec_hi, 0xffff0000
    ds_read_b128 v[104:107], v224 offset:256
    ds_read_b128 v[108:111], v225 offset:256
    ds_read_b128 v[112:115], v226 offset:256
    ds_read_b128 v[116:119], v227 offset:256
    ds_read_b128 v[120:123], v228 offset:256
    ds_read_b128 v[124:127], v229 offset:256
    ds_read_b128 v[128:131], v230 offset:256
    ds_read_b128 v[132:135], v231 offset:256
    s_mov_b64 exec, -1
    v_lshlrev_b32 v36, 16, v7
    v_and_b32 v38, 0xffff0000, v7
    v_lshlrev_b32 v37, 16, v8
    v_and_b32 v39, 0xffff0000, v8
    v_max_f32_e64 v11, abs(v36), abs(v37)
    v_max3_f32 v11, abs(v38), abs(v39), v11
    s_nop 1
    v_max_f32_dpp v11, v11, v11 row_ror:8 row_mask:0xf bank_mask:0xf
    s_nop 1
    v_max_f32_dpp v11, v11, v11 row_ror:4 row_mask:0xf bank_mask:0xf
    s_nop 1
    v_max_f32_dpp v11, v11, v11 row_ror:2 row_mask:0xf bank_mask:0xf
    s_nop 1
    v_max_f32_dpp v11, v11, v11 row_ror:1 row_mask:0xf bank_mask:0xf
    s_nop 0
    v_readlane_b32 s40, v11, 0
    v_readlane_b32 s41, v11, 16
    v_readlane_b32 s42, v11, 32
    v_readlane_b32 s43, v11, 48
    s_max_u32 s40, s40, s41
    s_max_u32 s42, s42, s43
    s_max_u32 s40, s40, s42
    s_lshr_b32 s40, s40, 23
    s_min_u32 s40, s40, 253
    s_sub_u32 s41, 254, s40
    s_lshl_b32 s41, s41, 23
    s_lshl_b32 s40, s40, 23
    v_mul_f32 v14, s40, v10
    v_add_f32 v14, v14, v14
    v_mul_f32 v36, s41, v36
    v_mul_f32 v37, s41, v37
    v_mul_f32 v38, s41, v38
    v_mul_f32 v39, s41, v39
    v_cvt_pk_f16_f32 v238, v16, v17
    v_cvt_pk_f16_f32 v239, v18, v19
    v_mul_f32 v28, v16, v16
    v_mul_f32 v29, v17, v16
    v_mul_f32 v30, v18, v18
    v_mul_f32 v31, v19, v18
    v_fma_f32 v28, -v17, v17, v28
    v_fmac_f32 v29, v16, v17
    v_fma_f32 v30, -v19, v19, v30
    v_fmac_f32 v31, v18, v19
    v_cvt_pk_f16_f32 v240, v28, v29
    v_cvt_pk_f16_f32 v241, v30, v31
    v_mul_f32 v44, v28, v16
    v_mul_f32 v45, v29, v16
    v_mul_f32 v46, v30, v18
    v_mul_f32 v47, v31, v18
    v_fma_f32 v44, -v29, v17, v44
    v_fmac_f32 v45, v28, v17
    v_fma_f32 v46, -v31, v19, v46
    v_fmac_f32 v47, v30, v19
    v_cvt_pk_f16_f32 v242, v44, v45
    v_cvt_pk_f16_f32 v243, v46, v47
    v_mul_f32 v32, v28, v28
    v_mul_f32 v33, v29, v28
    v_mul_f32 v34, v30, v30
    v_mul_f32 v35, v31, v30
    v_fma_f32 v32, -v29, v29, v32
    v_fmac_f32 v33, v28, v29
    v_fma_f32 v34, -v31, v31, v34
    v_fmac_f32 v35, v30, v31
    v_cvt_pk_f16_f32 v244, v32, v33
    v_cvt_pk_f16_f32 v245, v34, v35
    v_mul_f32 v48, v44, v44
    v_mul_f32 v49, v45, v44
    v_mul_f32 v50, v46, v46
    v_mul_f32 v51, v47, v46
    v_fma_f32 v48, -v45, v45, v48
    v_fmac_f32 v49, v44, v45
    v_fma_f32 v50, -v47, v47, v50
    v_fmac_f32 v51, v46, v47
    v_cvt_pk_f16_f32 v246, v48, v49
    v_cvt_pk_f16_f32 v247, v50, v51
    v_cvt_pk_f16_f32 v136, v36, -v37
    v_cvt_pk_f16_f32 v137, v38, -v39
    v_mul_f32 v44, v36, v32
    v_mul_f32 v45, v37, v32
    v_mul_f32 v46, v38, v34
    v_mul_f32 v47, v39, v34
    v_fma_f32 v44, -v37, v33, v44
    v_fmac_f32 v45, v36, v33
    v_fma_f32 v46, -v39, v35, v46
    v_fmac_f32 v47, v38, v35
    v_pk_mul_f16 v138, v136, v238 op_sel_hi:[1,0]
    v_pk_mul_f16 v139, v137, v239 op_sel_hi:[1,0]
    v_pk_fma_f16 v138, v136, v238, v138 op_sel:[1,1,0] op_sel_hi:[0,1,1] neg_hi:[1,0,0]
    v_pk_fma_f16 v139, v137, v239, v139 op_sel:[1,1,0] op_sel_hi:[0,1,1] neg_hi:[1,0,0]
    v_pk_mul_f16 v140, v136, v240 op_sel_hi:[1,0]
    v_pk_mul_f16 v141, v137, v241 op_sel_hi:[1,0]
    v_pk_fma_f16 v140, v136, v240, v140 op_sel:[1,1,0] op_sel_hi:[0,1,1] neg_hi:[1,0,0]
    v_pk_fma_f16 v141, v137, v241, v141 op_sel:[1,1,0] op_sel_hi:[0,1,1] neg_hi:[1,0,0]
    v_pk_mul_f16 v142, v136, v242 op_sel_hi:[1,0]
    v_pk_mul_f16 v143, v137, v243 op_sel_hi:[1,0]
    v_pk_fma_f16 v142, v136, v242, v142 op_sel:[1,1,0] op_sel_hi:[0,1,1] neg_hi:[1,0,0]
    v_pk_fma_f16 v143, v137, v243, v143 op_sel:[1,1,0] op_sel_hi:[0,1,1] neg_hi:[1,0,0]
    v_pk_mul_f16 v166, v136, v232 op_sel_hi:[1,0]
    v_pk_mul_f16 v167, v137, v233 op_sel_hi:[1,0]
    v_pk_fma_f16 v166, v136, v232, v166 op_sel:[1,1,0] op_sel_hi:[0,1,1] neg_hi:[1,0,0]
    v_pk_fma_f16 v167, v137, v233, v167 op_sel:[1,1,0] op_sel_hi:[0,1,1] neg_hi:[1,0,0]
    v_cvt_pk_f16_f32 v144, v44, -v45
    v_cvt_pk_f16_f32 v145, v46, -v47
    v_mul_f32 v40, v36, v24
    v_mul_f32 v41, v37, v24
    v_mul_f32 v42, v38, v26
    v_mul_f32 v43, v39, v26
    v_fma_f32 v40, -v37, v25, v40
    v_fmac_f32 v41, v36, v25
    v_fma_f32 v42, -v39, v27, v42
    v_fmac_f32 v43, v38, v27
    v_pk_mul_f16 v146, v144, v238 op_sel_hi:[1,0]
    v_pk_mul_f16 v147, v145, v239 op_sel_hi:[1,0]
    v_pk_fma_f16 v146, v144, v238, v146 op_sel:[1,1,0] op_sel_hi:[0,1,1] neg_hi:[1,0,0]
    v_pk_fma_f16 v147, v145, v239, v147 op_sel:[1,1,0] op_sel_hi:[0,1,1] neg_hi:[1,0,0]
    v_pk_mul_f16 v148, v144, v240 op_sel_hi:[1,0]
    v_pk_mul_f16 v149, v145, v241 op_sel_hi:[1,0]
    v_pk_fma_f16 v148, v144, v240, v148 op_sel:[1,1,0] op_sel_hi:[0,1,1] neg_hi:[1,0,0]
    v_pk_fma_f16 v149, v145, v241, v149 op_sel:[1,1,0] op_sel_hi:[0,1,1] neg_hi:[1,0,0]
    v_pk_mul_f16 v150, v144, v242 op_sel_hi:[1,0]
    v_pk_mul_f16 v151, v145, v243 op_sel_hi:[1,0]
    v_pk_fma_f16 v150, v144, v242, v150 op_sel:[1,1,0] op_sel_hi:[0,1,1] neg_hi:[1,0,0]
    v_pk_fma_f16 v151, v145, v243, v151 op_sel:[1,1,0] op_sel_hi:[0,1,1] neg_hi:[1,0,0]
    v_cvt_pk_f16_f32 v184, v40, -v41
    v_cvt_pk_f16_f32 v185, v42, -v43
    v_mul_f32 v44, v40, v24
    v_mul_f32 v45, v41, v24
    v_mul_f32 v46, v42, v26
    v_mul_f32 v47, v43, v26
    v_fma_f32 v44, -v41, v25, v44
    v_fmac_f32 v45, v40, v25
    v_fma_f32 v46, -v43, v27, v46
    v_fmac_f32 v47, v42, v27
    v_pk_mul_f16 v186, v184, v240 op_sel_hi:[1,0]
    v_pk_mul_f16 v187, v185, v241 op_sel_hi:[1,0]
    v_pk_fma_f16 v186, v184, v240, v186 op_sel:[1,1,0] op_sel_hi:[0,1,1] neg_hi:[1,0,0]
    v_pk_fma_f16 v187, v185, v241, v187 op_sel:[1,1,0] op_sel_hi:[0,1,1] neg_hi:[1,0,0]
    v_pk_mul_f16 v188, v184, v244 op_sel_hi:[1,0]
    v_pk_mul_f16 v189, v185, v245 op_sel_hi:[1,0]
    v_pk_fma_f16 v188, v184, v244, v188 op_sel:[1,1,0] op_sel_hi:[0,1,1] neg_hi:[1,0,0]
    v_pk_fma_f16 v189, v185, v245, v189 op_sel:[1,1,0] op_sel_hi:[0,1,1] neg_hi:[1,0,0]
    v_pk_mul_f16 v194, v184, v246 op_sel_hi:[1,0]
    v_pk_mul_f16 v195, v185, v247 op_sel_hi:[1,0]
    v_pk_fma_f16 v194, v184, v246, v194 op_sel:[1,1,0] op_sel_hi:[0,1,1] neg_hi:[1,0,0]
    v_pk_fma_f16 v195, v185, v247, v195 op_sel:[1,1,0] op_sel_hi:[0,1,1] neg_hi:[1,0,0]
    v_pk_mul_f16 v196, v184, v232 op_sel_hi:[1,0]
    v_pk_mul_f16 v197, v185, v233 op_sel_hi:[1,0]
    v_pk_fma_f16 v196, v184, v232, v196 op_sel:[1,1,0] op_sel_hi:[0,1,1] neg_hi:[1,0,0]
    v_pk_fma_f16 v197, v185, v233, v197 op_sel:[1,1,0] op_sel_hi:[0,1,1] neg_hi:[1,0,0]
    v_cvt_pk_f16_f32 v152, v44, -v45
    v_cvt_pk_f16_f32 v153, v46, -v47
    v_mul_f32 v48, v44, v24
    v_mul_f32 v49, v45, v24
    v_mul_f32 v50, v46, v26
    v_mul_f32 v51, v47, v26
    v_fma_f32 v48, -v45, v25, v48
    v_fmac_f32 v49, v44, v25
    v_fma_f32 v50, -v47, v27, v50
    v_fmac_f32 v51, v46, v27
    v_pk_mul_f16 v154, v152, v244 op_sel_hi:[1,0]
    v_pk_mul_f16 v155, v153, v245 op_sel_hi:[1,0]
    v_pk_fma_f16 v154, v152, v244, v154 op_sel:[1,1,0] op_sel_hi:[0,1,1] neg_hi:[1,0,0]
    v_pk_fma_f16 v155, v153, v245, v155 op_sel:[1,1,0] op_sel_hi:[0,1,1] neg_hi:[1,0,0]
    v_pk_mul_f16 v156, v152, v232 op_sel_hi:[1,0]
    v_pk_mul_f16 v157, v153, v233 op_sel_hi:[1,0]
    v_pk_fma_f16 v156, v152, v232, v156 op_sel:[1,1,0] op_sel_hi:[0,1,1] neg_hi:[1,0,0]
    v_pk_fma_f16 v157, v153, v233, v157 op_sel:[1,1,0] op_sel_hi:[0,1,1] neg_hi:[1,0,0]
    v_cvt_pk_f16_f32 v160, v48, -v49
    v_cvt_pk_f16_f32 v161, v50, -v51
    v_mul_f32 v44, v48, v24
    v_mul_f32 v45, v49, v24
    v_mul_f32 v46, v50, v26
    v_mul_f32 v47, v51, v26
    v_fma_f32 v44, -v49, v25, v44
    v_fmac_f32 v45, v48, v25
    v_fma_f32 v46, -v51, v27, v46
    v_fmac_f32 v47, v50, v27
    v_pk_mul_f16 v162, v160, v244 op_sel_hi:[1,0]
    v_pk_mul_f16 v163, v161, v245 op_sel_hi:[1,0]
    v_pk_fma_f16 v162, v160, v244, v162 op_sel:[1,1,0] op_sel_hi:[0,1,1] neg_hi:[1,0,0]
    v_pk_fma_f16 v163, v161, v245, v163 op_sel:[1,1,0] op_sel_hi:[0,1,1] neg_hi:[1,0,0]
    v_pk_mul_f16 v164, v160, v232 op_sel_hi:[1,0]
    v_pk_mul_f16 v165, v161, v233 op_sel_hi:[1,0]
    v_pk_fma_f16 v164, v160, v232, v164 op_sel:[1,1,0] op_sel_hi:[0,1,1] neg_hi:[1,0,0]
    v_pk_fma_f16 v165, v161, v233, v165 op_sel:[1,1,0] op_sel_hi:[0,1,1] neg_hi:[1,0,0]
    v_cvt_pk_f16_f32 v168, v44, -v45
    v_cvt_pk_f16_f32 v169, v46, -v47
    v_mul_f32 v48, v44, v24
    v_mul_f32 v49, v45, v24
    v_mul_f32 v50, v46, v26
    v_mul_f32 v51, v47, v26
    v_fma_f32 v48, -v45, v25, v48
    v_fmac_f32 v49, v44, v25
    v_fma_f32 v50, -v47, v27, v50
    v_fmac_f32 v51, v46, v27
    v_pk_mul_f16 v170, v168, v232 op_sel_hi:[1,0]
    v_pk_mul_f16 v171, v169, v233 op_sel_hi:[1,0]
    v_pk_fma_f16 v170, v168, v232, v170 op_sel:[1,1,0] op_sel_hi:[0,1,1] neg_hi:[1,0,0]
    v_pk_fma_f16 v171, v169, v233, v171 op_sel:[1,1,0] op_sel_hi:[0,1,1] neg_hi:[1,0,0]
    v_cvt_pk_f16_f32 v172, v48, -v49
    v_cvt_pk_f16_f32 v173, v50, -v51
    v_mul_f32 v44, v48, v24
    v_mul_f32 v45, v49, v24
    v_mul_f32 v46, v50, v26
    v_mul_f32 v47, v51, v26
    v_fma_f32 v44, -v49, v25, v44
    v_fmac_f32 v45, v48, v25
    v_fma_f32 v46, -v51, v27, v46
    v_fmac_f32 v47, v50, v27
    v_pk_mul_f16 v174, v172, v232 op_sel_hi:[1,0]
    s_barrier
    v_pk_mul_f16 v175, v173, v233 op_sel_hi:[1,0]
    v_pk_fma_f16 v174, v172, v232, v174 op_sel:[1,1,0] op_sel_hi:[0,1,1] neg_hi:[1,0,0]
    v_pk_fma_f16 v175, v173, v233, v175 op_sel:[1,1,0] op_sel_hi:[0,1,1] neg_hi:[1,0,0]
    v_cvt_pk_f16_f32 v176, v44, -v45
    v_cvt_pk_f16_f32 v177, v46, -v47
    v_mul_f32 v48, v44, v24
    v_mul_f32 v49, v45, v24
    v_mul_f32 v50, v46, v26
    v_mul_f32 v51, v47, v26
    v_fma_f32 v48, -v45, v25, v48
    v_fmac_f32 v49, v44, v25
    v_fma_f32 v50, -v47, v27, v50
    v_fmac_f32 v51, v46, v27
    v_pk_mul_f16 v178, v176, v232 op_sel_hi:[1,0]
    v_pk_mul_f16 v179, v177, v233 op_sel_hi:[1,0]
    v_pk_fma_f16 v178, v176, v232, v178 op_sel:[1,1,0] op_sel_hi:[0,1,1] neg_hi:[1,0,0]
    v_pk_fma_f16 v179, v177, v233, v179 op_sel:[1,1,0] op_sel_hi:[0,1,1] neg_hi:[1,0,0]
    v_cvt_pk_f16_f32 v180, v48, -v49
    v_cvt_pk_f16_f32 v181, v50, -v51
    v_pk_mul_f16 v182, v180, v232 op_sel_hi:[1,0]
    v_pk_mul_f16 v183, v181, v233 op_sel_hi:[1,0]
    v_pk_fma_f16 v182, v180, v232, v182 op_sel:[1,1,0] op_sel_hi:[0,1,1] neg_hi:[1,0,0]
    v_pk_fma_f16 v183, v181, v233, v183 op_sel:[1,1,0] op_sel_hi:[0,1,1] neg_hi:[1,0,0]
    v_add_u32 v208, s57, v208
    v_add_u32 v209, s57, v209
    v_add_u32 v210, s57, v210
    v_add_u32 v211, s57, v211
    v_add_u32 v212, s57, v212
    v_add_u32 v213, s57, v213
    v_add_u32 v214, s57, v214
    v_add_u32 v215, s57, v215
    v_add_u32 v216, s57, v216
    v_add_u32 v217, s57, v217
    v_add_u32 v218, s57, v218
    v_add_u32 v219, s57, v219
    v_add_u32 v220, s57, v220
    v_add_u32 v221, s57, v221
    v_add_u32 v222, s57, v222
    v_add_u32 v223, s57, v223
    v_and_b32 v11, 16, v1
    v_lshl_add_u32 v11, v11, 9, s57
    v_add_u32 v224, v11, v224
    v_add_u32 v225, v11, v225
    v_add_u32 v226, v11, v226
    v_add_u32 v227, v11, v227
    v_add_u32 v228, v11, v228
    v_add_u32 v229, v11, v229
    v_add_u32 v230, v11, v230
    v_add_u32 v231, v11, v231
    s_barrier
    s_cmp_lg_u32 s3, 7
    s_cbranch_scc1 KW_29
    s_mov_b32 s53, 0
    s_waitcnt vmcnt(0)
TG_30:
    v_readfirstlane_b32 s50, v206
    v_readfirstlane_b32 s51, v207
    s_cmp_lg_u32 s50, 0
    s_cbranch_scc1 TD_31
    s_add_u32 s53, s53, 1
    s_cmp_gt_u32 s53, 200000
    s_cbranch_scc1 TD_31
    s_sleep 2
    buffer_load_dwordx2 v[206:207], v205, s[20:23], 0 offen sc1
    s_waitcnt vmcnt(0)
    s_branch TG_30
TD_31:
    s_and_b32 s32, s2, 7
    s_lshl_b32 s32, s32, 2
    s_lshr_b32 s32, 0x76315420, s32
    s_and_b32 s32, s32, 7
    s_mul_i32 s32, s32, 28
    s_lshr_b32 s33, s46, 3
    s_add_u32 s33, s33, s32
    s_lshl_b32 s33, s33, 7
    s_add_u32 s33, s33, 65536
    s_mov_b64 exec, 1
    v_mov_b32 v202, s50
    v_mov_b32 v203, s51
    buffer_store_dwordx2 v[202:203], v205, s[4:7], s33 offen offset:0 sc1
    s_mov_b64 exec, -1
KW_29:
    s_cmp_lg_u32 s3, 6
    s_cbranch_scc1 KW_32
    s_mov_b32 s53, 0
    s_waitcnt vmcnt(0)
TG_33:
    v_readfirstlane_b32 s50, v206
    v_readfirstlane_b32 s51, v207
    s_cmp_lg_u32 s50, 0
    s_cbranch_scc1 TD_34
    s_add_u32 s53, s53, 1
    s_cmp_gt_u32 s53, 200000
    s_cbranch_scc1 TD_34
    s_sleep 2
    buffer_load_dwordx2 v[206:207], v205, s[20:23], 0 offen sc1
    s_waitcnt vmcnt(0)
    s_branch TG_33
TD_34:
KW_32:
    v_lshlrev_b32 v203, 4, v1
    s_getpc_b64 s[32:33]
BX_35:
    v_add_u32 v203, K_box - BX_35 + 2048, v203
    global_load_dwordx4 v[48:51], v203, s[32:33] offset:-2048
    global_load_dwordx4 v[52:55], v203, s[32:33] offset:-1024
    global_load_dwordx4 v[56:59], v203, s[32:33] offset:0
    global_load_dwordx4 v[60:63], v203, s[32:33] offset:1024
    global_load_dwordx4 v[64:67], v203, s[32:33] offset:2048
    s_barrier
    s_lshl_b32 s33, s48, 3
    s_mov_b32 s40, 0x41291200
    s_mov_b32 s41, 0xb0998270
    s_lshr_b64 s[40:41], s[40:41], s33
    s_and_b32 s32, s40, 0xff
    v_add_u32 v200, s32, v1
    s_mov_b32 s40, 0x6a584029
    s_mov_b32 s41, 0xdac8b099
    s_lshr_b64 s[40:41], s[40:41], s33
    s_and_b32 s32, s40, 0xff
    v_min_u32 v200, s32, v200
    v_lshlrev_b32 v200, 7, v200
    v_add_u32 v200, 65536, v200
    s_lshl_b32 s33, s48, 3
    s_mov_b32 s40, 0xe2d6cbc0
    s_mov_b32 s41, 0xf2e5e0ed
    s_lshr_b64 s[40:41], s[40:41], s33
    s_and_b32 s32, s40, 0xff
    v_add_u32 v13, s32, v1
    s_mov_b32 s40, 0xede2d6cb
    s_mov_b32 s41, 0xfff2fff9
    s_lshr_b64 s[40:41], s[40:41], s33
    s_and_b32 s32, s40, 0xff
    v_min_u32 v13, s32, v13
    s_lshl_b32 s32, s46, 1
    s_mul_hi_u32 s32, s32, 0x24924925
    s_add_u32 s32, s32, 192
    v_writelane_b32 v13, s32, 62
    s_lshl_b32 s32, s46, 1
    s_add_u32 s32, s32, 1
    s_mul_hi_u32 s32, s32, 0x24924925
    s_add_u32 s32, s32, 192
    v_writelane_b32 v13, s32, 63
    v_lshlrev_b32 v13, 7, v13
    v_add_u32 v13, 126976, v13
    v_and_b32 v198, 31, v1
    v_lshlrev_b32 v198, 7, v198
    s_mov_b32 s59, s34
    s_mul_i32 s34, s48, 276480
    s_add_u32 s34, s34, 0x900000
    s_add_u32 s8, s86, s34
    s_addc_u32 s9, s87, 0
    s_mov_b32 s10, 276480
    s_mov_b32 s11, 0x20000
    v_lshlrev_b32 v201, 4, v1
    v_add_u32 v204, 4096, v201
    s_and_b32 s33, s47, 3
    s_lshl_b32 s33, s33, 1
    s_add_u32 s33, s33, s48
    s_and_b32 s33, s33, 7
    s_mul_i32 s33, s33, 7
    s_add_u32 s33, s33, s35
    s_add_u32 s34, s33, 20
    s_cmp_ge_u32 s34, 54
    s_cselect_b32 s32, 54, 0
    s_sub_u32 s34, s34, s32
    s_mul_i32 s12, s34, 5120
    s_add_u32 s34, s33, 24
    s_cmp_ge_u32 s34, 54
    s_cselect_b32 s32, 54, 0
    s_sub_u32 s34, s34, s32
    s_mul_i32 s13, s34, 5120
    s_add_u32 s34, s33, 28
    s_cmp_ge_u32 s34, 54
    s_cselect_b32 s32, 54, 0
    s_sub_u32 s34, s34, s32
    s_mul_i32 s14, s34, 5120
    s_add_u32 s34, s33, 32
    s_cmp_ge_u32 s34, 54
    s_cselect_b32 s32, 54, 0
    s_sub_u32 s34, s34, s32
    s_mul_i32 s15, s34, 5120
    s_add_u32 s16, s33, 36
    s_mul_i32 s18, s35, 5120
    s_mul_i32 s17, s35, 20480
    s_cmp_ge_u32 s35, 2
    s_cselect_b32 s32, 8192, 0
    s_add_u32 s17, s17, s32
    s_mov_b32 s34, s59
    s_mov_b64 s[28:29], -1
    v_mov_b32 v190, 0x7fa57fa5
    s_barrier
    s_barrier
    s_barrier
    s_barrier
    s_barrier
    s_cmp_lg_u32 s3, 6
    s_cbranch_scc1 KW_36
    buffer_load_dwordx2 v[252:253], v200, s[4:7], 0 offen offset:0 sc1
KW_36:
    s_barrier
    s_barrier
    s_cmp_lg_u32 s3, 6
    s_cbranch_scc1 KW_37
    s_mov_b32 s53, 0
    s_waitcnt vmcnt(0)
PL_38:
    v_cmp_eq_u64 vcc, s[50:51], v[252:253]
    s_nop 0
    s_andn2_b64 s[54:55], s[28:29], vcc
    s_cbranch_scc0 PD_39
    s_add_u32 s53, s53, 1
    s_cmp_gt_u32 s53, 200000
    s_cbranch_scc1 PD_39
    s_sleep 2
    buffer_load_dwordx2 v[252:253], v200, s[4:7], 0 offen offset:0 sc1
    s_waitcnt vmcnt(0)
    s_branch PL_38
PD_39:
KW_37:
    s_cmp_lg_u32 s3, 6
    s_cbranch_scc1 KW_40
    s_add_i32 s33, s16, 3
    s_cmp_ge_u32 s33, 54
    s_cselect_b32 s53, 54, 0
    s_sub_u32 s33, s33, s53
    s_mul_i32 s33, s33, 5120
    s_add_u32 m0, s18, 158720
    s_nop 0
    buffer_load_dwordx4 v201, s[8:11], s33 offen offset:0 sc1 lds
    buffer_load_dwordx4 v201, s[8:11], s33 offen offset:1024 sc1 lds
    buffer_load_dwordx4 v201, s[8:11], s33 offen offset:2048 sc1 lds
KW_40:
    s_barrier
    s_add_i32 s33, s16, 1
    s_cmp_ge_u32 s33, 54
    s_cselect_b32 s53, 54, 0
    s_sub_u32 s33, s33, s53
    s_mul_i32 s33, s33, 5120
    s_add_u32 m0, s18, 148480
    s_nop 0
    buffer_load_dwordx4 v201, s[8:11], s33 offen offset:0 sc1 lds
    buffer_load_dwordx4 v201, s[8:11], s33 offen offset:1024 sc1 lds
    buffer_load_dwordx4 v201, s[8:11], s33 offen offset:2048 sc1 lds
    s_barrier
    s_cmp_lg_u32 s3, 6
    s_cbranch_scc1 KW_41
    s_mov_b64 exec, 1
    s_add_u32 s33, s56, 36864
    v_mov_b32 v202, s50
    v_mov_b32 v203, s51
    buffer_store_dwordx2 v[202:203], v205, s[4:7], s33 offen offset:0 sc1
    s_mov_b64 exec, -1
KW_41:
    s_add_i32 s33, s16, 1
    s_cmp_ge_u32 s33, 54
    s_cselect_b32 s53, 54, 0
    s_sub_u32 s33, s33, s53
    s_mul_i32 s33, s33, 5120
    s_add_u32 m0, s18, 148480
    s_nop 0
    buffer_load_dwordx4 v201, s[8:11], s33 offen offset:3072 sc1 lds
    s_add_u32 m0, s18, 152576
    s_nop 0
    buffer_load_dwordx4 v204, s[8:11], s33 offen sc1 lds
    s_barrier
    s_cmp_lg_u32 s3, 7
    s_cbranch_scc1 KW_42
    buffer_load_dwordx2 v[254:255], v198, s[4:7], 0 offen offset:0 sc1
KW_42:
    s_add_u32 s20, s86, 0x300000
    s_addc_u32 s21, s87, 0
    s_mov_b32 s22, 0x280000
    s_mov_b32 s23, 0x20000
    s_mov_b32 s24, s72
    s_mov_b32 s25, s73
    s_mov_b32 s26, 0x500
    s_mov_b32 s27, 0x20000
    s_cmp_lg_u32 s3, 6
    s_cbranch_scc1 KW_43
    s_add_u32 m0, s17, 0
    s_nop 0
    buffer_load_dwordx4 v201, s[8:11], s12 offen offset:0 sc1 lds
    buffer_load_dwordx4 v201, s[8:11], s12 offen offset:1024 sc1 lds
    buffer_load_dwordx4 v201, s[8:11], s12 offen offset:2048 sc1 lds
    buffer_load_dwordx4 v201, s[8:11], s12 offen offset:3072 sc1 lds
KW_43:
    s_cmp_lg_u32 s3, 6
    s_cbranch_scc1 KW_44
    s_add_i32 s33, s16, 3
    s_cmp_ge_u32 s33, 54
    s_cselect_b32 s53, 54, 0
    s_sub_u32 s33, s33, s53
    s_mul_i32 s33, s33, 5120
    s_add_u32 m0, s18, 158720
    s_nop 0
    buffer_load_dwordx4 v201, s[8:11], s33 offen offset:3072 sc1 lds
    s_add_u32 m0, s18, 162816
    s_nop 0
    buffer_load_dwordx4 v204, s[8:11], s33 offen sc1 lds
KW_44:
    s_barrier
    s_cmp_lg_u32 s3, 6
    s_cbranch_scc1 KW_45
    s_add_u32 m0, s17, 4096
    s_nop 0
    buffer_load_dwordx4 v204, s[8:11], s12 offen sc1 lds
    s_add_u32 m0, s17, 5120
    s_nop 0
    buffer_load_dwordx4 v201, s[8:11], s13 offen offset:0 sc1 lds
    buffer_load_dwordx4 v201, s[8:11], s13 offen offset:1024 sc1 lds
    buffer_load_dwordx4 v201, s[8:11], s13 offen offset:2048 sc1 lds
KW_45:
    s_barrier
    s_cmp_lg_u32 s3, 7
    s_cbranch_scc1 KW_46
    s_mov_b32 s53, 0
    s_waitcnt vmcnt(0)
PL_47:
    v_cmp_eq_u64 vcc, s[50:51], v[254:255]
    s_nop 0
    s_andn2_b64 s[54:55], s[28:29], vcc
    s_cbranch_scc0 PD_48
    s_add_u32 s53, s53, 1
    s_cmp_gt_u32 s53, 200000
    s_cbranch_scc1 PD_48
    s_sleep 2
    buffer_load_dwordx2 v[254:255], v198, s[4:7], 0 offen offset:0 sc1
    s_waitcnt vmcnt(0)
    s_branch PL_47
PD_48:
KW_46:
    s_cmp_lg_u32 s3, 6
    s_cbranch_scc1 KW_49
    s_add_u32 m0, s17, 5120
    s_nop 0
    buffer_load_dwordx4 v201, s[8:11], s13 offen offset:3072 sc1 lds
    s_add_u32 m0, s17, 9216
    s_nop 0
    buffer_load_dwordx4 v204, s[8:11], s13 offen sc1 lds
    s_add_u32 m0, s17, 10240
    s_nop 0
    buffer_load_dwordx4 v201, s[8:11], s14 offen offset:0 sc1 lds
KW_49:
    s_cmp_lg_u32 s3, 7
    s_cbranch_scc1 KW_50
    s_add_u32 m0, s17, 0
    s_nop 0
    buffer_load_dwordx4 v201, s[8:11], s12 offen offset:0 sc1 lds
    buffer_load_dwordx4 v201, s[8:11], s12 offen offset:1024 sc1 lds
    buffer_load_dwordx4 v201, s[8:11], s12 offen offset:2048 sc1 lds
    buffer_load_dwordx4 v201, s[8:11], s12 offen offset:3072 sc1 lds
    s_add_u32 m0, s17, 4096
    s_nop 0
    buffer_load_dwordx4 v204, s[8:11], s12 offen sc1 lds
    s_add_u32 m0, s17, 5120
    s_nop 0
    buffer_load_dwordx4 v201, s[8:11], s13 offen offset:0 sc1 lds
    buffer_load_dwordx4 v201, s[8:11], s13 offen offset:1024 sc1 lds
KW_50:
    s_barrier
    s_lshl_b32 s32, s49, 12
    s_lshl_b32 s33, s49, 1
    buffer_load_dwordx4 v[16:19], v201, s[20:23], s32 offen offset:0 sc1
    buffer_load_dwordx4 v[20:23], v201, s[20:23], s32 offen offset:1024 sc1
    buffer_load_dwordx4 v[24:27], v201, s[20:23], s32 offen offset:2048 sc1
    buffer_load_dwordx4 v[28:31], v201, s[20:23], s32 offen offset:3072 sc1
    buffer_load_ushort v207, v205, s[24:27], s33 offen
    s_barrier
    s_cmp_lg_u32 s3, 6
    s_cbranch_scc1 KW_51
    s_add_u32 m0, s17, 10240
    s_nop 0
    buffer_load_dwordx4 v201, s[8:11], s14 offen offset:1024 sc1 lds
    buffer_load_dwordx4 v201, s[8:11], s14 offen offset:2048 sc1 lds
    buffer_load_dwordx4 v201, s[8:11], s14 offen offset:3072 sc1 lds
KW_51:
    s_cmp_lg_u32 s3, 7
    s_cbranch_scc1 KW_52
    s_add_u32 m0, s17, 5120
    s_nop 0
    buffer_load_dwordx4 v201, s[8:11], s13 offen offset:2048 sc1 lds
    buffer_load_dwordx4 v201, s[8:11], s13 offen offset:3072 sc1 lds
    s_add_u32 m0, s17, 9216
    s_nop 0
    buffer_load_dwordx4 v204, s[8:11], s13 offen sc1 lds
    s_add_u32 m0, s17, 10240
    s_nop 0
    buffer_load_dwordx4 v201, s[8:11], s14 offen offset:0 sc1 lds
    buffer_load_dwordx4 v201, s[8:11], s14 offen offset:1024 sc1 lds
    buffer_load_dwordx4 v201, s[8:11], s14 offen offset:2048 sc1 lds
    buffer_load_dwordx4 v201, s[8:11], s14 offen offset:3072 sc1 lds
KW_52:
    s_barrier
    s_cmp_lg_u32 s3, 6
    s_cbranch_scc1 KW_53
    s_add_u32 m0, s17, 14336
    s_nop 0
    buffer_load_dwordx4 v204, s[8:11], s14 offen sc1 lds
    s_add_u32 m0, s17, 15360
    s_nop 0
    buffer_load_dwordx4 v201, s[8:11], s15 offen offset:0 sc1 lds
    buffer_load_dwordx4 v201, s[8:11], s15 offen offset:1024 sc1 lds
    buffer_load_dwordx4 v201, s[8:11], s15 offen offset:2048 sc1 lds
    buffer_load_dwordx4 v201, s[8:11], s15 offen offset:3072 sc1 lds
    s_add_u32 m0, s17, 19456
    s_nop 0
    buffer_load_dwordx4 v204, s[8:11], s15 offen sc1 lds
KW_53:
    s_cmp_lg_u32 s3, 7
    s_cbranch_scc1 KW_54
    s_add_u32 m0, s17, 14336
    s_nop 0
    buffer_load_dwordx4 v204, s[8:11], s14 offen sc1 lds
    s_add_u32 m0, s17, 15360
    s_nop 0
    buffer_load_dwordx4 v201, s[8:11], s15 offen offset:0 sc1 lds
    buffer_load_dwordx4 v201, s[8:11], s15 offen offset:1024 sc1 lds
    buffer_load_dwordx4 v201, s[8:11], s15 offen offset:2048 sc1 lds
    buffer_load_dwordx4 v201, s[8:11], s15 offen offset:3072 sc1 lds
    s_add_u32 m0, s17, 19456
    s_nop 0
    buffer_load_dwordx4 v204, s[8:11], s15 offen sc1 lds
KW_54:
    s_cmp_lg_u32 s3, 7
    s_cbranch_scc1 KW_55
    buffer_load_dwordx2 v[8:9], v13, s[4:7], 0 offen offset:0 sc1
KW_55:
    s_barrier
    v_and_b32 v2, 15, v1
    v_lshrrev_b32 v3, 4, v1
    v_lshlrev_b32 v15, 5, v2
    v_lshl_add_u32 v7, v3, 4, v15
    s_add_u32 s33, s44, 32
    v_add_u32 v7, s33, v7
    v_and_b32 v44, 1, v1
    v_mul_u32_u24 v4, 4160, v44
    v_lshlrev_b32 v68, 4, v3
    v_sub_u32 v68, v68, v4
    v_add_u32 v4, 1, v2
    v_lshrrev_b32 v4, 1, v4
    v_lshlrev_b32 v4, 2, v4
    v_sub_u32 v68, v68, v4
    s_add_u32 s33, s34, 7264
    v_add_u32 v68, s33, v68
    v_subrev_u32 v69, 576, v68
    v_lshlrev_b32 v4, 2, v3
    v_sub_u32 v4, v4, v2
    s_add_u32 s33, s34, 2108
    v_lshl_add_u32 v70, v4, 2, s33
    v_lshrrev_b32 v4, 2, v2
    v_lshlrev_b32 v15, 7, v4
    v_and_b32 v4, 3, v2
    v_lshl_add_u32 v15, v4, 4, v15
    v_lshrrev_b32 v4, 1, v3
    v_lshl_add_u32 v15, v4, 6, v15
    v_and_b32 v4, 1, v3
    v_lshl_add_u32 v15, v4, 9, v15
    v_lshlrev_b32 v4, 3, v3
    v_sub_u32 v4, v2, v4
    v_add_u32 v4, 16, v4
    v_ashrrev_i32 v4, 1, v4
    v_lshlrev_b32 v44, 4, v44
    s_waitcnt vmcnt(9)
    v_lshlrev_b32 v44, v44, v207
    v_cmp_eq_u32 vcc, 0, v4
    s_nop 1
    v_cndmask_b32 v40, 0, v44, vcc
    v_cmp_eq_u32 vcc, 1, v4
    s_nop 1
    v_cndmask_b32 v41, 0, v44, vcc
    v_cmp_eq_u32 vcc, 2, v4
    s_nop 1
    v_cndmask_b32 v42, 0, v44, vcc
    v_cmp_eq_u32 vcc, 3, v4
    s_nop 1
    v_cndmask_b32 v43, 0, v44, vcc
    ds_write_b64 v208, v[136:137] offset:0
    ds_write_b64 v209, v[138:139] offset:512
    ds_write_b64 v210, v[140:141] offset:1024
    ds_write_b64 v211, v[142:143] offset:1536
    ds_write_b64 v212, v[144:145] offset:2048
    ds_write_b64 v213, v[146:147] offset:2560
    ds_write_b64 v214, v[148:149] offset:3072
    ds_write_b64 v215, v[150:151] offset:3584
    ds_write_b64 v216, v[152:153] offset:4096
    ds_write_b64 v217, v[154:155] offset:4608
    ds_write_b64 v218, v[156:157] offset:5120
    ds_write_b64 v219, v[144:145] offset:5632
    ds_write_b64 v220, v[160:161] offset:6144
    ds_write_b64 v221, v[162:163] offset:6656
    ds_write_b64 v222, v[164:165] offset:7168
    ds_write_b64 v223, v[166:167] offset:7680
    ds_write_b64 v208, v[168:169] offset:8192
    ds_write_b64 v209, v[170:171] offset:8704
    ds_write_b64 v210, v[172:173] offset:9216
    ds_write_b64 v211, v[174:175] offset:9728
    ds_write_b64 v212, v[176:177] offset:10240
    ds_write_b64 v213, v[178:179] offset:10752
    ds_write_b64 v214, v[180:181] offset:11264
    ds_write_b64 v215, v[182:183] offset:11776
    ds_write_b64 v216, v[184:185] offset:12288
    ds_write_b64 v217, v[186:187] offset:12800
    ds_write_b64 v218, v[188:189] offset:13312
    ds_write_b64 v220, v[188:189] offset:14336
    ds_write_b64 v221, v[194:195] offset:14848
    ds_write_b64 v222, v[196:197] offset:15360
    ds_read_b128 v[136:139], v224 offset:0
    ds_read_b128 v[140:143], v225 offset:0
    ds_read_b128 v[144:147], v226 offset:0
    ds_read_b128 v[148:151], v227 offset:0
    ds_read_b128 v[152:155], v228 offset:0
    ds_read_b128 v[156:159], v229 offset:0
    ds_read_b128 v[160:163], v230 offset:0
    ds_read_b128 v[164:167], v231 offset:0
    ds_read_b128 v[168:171], v224 offset:256
    ds_read_b128 v[172:175], v225 offset:256
    ds_read_b128 v[176:179], v226 offset:256
    ds_read_b128 v[180:183], v227 offset:256
    ds_read_b128 v[184:187], v228 offset:256
    ds_read_b128 v[188:191], v229 offset:256
    ds_read_b128 v[192:195], v230 offset:256
    ds_read_b128 v[196:199], v231 offset:256
    v_mov_b32 v36, 0
    v_mov_b32 v37, 0
    v_lshl_add_u32 v38, v1, 3, s44
    ds_write_b64 v38, v[36:37]
    v_add_u32 v202, s44, v201
    ds_write_b128 v202, v[16:19] offset:512
    ds_write_b128 v202, v[20:23] offset:1536
    ds_write_b128 v202, v[24:27] offset:2560
    ds_write_b128 v202, v[28:31] offset:3584
    s_waitcnt lgkmcnt(0)
    v_mfma_f32_32x32x16_f16 v[240:255], v[136:139], v[72:75], 0
    v_mov_b32 v32, 0
    v_mov_b32 v33, 0
    v_mfma_f32_32x32x16_f16 v[240:255], v[140:143], v[76:79], v[240:255]
    v_mov_b32 v34, 0
    v_mov_b32 v35, 0
    v_mfma_f32_32x32x16_f16 v[240:255], v[144:147], v[80:83], v[240:255]
    v_lshl_add_u32 v203, v1, 4, s34
    ds_write_b128 v203, v[32:35] offset:2048
    v_mfma_f32_32x32x16_f16 v[240:255], v[148:151], v[84:87], v[240:255]
    ds_write_b128 v203, v[32:35] offset:6208
    v_and_b32 v200, 31, v1
    v_mfma_f32_32x32x16_f16 v[240:255], v[152:155], v[88:91], v[240:255]
    v_lshrrev_b32 v201, 5, v1
    v_lshlrev_b32 v202, 4, v200
    v_mfma_f32_32x32x16_f16 v[240:255], v[156:159], v[92:95], v[240:255]
    v_sub_u32 v202, s34, v202
    v_lshlrev_b32 v203, 3, v201
    v_mfma_f32_32x32x16_f16 v[240:255], v[160:163], v[96:99], v[240:255]
    v_sub_u32 v202, v202, v203
    v_lshrrev_b32 v200, 1, v200
    v_mfma_f32_32x32x16_f16 v[240:255], v[164:167], v[100:103], v[240:255]
    v_lshlrev_b32 v200, 2, v200
    v_sub_u32 v203, s34, v200
    v_mfma_f32_32x32x16_f16 v[240:255], v[168:171], v[104:107], v[240:255]
    v_and_b32 v204, 1, v1
    v_lshlrev_b32 v200, 6, v201
    v_mfma_f32_32x32x16_f16 v[240:255], v[172:175], v[108:111], v[240:255]
    v_sub_u32 v203, v203, v200
    v_sub_u32 v12, v203, v200
    v_mfma_f32_32x32x16_f16 v[240:255], v[176:179], v[112:115], v[240:255]
    v_mul_u32_u24 v200, 192, v204
    v_add_u32 v203, v203, v200
    v_mfma_f32_32x32x16_f16 v[240:255], v[180:183], v[116:119], v[240:255]
    v_lshl_add_u32 v12, v204, 10, v12
    v_lshlrev_b32 v200, 4, v204
    v_mfma_f32_32x32x16_f16 v[240:255], v[184:187], v[120:123], v[240:255]
    v_bfe_u32 v201, v1, 1, 1
    v_mul_u32_u24 v201, 4160, v201
    v_mfma_f32_32x32x16_f16 v[240:255], v[188:191], v[124:127], v[240:255]
    v_add3_u32 v200, v200, v201, s34
    v_mov_b32 v204, s34
    v_mfma_f32_32x32x16_f16 v[240:255], v[192:195], v[128:131], v[240:255]
    v_add_u32 v201, 2048, v204
    v_mfma_f32_32x32x16_f16 v[240:255], v[196:199], v[132:135], v[240:255]
    s_nop 11
    v_mul_f32 v72, v240, v14
    v_mul_f32 v73, v241, v14
    v_mul_f32 v74, v242, v14
    v_mul_f32 v75, v243, v14
    v_mul_f32 v79, v247, v14
    v_mul_f32 v84, v252, v14
    v_mul_f32 v85, v253, v14
    v_mul_f32 v86, v254, v14
    v_mul_f32 v76, v244, v14
    v_mul_f32 v77, v245, v14
    v_mul_f32 v78, v246, v14
    v_mul_f32 v80, v248, v14
    v_mul_f32 v81, v249, v14
    v_mul_f32 v82, v250, v14
    v_mul_f32 v83, v251, v14
    v_cvt_pk_bf16_f32 v88, v75, v74
    v_cvt_pk_bf16_f32 v89, v73, v72
    v_cvt_pk_bf16_f32 v104, v79, v75
    v_cvt_pk_bf16_f32 v105, v74, v73
    v_cvt_pk_bf16_f32 v11, v72, 0
    ds_write_b64 v202, v[88:89] offset:4088
    ds_write_b64 v202, v[104:105] offset:8248
    v_cvt_pk_bf16_f32 v90, v86, v85
    v_cvt_pk_bf16_f32 v91, v84, v84
    v_cvt_pk_bf16_f32 v106, v86, v86
    v_cvt_pk_bf16_f32 v107, v85, v84
    v_readfirstlane_b32 s40, v11
    ds_write_b64 v202, v[90:91] offset:3576
    ds_write_b64 v202, v[106:107] offset:7736
    v_cvt_pk_bf16_f32 v92, v77, v78
    v_cvt_pk_bf16_f32 v93, v80, v81
    v_cvt_pk_bf16_f32 v94, v82, v83
    v_cvt_pk_bf16_f32 v109, v76, v76
    v_cvt_pk_bf16_f32 v110, v80, v80
    v_writelane_b32 v32, s40, 2
    ds_write_b32 v203, v92 offset:2236
    ds_write_b32 v12, v93 offset:1820
    ds_write_b32 v12, v94 offset:1756
    v_and_b32 v108, 0xffff0000, v109
    v_and_b32 v111, 0xffff0000, v110
    v_and_b32 v112, 0xffff, v110
    s_mov_b64 exec, 15
    ds_write_b128 v200, v[32:35] offset:4096
    s_mov_b64 exec, 1
    ds_write2_b32 v201, v108, v109 offset0:254 offset1:255
    ds_write2_b32 v201, v111, v112 offset0:125 offset1:126
    ds_write_b32 v204, v109 offset:7228
    ds_write_b32 v204, v110 offset:6712
    s_mov_b64 exec, -1
    v_mov_b32 v5, 48136
    s_mov_b32 s53, 0
LS_56:
    ds_read_b32 v6, v5
    s_waitcnt lgkmcnt(0)
    v_readfirstlane_b32 s54, v6
    s_nop 0
    s_cmp_ge_u32 s54, 4
    s_cbranch_scc1 LD_57
    s_add_u32 s53, s53, 1
    s_cmp_gt_u32 s53, 3200000
    s_cbranch_scc1 LD_57
    s_sleep 1
    s_branch LS_56
LD_57:
    s_branch CONV
FIN7:
    s_setprio 3
    s_add_u32 s12, s86, 0x1400000
    s_addc_u32 s13, s87, 0
    s_mov_b32 s14, 0x280000
    s_mov_b32 s15, 0x20000
    s_add_u32 s16, s86, 0x1700000
    s_addc_u32 s17, s87, 0
    s_mov_b32 s18, 0x4000
    s_mov_b32 s19, 0x20000
    s_and_b32 s49, s3, 1
    s_lshl_b32 s36, s47, 2
    s_add_u32 s36, s36, s49
    s_lshl_b32 s36, s36, 5
    v_lshlrev_b32 v5, 3, v1
    s_lshl_b32 s38, s47, 9
    buffer_load_dword v6, v5, s[16:19], s38 offen offset:4 sc1
    v_lshrrev_b32 v13, 2, v1
    v_and_b32 v9, 3, v1
    v_lshlrev_b32 v8, 12, v13
    v_and_b32 v14, 1, v1
    v_lshl_add_u32 v8, v14, 6, v8
    v_and_b32 v14, 2, v1
    v_lshl_add_u32 v8, v14, 3, v8
    s_cmp_lt_u32 s2, 32
    s_cselect_b32 s37, 0xffff9900, 0
    s_add_u32 s37, s37, 0x1400
    s_mul_i32 s37, s37, s49
    s_cmp_lt_u32 s2, 32
    s_cselect_b32 s33, 0x43c0, 0
    s_add_u32 s33, s33, 0x16000
    s_add_u32 s37, s37, s33
    v_lshlrev_b32 v13, 6, v13
    v_lshl_add_u32 v13, v9, 3, v13
    v_add_u32 v9, s37, v13
    v_add_u32 v11, s37, v5
    v_lshlrev_b32 v12, 2, v1
    s_cmp_lt_u32 s2, 32
    s_cselect_b32 s33, 0xa000, 0
    s_add_u32 s33, s33, 0xa000
    v_add_u32 v12, s33, v12
    s_mul_i32 s32, s48, 327680
    s_add_u32 s32, s32, s36
    s_cmp_lt_u32 s2, 32
    s_cselect_b32 s33, 0xfffffffc, 0
    s_add_u32 s33, s33, 0x4
    v_mov_b32 v2, 48140
    s_mov_b32 s53, 0
LS_58:
    ds_read_b32 v3, v2
    s_waitcnt lgkmcnt(0)
    v_readfirstlane_b32 s54, v3
    s_nop 0
    s_cmp_ge_u32 s54, s33
    s_cbranch_scc1 LD_59
    s_add_u32 s53, s53, 1
    s_cmp_gt_u32 s53, 3200000
    s_cbranch_scc1 LD_59
    s_sleep 1
    s_branch LS_58
LD_59:
    s_cmp_lt_u32 s2, 32
    s_cselect_b32 s33, 0x1c3dc, 0
    s_add_u32 s33, s33, 0xbc20
    v_mov_b32 v2, s33
    s_mov_b32 s53, 0
LS_60:
    ds_read_b32 v3, v2
    s_waitcnt lgkmcnt(0)
    v_readfirstlane_b32 s54, v3
    s_nop 0
    s_cmp_ge_u32 s54, 1
    s_cbranch_scc1 LD_61
    s_add_u32 s53, s53, 1
    s_cmp_gt_u32 s53, 3200000
    s_cbranch_scc1 LD_61
    s_sleep 1
    s_branch LS_60
LD_61:
    v_lshl_add_u32 v14, v1, 4, s37
    v_and_b32 v2, 15, v1
    v_mul_u32_u24 v2, 160, v2
    v_lshrrev_b32 v3, 4, v1
    v_lshl_add_u32 v2, v3, 3, v2
    v_add_u32 v2, s37, v2
    ds_read_b64 v[136:137], v2 offset:0
    ds_read_b64 v[138:139], v2 offset:32
    ds_read_b64 v[140:141], v2 offset:64
    ds_read_b64 v[142:143], v2 offset:96
    ds_read_b64 v[144:145], v2 offset:128
    ds_read_b64 v[146:147], v2 offset:2560
    ds_read_b64 v[148:149], v2 offset:2592
    ds_read_b64 v[150:151], v2 offset:2624
    ds_read_b64 v[152:153], v2 offset:2656
    ds_read_b64 v[154:155], v2 offset:2688
    s_cmp_lt_u32 s2, 32
    s_cselect_b32 s33, 0x1c3b8, 0
    s_add_u32 s33, s33, 0xbc40
    v_mov_b32 v2, s33
    s_lshl_b32 s33, s49, 4
    s_lshl_b32 s33, 0x2020, s33
    v_mov_b32 v3, s33
    s_mov_b32 s39, s32
    s_waitcnt lgkmcnt(0)
    v_lshlrev_b32 v72, 16, v136
    v_and_b32 v73, 0xffff0000, v136
    v_lshlrev_b32 v74, 16, v137
    v_and_b32 v75, 0xffff0000, v137
    v_lshlrev_b32 v76, 16, v138
    v_and_b32 v77, 0xffff0000, v138
    v_lshlrev_b32 v78, 16, v139
    v_and_b32 v79, 0xffff0000, v139
    v_lshlrev_b32 v80, 16, v140
    v_and_b32 v81, 0xffff0000, v140
    v_lshlrev_b32 v82, 16, v141
    v_and_b32 v83, 0xffff0000, v141
    v_lshlrev_b32 v84, 16, v142
    v_and_b32 v85, 0xffff0000, v142
    v_lshlrev_b32 v86, 16, v143
    v_and_b32 v87, 0xffff0000, v143
    v_lshlrev_b32 v88, 16, v144
    v_and_b32 v89, 0xffff0000, v144
    v_lshlrev_b32 v90, 16, v145
    v_and_b32 v91, 0xffff0000, v145
    v_lshlrev_b32 v92, 16, v146
    v_and_b32 v93, 0xffff0000, v146
    v_lshlrev_b32 v94, 16, v147
    v_and_b32 v95, 0xffff0000, v147
    v_lshlrev_b32 v96, 16, v148
    v_and_b32 v97, 0xffff0000, v148
    v_lshlrev_b32 v98, 16, v149
    v_and_b32 v99, 0xffff0000, v149
    v_lshlrev_b32 v100, 16, v150
    v_and_b32 v101, 0xffff0000, v150
    v_lshlrev_b32 v102, 16, v151
    v_and_b32 v103, 0xffff0000, v151
    v_lshlrev_b32 v104, 16, v152
    v_and_b32 v105, 0xffff0000, v152
    v_lshlrev_b32 v106, 16, v153
    v_and_b32 v107, 0xffff0000, v153
    v_lshlrev_b32 v108, 16, v154
    v_and_b32 v109, 0xffff0000, v154
    v_lshlrev_b32 v110, 16, v155
    v_and_b32 v111, 0xffff0000, v155
    s_add_u32 s20, s39, 0
    s_add_u32 s21, s39, 65536
    s_add_u32 s22, s39, 131072
    s_add_u32 s23, s39, 196608
    s_add_u32 s24, s39, 262144
    s_cmp_lt_u32 s2, 32
    s_cselect_b32 s38, 0xffff5900, 0
    s_add_u32 s38, s38, 0x5400
    s_mul_i32 s38, s38, 0
    s_cmp_lt_u32 s2, 32
    s_cselect_b32 s40, 0x2fc0, 0
    s_add_u32 s40, s40, 0x18800
    s_add_u32 s40, s40, s38
    s_cmp_lt_u32 s2, 32
    s_cselect_b32 s38, 0xffff6780, 0
    s_add_u32 s38, s38, 0x5400
    s_mul_i32 s38, s38, 0
    s_cmp_lt_u32 s2, 32
    s_cselect_b32 s41, 0x9f40, 0
    s_add_u32 s41, s41, 0x1c400
    s_add_u32 s41, s41, s38
    s_mul_i32 s42, s49, 10240
    s_add_u32 s42, s42, s40
    s_add_u32 s40, s40, 5120
    s_cmp_eq_u32 s49, 1
    s_cselect_b32 s40, s41, s40
    v_lshl_add_u32 v21, v1, 4, s42
    v_lshl_add_u32 v22, v1, 4, s40
    s_cmp_lt_u32 s2, 32
    s_cselect_b32 s38, 0xffff5900, 0
    s_add_u32 s38, s38, 0x5400
    s_mul_i32 s38, s38, 1
    s_cmp_lt_u32 s2, 32
    s_cselect_b32 s40, 0x2fc0, 0
    s_add_u32 s40, s40, 0x18800
    s_add_u32 s40, s40, s38
    s_cmp_lt_u32 s2, 32
    s_cselect_b32 s38, 0xffff6780, 0
    s_add_u32 s38, s38, 0x5400
    s_mul_i32 s38, s38, 1
    s_cmp_lt_u32 s2, 32
    s_cselect_b32 s41, 0x9f40, 0
    s_add_u32 s41, s41, 0x1c400
    s_add_u32 s41, s41, s38
    s_mul_i32 s42, s49, 10240
    s_add_u32 s42, s42, s40
    s_add_u32 s40, s40, 5120
    s_cmp_eq_u32 s49, 1
    s_cselect_b32 s40, s41, s40
    v_lshl_add_u32 v23, v1, 4, s42
    v_lshl_add_u32 v24, v1, 4, s40
    s_lshl_b32 s43, s49, 4
    s_movk_i32 s25, 0x1818
    v_and_b32 v26, 15, v1
    s_cmp_lt_u32 s2, 32
    s_cselect_b32 s33, 0xa000, 0
    s_add_u32 s33, s33, 0xa000
    s_lshl_b32 s42, s49, 7
    s_add_u32 s33, s33, s42
    v_lshl_add_u32 v26, v26, 2, s33
    s_mov_b32 s36, 0x7fa57fa5
    s_waitcnt vmcnt(0)
    s_add_u32 m0, s37, 0
    s_nop 0
    buffer_load_dwordx4 v8, s[12:15], s20 offen sc1 lds
    s_add_u32 m0, s37, 1024
    s_nop 0
    buffer_load_dwordx4 v8, s[12:15], s21 offen sc1 lds
    s_add_u32 m0, s37, 2048
    s_nop 0
    buffer_load_dwordx4 v8, s[12:15], s22 offen sc1 lds
    s_add_u32 m0, s37, 3072
    s_nop 0
    buffer_load_dwordx4 v8, s[12:15], s23 offen sc1 lds
    s_add_u32 m0, s37, 4096
    s_nop 0
    buffer_load_dwordx4 v8, s[12:15], s24 offen sc1 lds
    ds_write_b32 v12, v6
    ds_read_b32 v60, v26
    ds_read_b32 v62, v26 offset:64
    s_cmp_lt_u32 s2, 32
    s_cselect_b32 s33, 0x1c3bc, 0
    s_add_u32 s33, s33, 0xbc10
    s_cmp_lt_u32 s2, 32
    s_cselect_b32 s35, 0x4, 0
    s_add_u32 s35, s35, 0x1
    v_mov_b32 v46, s33
    v_mov_b32 v47, 1
    s_mov_b64 exec, 1
    ds_add_rtn_u32 v47, v46, v47
    s_cmp_lt_u32 s2, 32
    s_cselect_b32 s33, 0x7000, 0
    s_add_u32 s33, s33, 0x17000
    s_lshl_b32 s32, s46, 7
    s_add_u32 s33, s33, s32
    s_waitcnt lgkmcnt(0)
    v_readfirstlane_b32 s32, v47
    s_nop 0
    s_cmp_lg_u32 s32, s35
    s_cbranch_scc1 CF_62
    v_mov_b32 v44, s50
    v_mov_b32 v45, s51
    buffer_store_dwordx2 v[44:45], v10, s[4:7], s33 offen offset:0 sc1
    s_branch CF_62x
CF_62:
    buffer_load_dword v44, v10, s[16:19], 0 offen sc1
CF_62x:
    s_mov_b64 exec, -1
    s_mov_b32 s53, 0
    s_mov_b32 s41, 0
AT_top:
    s_cmp_eq_u32 s25, 0
    s_cbranch_scc1 AT_go
    ds_read_b32 v25, v2
    s_waitcnt lgkmcnt(0)
    v_readfirstlane_b32 s33, v25
    s_nop 0
    s_lshr_b32 s33, s33, s43
    s_and_b32 s33, s33, s25
    s_lshr_b32 s40, s33, 1
    s_and_b32 s33, s33, s40
    s_cbranch_scc0 AT_na
    s_mul_i32 s40, s33, 3
    s_andn2_b32 s25, s25, s40
    s_bitcmp1_b32 s33, 3
    s_cbranch_scc0 AT_ra0
    ds_read_b128 v[168:171], v21 offset:0
    ds_read_b128 v[172:175], v23 offset:0
    ds_read_b128 v[176:179], v21 offset:1024
    ds_read_b128 v[180:183], v23 offset:1024
    ds_read_b128 v[184:187], v21 offset:2048
    ds_read_b128 v[188:191], v23 offset:2048
    ds_read_b128 v[192:195], v21 offset:3072
    ds_read_b128 v[196:199], v23 offset:3072
    ds_read_b128 v[200:203], v21 offset:4096
    ds_read_b128 v[204:207], v23 offset:4096
AT_ra0:
    s_bitcmp1_b32 s33, 11
    s_cbranch_scc0 AT_ra1
    ds_read_b128 v[208:211], v22 offset:0
    ds_read_b128 v[212:215], v24 offset:0
    ds_read_b128 v[216:219], v22 offset:1024
    ds_read_b128 v[220:223], v24 offset:1024
    ds_read_b128 v[224:227], v22 offset:2048
    ds_read_b128 v[228:231], v24 offset:2048
    ds_read_b128 v[232:235], v22 offset:3072
    ds_read_b128 v[236:239], v24 offset:3072
    ds_read_b128 v[240:243], v22 offset:4096
    ds_read_b128 v[244:247], v24 offset:4096
AT_ra1:
    s_bitcmp1_b32 s33, 3
    s_cbranch_scc0 AT_fa0
    s_waitcnt lgkmcnt(0)
    v_add_f32 v168, v168, v172
    v_add_f32 v169, v169, v173
    v_add_f32 v170, v170, v174
    v_add_f32 v171, v171, v175
    v_fma_f32 v72, v168, v60, v72
    v_fma_f32 v73, v169, v60, v73
    v_fma_f32 v74, v170, v60, v74
    v_fma_f32 v75, v171, v60, v75
    v_add_f32 v176, v176, v180
    v_add_f32 v177, v177, v181
    v_add_f32 v178, v178, v182
    v_add_f32 v179, v179, v183
    v_fma_f32 v76, v176, v60, v76
    v_fma_f32 v77, v177, v60, v77
    v_fma_f32 v78, v178, v60, v78
    v_fma_f32 v79, v179, v60, v79
    v_add_f32 v184, v184, v188
    v_add_f32 v185, v185, v189
    v_add_f32 v186, v186, v190
    v_add_f32 v187, v187, v191
    v_fma_f32 v80, v184, v60, v80
    v_fma_f32 v81, v185, v60, v81
    v_fma_f32 v82, v186, v60, v82
    v_fma_f32 v83, v187, v60, v83
    v_add_f32 v192, v192, v196
    v_add_f32 v193, v193, v197
    v_add_f32 v194, v194, v198
    v_add_f32 v195, v195, v199
    v_fma_f32 v84, v192, v60, v84
    v_fma_f32 v85, v193, v60, v85
    v_fma_f32 v86, v194, v60, v86
    v_fma_f32 v87, v195, v60, v87
    v_add_f32 v200, v200, v204
    v_add_f32 v201, v201, v205
    v_add_f32 v202, v202, v206
    v_add_f32 v203, v203, v207
    v_fma_f32 v88, v200, v60, v88
    v_fma_f32 v89, v201, v60, v89
    v_fma_f32 v90, v202, v60, v90
    v_fma_f32 v91, v203, v60, v91
AT_fa0:
    s_bitcmp1_b32 s33, 11
    s_cbranch_scc0 AT_fa1
    s_waitcnt lgkmcnt(8)
    v_add_f32 v208, v208, v212
    v_add_f32 v209, v209, v213
    v_add_f32 v210, v210, v214
    v_add_f32 v211, v211, v215
    v_fma_f32 v92, v208, v62, v92
    v_fma_f32 v93, v209, v62, v93
    v_fma_f32 v94, v210, v62, v94
    v_fma_f32 v95, v211, v62, v95
    s_waitcnt lgkmcnt(6)
    v_add_f32 v216, v216, v220
    v_add_f32 v217, v217, v221
    v_add_f32 v218, v218, v222
    v_add_f32 v219, v219, v223
    v_fma_f32 v96, v216, v62, v96
    v_fma_f32 v97, v217, v62, v97
    v_fma_f32 v98, v218, v62, v98
    v_fma_f32 v99, v219, v62, v99
    s_waitcnt lgkmcnt(4)
    v_add_f32 v224, v224, v228
    v_add_f32 v225, v225, v229
    v_add_f32 v226, v226, v230
    v_add_f32 v227, v227, v231
    v_fma_f32 v100, v224, v62, v100
    v_fma_f32 v101, v225, v62, v101
    v_fma_f32 v102, v226, v62, v102
    v_fma_f32 v103, v227, v62, v103
    s_waitcnt lgkmcnt(2)
    v_add_f32 v232, v232, v236
    v_add_f32 v233, v233, v237
    v_add_f32 v234, v234, v238
    v_add_f32 v235, v235, v239
    v_fma_f32 v104, v232, v62, v104
    v_fma_f32 v105, v233, v62, v105
    v_fma_f32 v106, v234, v62, v106
    v_fma_f32 v107, v235, v62, v107
    s_waitcnt lgkmcnt(0)
    v_add_f32 v240, v240, v244
    v_add_f32 v241, v241, v245
    v_add_f32 v242, v242, v246
    v_add_f32 v243, v243, v247
    v_fma_f32 v108, v240, v62, v108
    v_fma_f32 v109, v241, v62, v109
    v_fma_f32 v110, v242, v62, v110
    v_fma_f32 v111, v243, v62, v111
AT_fa1:
AT_na:
    s_getreg_b32 s33, hwreg(HW_REG_IB_STS, 0, 4)
    s_cmp_eq_u32 s53, 0
    s_cselect_b32 s40, 1, 0
    s_add_u32 s41, s41, 1
    s_cmp_gt_u32 s41, 200000
    s_cselect_b32 s33, 0, s33
    s_cmp_gt_u32 s33, s40
    s_cbranch_scc1 AT_top
AT_go:
    s_cmp_eq_u32 s53, 0
    s_cbranch_scc1 AT_w1
    s_waitcnt vmcnt(0)
AT_w1:
    s_waitcnt vmcnt(1)
AT_chk:
    ds_read_b32 v16, v14 offset:0
    ds_read_b32 v17, v14 offset:1024
    ds_read_b32 v18, v14 offset:2048
    ds_read_b32 v19, v14 offset:3072
    ds_read_b32 v20, v14 offset:4096
    ds_read_b64_tr_b16 v[136:137], v9 offset:0
    ds_read_b64_tr_b16 v[138:139], v9 offset:1024
    ds_read_b64_tr_b16 v[140:141], v9 offset:2048
    ds_read_b64_tr_b16 v[142:143], v9 offset:3072
    ds_read_b64_tr_b16 v[144:145], v9 offset:4096
    ds_read_b64_tr_b16 v[146:147], v9 offset:32
    ds_read_b64_tr_b16 v[148:149], v9 offset:1056
    ds_read_b64_tr_b16 v[150:151], v9 offset:2080
    ds_read_b64_tr_b16 v[152:153], v9 offset:3104
    ds_read_b64_tr_b16 v[154:155], v9 offset:4128
    s_waitcnt lgkmcnt(10)
    v_cmp_eq_u32 s[26:27], s36, v16
    v_cmp_eq_u32 s[28:29], s36, v17
    v_cmp_eq_u32 s[30:31], s36, v18
    v_cmp_eq_u32 s[32:33], s36, v19
    v_cmp_eq_u32 s[34:35], s36, v20
    s_or_b64 s[54:55], s[26:27], s[28:29]
    s_or_b64 s[56:57], s[30:31], s[32:33]
    s_or_b64 s[54:55], s[54:55], s[34:35]
    s_or_b64 s[54:55], s[54:55], s[56:57]
    s_cbranch_scc1 AT_again
AT_ok:
    s_cmp_lg_u32 s25, 0
    s_cbranch_scc1 AT_late
    s_waitcnt lgkmcnt(9)
    v_lshlrev_b32 v160, 16, v136
    v_and_b32 v161, 0xffff0000, v136
    v_lshlrev_b32 v162, 16, v137
    v_and_b32 v163, 0xffff0000, v137
    v_add_f32 v72, v160, v72
    v_add_f32 v73, v161, v73
    v_add_f32 v74, v162, v74
    v_add_f32 v75, v163, v75
    ds_write_b128 v21, v[72:75] offset:0
    s_waitcnt lgkmcnt(9)
    v_lshlrev_b32 v164, 16, v138
    v_and_b32 v165, 0xffff0000, v138
    v_lshlrev_b32 v166, 16, v139
    v_and_b32 v167, 0xffff0000, v139
    v_add_f32 v76, v164, v76
    v_add_f32 v77, v165, v77
    v_add_f32 v78, v166, v78
    v_add_f32 v79, v167, v79
    ds_write_b128 v21, v[76:79] offset:1024
    s_waitcnt lgkmcnt(9)
    v_lshlrev_b32 v160, 16, v140
    v_and_b32 v161, 0xffff0000, v140
    v_lshlrev_b32 v162, 16, v141
    v_and_b32 v163, 0xffff0000, v141
    v_add_f32 v80, v160, v80
    v_add_f32 v81, v161, v81
    v_add_f32 v82, v162, v82
    v_add_f32 v83, v163, v83
    ds_write_b128 v21, v[80:83] offset:2048
    s_waitcnt lgkmcnt(9)
    v_lshlrev_b32 v164, 16, v142
    v_and_b32 v165, 0xffff0000, v142
    v_lshlrev_b32 v166, 16, v143
    v_and_b32 v167, 0xffff0000, v143
    v_add_f32 v84, v164, v84
    v_add_f32 v85, v165, v85
    v_add_f32 v86, v166, v86
    v_add_f32 v87, v167, v87
    ds_write_b128 v21, v[84:87] offset:3072
    s_waitcnt lgkmcnt(9)
    v_lshlrev_b32 v160, 16, v144
    v_and_b32 v161, 0xffff0000, v144
    v_lshlrev_b32 v162, 16, v145
    v_and_b32 v163, 0xffff0000, v145
    v_add_f32 v88, v160, v88
    v_add_f32 v89, v161, v89
    v_add_f32 v90, v162, v90
    v_add_f32 v91, v163, v91
    ds_write_b128 v21, v[88:91] offset:4096
    s_waitcnt lgkmcnt(9)
    v_lshlrev_b32 v164, 16, v146
    v_and_b32 v165, 0xffff0000, v146
    v_lshlrev_b32 v166, 16, v147
    v_and_b32 v167, 0xffff0000, v147
    v_add_f32 v92, v164, v92
    v_add_f32 v93, v165, v93
    v_add_f32 v94, v166, v94
    v_add_f32 v95, v167, v95
    ds_write_b128 v22, v[92:95] offset:0
    s_waitcnt lgkmcnt(9)
    v_lshlrev_b32 v160, 16, v148
    v_and_b32 v161, 0xffff0000, v148
    v_lshlrev_b32 v162, 16, v149
    v_and_b32 v163, 0xffff0000, v149
    v_add_f32 v96, v160, v96
    v_add_f32 v97, v161, v97
    v_add_f32 v98, v162, v98
    v_add_f32 v99, v163, v99
    ds_write_b128 v22, v[96:99] offset:1024
    s_waitcnt lgkmcnt(9)
    v_lshlrev_b32 v164, 16, v150
    v_and_b32 v165, 0xffff0000, v150
    v_lshlrev_b32 v166, 16, v151
    v_and_b32 v167, 0xffff0000, v151
    v_add_f32 v100, v164, v100
    v_add_f32 v101, v165, v101
    v_add_f32 v102, v166, v102
    v_add_f32 v103, v167, v103
    ds_write_b128 v22, v[100:103] offset:2048
    s_waitcnt lgkmcnt(9)
    v_lshlrev_b32 v160, 16, v152
    v_and_b32 v161, 0xffff0000, v152
    v_lshlrev_b32 v162, 16, v153
    v_and_b32 v163, 0xffff0000, v153
    v_add_f32 v104, v160, v104
    v_add_f32 v105, v161, v105
    v_add_f32 v106, v162, v106
    v_add_f32 v107, v163, v107
    ds_write_b128 v22, v[104:107] offset:3072
    s_waitcnt lgkmcnt(9)
    v_lshlrev_b32 v164, 16, v154
    v_and_b32 v165, 0xffff0000, v154
    v_lshlrev_b32 v166, 16, v155
    v_and_b32 v167, 0xffff0000, v155
    v_add_f32 v108, v164, v108
    v_add_f32 v109, v165, v109
    v_add_f32 v110, v166, v110
    v_add_f32 v111, v167, v111
    ds_write_b128 v22, v[108:111] offset:4096
AT_sig:
    s_mov_b64 exec, 1
    ds_add_u32 v2, v3
    s_waitcnt lgkmcnt(0)
    s_endpgm
AT_again:
    s_add_u32 s53, s53, 1
    s_cmp_gt_u32 s53, 200000
    s_cbranch_scc1 AT_ok
    s_waitcnt lgkmcnt(0)
    s_sleep 2
    s_cmp_eq_u64 s[26:27], 0
    s_cbranch_scc1 AT_s0
    s_add_u32 m0, s37, 0
    s_nop 0
    buffer_load_dwordx4 v8, s[12:15], s20 offen sc1 lds
AT_s0:
    s_cmp_eq_u64 s[28:29], 0
    s_cbranch_scc1 AT_s1
    s_add_u32 m0, s37, 1024
    s_nop 0
    buffer_load_dwordx4 v8, s[12:15], s21 offen sc1 lds
AT_s1:
    s_cmp_eq_u64 s[30:31], 0
    s_cbranch_scc1 AT_s2
    s_add_u32 m0, s37, 2048
    s_nop 0
    buffer_load_dwordx4 v8, s[12:15], s22 offen sc1 lds
AT_s2:
    s_cmp_eq_u64 s[32:33], 0
    s_cbranch_scc1 AT_s3
    s_add_u32 m0, s37, 3072
    s_nop 0
    buffer_load_dwordx4 v8, s[12:15], s23 offen sc1 lds
AT_s3:
    s_cmp_eq_u64 s[34:35], 0
    s_cbranch_scc1 AT_s4
    s_add_u32 m0, s37, 4096
    s_nop 0
    buffer_load_dwordx4 v8, s[12:15], s24 offen sc1 lds
AT_s4:
    s_branch AT_top
AT_late:
    s_waitcnt lgkmcnt(9)
    v_lshlrev_b32 v112, 16, v136
    v_and_b32 v113, 0xffff0000, v136
    v_lshlrev_b32 v114, 16, v137
    v_and_b32 v115, 0xffff0000, v137
    s_waitcnt lgkmcnt(8)
    v_lshlrev_b32 v116, 16, v138
    v_and_b32 v117, 0xffff0000, v138
    v_lshlrev_b32 v118, 16, v139
    v_and_b32 v119, 0xffff0000, v139
    s_waitcnt lgkmcnt(7)
    v_lshlrev_b32 v120, 16, v140
    v_and_b32 v121, 0xffff0000, v140
    v_lshlrev_b32 v122, 16, v141
    v_and_b32 v123, 0xffff0000, v141
    s_waitcnt lgkmcnt(6)
    v_lshlrev_b32 v124, 16, v142
    v_and_b32 v125, 0xffff0000, v142
    v_lshlrev_b32 v126, 16, v143
    v_and_b32 v127, 0xffff0000, v143
    s_waitcnt lgkmcnt(5)
    v_lshlrev_b32 v128, 16, v144
    v_and_b32 v129, 0xffff0000, v144
    v_lshlrev_b32 v130, 16, v145
    v_and_b32 v131, 0xffff0000, v145
    s_waitcnt lgkmcnt(4)
    v_lshlrev_b32 v132, 16, v146
    v_and_b32 v133, 0xffff0000, v146
    v_lshlrev_b32 v134, 16, v147
    v_and_b32 v135, 0xffff0000, v147
    s_waitcnt lgkmcnt(3)
    v_lshlrev_b32 v160, 16, v148
    v_and_b32 v161, 0xffff0000, v148
    v_lshlrev_b32 v162, 16, v149
    v_and_b32 v163, 0xffff0000, v149
    s_waitcnt lgkmcnt(2)
    v_lshlrev_b32 v164, 16, v150
    v_and_b32 v165, 0xffff0000, v150
    v_lshlrev_b32 v166, 16, v151
    v_and_b32 v167, 0xffff0000, v151
    s_waitcnt lgkmcnt(1)
    v_lshlrev_b32 v248, 16, v152
    v_and_b32 v249, 0xffff0000, v152
    v_lshlrev_b32 v250, 16, v153
    v_and_b32 v251, 0xffff0000, v153
    s_waitcnt lgkmcnt(0)
    v_lshlrev_b32 v252, 16, v154
    v_and_b32 v253, 0xffff0000, v154
    v_lshlrev_b32 v254, 16, v155
    v_and_b32 v255, 0xffff0000, v155
    s_mov_b32 s53, 0
    s_mov_b32 s42, 0x18
    v_and_b32 v4, 0xff00ff, v3
AT_ll:
    ds_read_b32 v25, v2
    s_waitcnt lgkmcnt(0)
    v_readfirstlane_b32 s33, v25
    s_nop 0
    s_lshr_b32 s33, s33, s43
    s_and_b32 s33, s33, s25
    s_lshr_b32 s40, s33, 1
    s_and_b32 s33, s33, s40
    s_cbranch_scc0 AT_nb
    s_mul_i32 s40, s33, 3
    s_andn2_b32 s25, s25, s40
    s_bitcmp1_b32 s33, 3
    s_cbranch_scc0 AT_rb0
    ds_read_b128 v[168:171], v21 offset:0
    ds_read_b128 v[172:175], v23 offset:0
    ds_read_b128 v[176:179], v21 offset:1024
    ds_read_b128 v[180:183], v23 offset:1024
    ds_read_b128 v[184:187], v21 offset:2048
    ds_read_b128 v[188:191], v23 offset:2048
    ds_read_b128 v[192:195], v21 offset:3072
    ds_read_b128 v[196:199], v23 offset:3072
    ds_read_b128 v[200:203], v21 offset:4096
    ds_read_b128 v[204:207], v23 offset:4096
AT_rb0:
    s_bitcmp1_b32 s33, 11
    s_cbranch_scc0 AT_rb1
    ds_read_b128 v[208:211], v22 offset:0
    ds_read_b128 v[212:215], v24 offset:0
    ds_read_b128 v[216:219], v22 offset:1024
    ds_read_b128 v[220:223], v24 offset:1024
    ds_read_b128 v[224:227], v22 offset:2048
    ds_read_b128 v[228:231], v24 offset:2048
    ds_read_b128 v[232:235], v22 offset:3072
    ds_read_b128 v[236:239], v24 offset:3072
    ds_read_b128 v[240:243], v22 offset:4096
    ds_read_b128 v[244:247], v24 offset:4096
AT_rb1:
    s_bitcmp1_b32 s33, 3
    s_cbranch_scc0 AT_fb0
    s_waitcnt lgkmcnt(0)
    v_add_f32 v168, v168, v172
    v_add_f32 v169, v169, v173
    v_add_f32 v170, v170, v174
    v_add_f32 v171, v171, v175
    v_fma_f32 v72, v168, v60, v72
    v_fma_f32 v73, v169, v60, v73
    v_fma_f32 v74, v170, v60, v74
    v_fma_f32 v75, v171, v60, v75
    v_add_f32 v176, v176, v180
    v_add_f32 v177, v177, v181
    v_add_f32 v178, v178, v182
    v_add_f32 v179, v179, v183
    v_fma_f32 v76, v176, v60, v76
    v_fma_f32 v77, v177, v60, v77
    v_fma_f32 v78, v178, v60, v78
    v_fma_f32 v79, v179, v60, v79
    v_add_f32 v184, v184, v188
    v_add_f32 v185, v185, v189
    v_add_f32 v186, v186, v190
    v_add_f32 v187, v187, v191
    v_fma_f32 v80, v184, v60, v80
    v_fma_f32 v81, v185, v60, v81
    v_fma_f32 v82, v186, v60, v82
    v_fma_f32 v83, v187, v60, v83
    v_add_f32 v192, v192, v196
    v_add_f32 v193, v193, v197
    v_add_f32 v194, v194, v198
    v_add_f32 v195, v195, v199
    v_fma_f32 v84, v192, v60, v84
    v_fma_f32 v85, v193, v60, v85
    v_fma_f32 v86, v194, v60, v86
    v_fma_f32 v87, v195, v60, v87
    v_add_f32 v200, v200, v204
    v_add_f32 v201, v201, v205
    v_add_f32 v202, v202, v206
    v_add_f32 v203, v203, v207
    v_fma_f32 v88, v200, v60, v88
    v_fma_f32 v89, v201, v60, v89
    v_fma_f32 v90, v202, v60, v90
    v_fma_f32 v91, v203, v60, v91
AT_fb0:
    s_bitcmp1_b32 s33, 11
    s_cbranch_scc0 AT_fb1
    s_waitcnt lgkmcnt(8)
    v_add_f32 v208, v208, v212
    v_add_f32 v209, v209, v213
    v_add_f32 v210, v210, v214
    v_add_f32 v211, v211, v215
    v_fma_f32 v92, v208, v62, v92
    v_fma_f32 v93, v209, v62, v93
    v_fma_f32 v94, v210, v62, v94
    v_fma_f32 v95, v211, v62, v95
    s_waitcnt lgkmcnt(6)
    v_add_f32 v216, v216, v220
    v_add_f32 v217, v217, v221
    v_add_f32 v218, v218, v222
    v_add_f32 v219, v219, v223
    v_fma_f32 v96, v216, v62, v96
    v_fma_f32 v97, v217, v62, v97
    v_fma_f32 v98, v218, v62, v98
    v_fma_f32 v99, v219, v62, v99
    s_waitcnt lgkmcnt(4)
    v_add_f32 v224, v224, v228
    v_add_f32 v225, v225, v229
    v_add_f32 v226, v226, v230
    v_add_f32 v227, v227, v231
    v_fma_f32 v100, v224, v62, v100
    v_fma_f32 v101, v225, v62, v101
    v_fma_f32 v102, v226, v62, v102
    v_fma_f32 v103, v227, v62, v103
    s_waitcnt lgkmcnt(2)
    v_add_f32 v232, v232, v236
    v_add_f32 v233, v233, v237
    v_add_f32 v234, v234, v238
    v_add_f32 v235, v235, v239
    v_fma_f32 v104, v232, v62, v104
    v_fma_f32 v105, v233, v62, v105
    v_fma_f32 v106, v234, v62, v106
    v_fma_f32 v107, v235, v62, v107
    s_waitcnt lgkmcnt(0)
    v_add_f32 v240, v240, v244
    v_add_f32 v241, v241, v245
    v_add_f32 v242, v242, v246
    v_add_f32 v243, v243, v247
    v_fma_f32 v108, v240, v62, v108
    v_fma_f32 v109, v241, v62, v109
    v_fma_f32 v110, v242, v62, v110
    v_fma_f32 v111, v243, v62, v111
AT_fb1:
AT_nb:
    s_and_b32 s33, s25, s42
    s_cbranch_scc1 AT_l1
    s_cmp_eq_u32 s42, 0
    s_cbranch_scc1 AT_l1
    s_mov_b32 s42, 0
    v_add_f32 v72, v112, v72
    v_add_f32 v73, v113, v73
    v_add_f32 v74, v114, v74
    v_add_f32 v75, v115, v75
    ds_write_b128 v21, v[72:75] offset:0
    v_add_f32 v76, v116, v76
    v_add_f32 v77, v117, v77
    v_add_f32 v78, v118, v78
    v_add_f32 v79, v119, v79
    ds_write_b128 v21, v[76:79] offset:1024
    v_add_f32 v80, v120, v80
    v_add_f32 v81, v121, v81
    v_add_f32 v82, v122, v82
    v_add_f32 v83, v123, v83
    ds_write_b128 v21, v[80:83] offset:2048
    v_add_f32 v84, v124, v84
    v_add_f32 v85, v125, v85
    v_add_f32 v86, v126, v86
    v_add_f32 v87, v127, v87
    ds_write_b128 v21, v[84:87] offset:3072
    v_add_f32 v88, v128, v88
    v_add_f32 v89, v129, v89
    v_add_f32 v90, v130, v90
    v_add_f32 v91, v131, v91
    ds_write_b128 v21, v[88:91] offset:4096
    v_sub_u32 v3, v3, v4
    s_mov_b64 exec, 1
    ds_add_u32 v2, v4
    s_mov_b64 exec, -1
AT_l1:
    s_add_u32 s53, s53, 1
    s_cmp_gt_u32 s53, 3200000
    s_cbranch_scc1 AT_l2
    s_or_b32 s33, s25, s42
    s_cbranch_scc1 AT_ll
AT_l2:
    v_add_f32 v92, v132, v92
    v_add_f32 v93, v133, v93
    v_add_f32 v94, v134, v94
    v_add_f32 v95, v135, v95
    ds_write_b128 v22, v[92:95] offset:0
    v_add_f32 v96, v160, v96
    v_add_f32 v97, v161, v97
    v_add_f32 v98, v162, v98
    v_add_f32 v99, v163, v99
    ds_write_b128 v22, v[96:99] offset:1024
    v_add_f32 v100, v164, v100
    v_add_f32 v101, v165, v101
    v_add_f32 v102, v166, v102
    v_add_f32 v103, v167, v103
    ds_write_b128 v22, v[100:103] offset:2048
    v_add_f32 v104, v248, v104
    v_add_f32 v105, v249, v105
    v_add_f32 v106, v250, v106
    v_add_f32 v107, v251, v107
    ds_write_b128 v22, v[104:107] offset:3072
    v_add_f32 v108, v252, v108
    v_add_f32 v109, v253, v109
    v_add_f32 v110, v254, v110
    v_add_f32 v111, v255, v111
    ds_write_b128 v22, v[108:111] offset:4096
    s_branch AT_sig
SIDE:
    s_and_b32 s46, s32, 1
    s_lshl_b32 s46, s46, 4
    s_lshr_b32 s34, s32, 1
    s_lshl_b32 s34, s34, 2
    s_add_u32 s46, s46, s34
    s_add_u32 s46, s46, s33
    v_mov_b32 v60, 0
    v_mov_b32 v61, 0
    v_mov_b32 v62, 0
    v_mov_b32 v63, 0
    v_mov_b32 v64, 163776
    ds_write_b128 v64, v[60:63]
    ds_write_b128 v64, v[60:63] offset:16
    ds_write_b128 v64, v[60:63] offset:32
    ds_write_b128 v64, v[60:63] offset:48
    s_waitcnt lgkmcnt(0)
    s_mul_i32 s49, s46, 6
    s_add_u32 s49, s49, s3
    s_add_u32 s49, s49, 444
    s_mov_b32 s8, s62
    s_mov_b32 s9, s63
    s_mov_b32 s10, 0x28000
    s_mov_b32 s11, 0x20000
    s_mov_b32 s12, s64
    s_mov_b32 s13, s65
    s_mov_b32 s14, 0x28000
    s_mov_b32 s15, 0x20000
    s_mov_b32 s16, s66
    s_mov_b32 s17, s67
    s_mov_b32 s18, 0x28000
    s_mov_b32 s19, 0x20000
    s_mov_b32 s20, s68
    s_mov_b32 s21, s69
    s_mov_b32 s22, 0x28000
    s_mov_b32 s23, 0x20000
    s_mov_b32 s24, s70
    s_mov_b32 s25, s71
    s_mov_b32 s26, 0x500
    s_mov_b32 s27, 0x20000
    s_and_b32 s45, s3, 2
    s_sub_u32 s45, 8, s45
    s_cmp_ge_u32 s3, 4
    s_cselect_b32 s45, 0, s45
    s_add_u32 s45, s49, s45
    v_lshlrev_b32 v2, 2, v1
    s_lshl_b32 s32, s45, 8
    s_lshl_b32 s33, s45, 1
    v_mov_b32 v11, 0
    buffer_load_ushort v9, v11, s[24:27], s33 offen
    buffer_load_dword v5, v2, s[8:11], s32 offen nt
    buffer_load_dword v6, v2, s[12:15], s32 offen nt
    buffer_load_dword v7, v2, s[16:19], s32 offen nt
    buffer_load_dword v8, v2, s[20:23], s32 offen nt
    s_mov_b32 s8, s60
    s_mov_b32 s9, s61
    s_mov_b32 s10, 0x280000
    s_mov_b32 s11, 0x20000
    s_mov_b32 s28, s84
    s_mov_b32 s29, s85
    s_mov_b32 s30, 0x100
    s_mov_b32 s31, 0x20000
    s_lshl_b32 s33, s2, 3
    s_add_u32 s33, s33, s3
    s_cmp_lg_u32 s33, 4
    s_cbranch_scc1 S_notag
    s_memrealtime s[50:51]
    s_waitcnt lgkmcnt(0)
    s_or_b32 s50, s50, 1
    v_mov_b32 v62, s50
    v_mov_b32 v63, s51
    buffer_store_dwordx2 v[62:63], v60, s[28:31], 0 offen offset:0 sc1
S_notag:
    v_and_b32 v2, 15, v1
    v_lshrrev_b32 v3, 4, v1
    v_mul_u32_u24 v3, 2560, v3
    v_lshl_add_u32 v15, v2, 4, v3
    s_lshl_b32 s32, s46, 3
    s_add_u32 s32, s32, s3
    s_lshl_b32 s56, s32, 6
    s_lshl_b32 s57, s32, 7
    s_mul_i32 s32, s32, 10240
    s_barrier
    s_cmp_ge_u32 s3, 4
    s_cbranch_scc1 S_x
    buffer_load_dwordx4 v[72:75], v15, s[8:11], s32 offen offset:0
    buffer_load_dwordx4 v[76:79], v15, s[8:11], s32 offen offset:256
    buffer_load_dwordx4 v[80:83], v15, s[8:11], s32 offen offset:512
    buffer_load_dwordx4 v[84:87], v15, s[8:11], s32 offen offset:768
    buffer_load_dwordx4 v[88:91], v15, s[8:11], s32 offen offset:1024
    buffer_load_dwordx4 v[92:95], v15, s[8:11], s32 offen offset:1280
    buffer_load_dwordx4 v[96:99], v15, s[8:11], s32 offen offset:1536
    buffer_load_dwordx4 v[100:103], v15, s[8:11], s32 offen offset:1792
    buffer_load_dwordx4 v[104:107], v15, s[8:11], s32 offen offset:2048
    buffer_load_dwordx4 v[108:111], v15, s[8:11], s32 offen offset:2304
S_x:
    s_add_u32 s4, s86, 0x1800000
    s_addc_u32 s5, s87, 0
    s_mov_b32 s6, 0x4b000
    s_mov_b32 s7, 0x20000
    s_add_u32 s12, s86, 0x1700000
    s_addc_u32 s13, s87, 0
    s_mov_b32 s14, 0x4000
    s_mov_b32 s15, 0x20000
    s_add_u32 s16, s86, 0x300000
    s_addc_u32 s17, s87, 0
    s_mov_b32 s18, 0x280000
    s_mov_b32 s19, 0x20000
    s_sub_u32 s33, s3, 5
    s_mul_i32 s44, s33, 21248
    s_sub_u32 s44, 128704, s44
    s_cmp_eq_u32 s3, 4
    s_cselect_b32 s44, 146240, s44
    s_cmp_ge_u32 s3, 6
    s_cselect_b32 s58, 2, 1
    s_cselect_b32 s35, 4608, 1
    s_max_u32 s35, s35, 512
    s_add_u32 s35, s44, s35
    s_add_u32 s34, s44, 4608
    s_cmp_ge_u32 s3, 4
    s_cbranch_scc1 S_r
    s_mul_i32 s34, s3, 21248
    s_sub_u32 s34, 120384, s34
    s_lshl_b32 s35, s3, 14
S_r:
    v_mov_b32 v4, 0
    v_lshlrev_b32 v208, 3, v1
    v_xor_b32 v209, 16, v208
    v_xor_b32 v210, 32, v208
    v_xor_b32 v211, 48, v208
    v_xor_b32 v212, 64, v208
    v_xor_b32 v213, 80, v208
    v_xor_b32 v214, 96, v208
    v_xor_b32 v215, 112, v208
    v_xor_b32 v216, 128, v208
    v_xor_b32 v217, 144, v208
    v_xor_b32 v218, 160, v208
    v_xor_b32 v219, 176, v208
    v_xor_b32 v220, 192, v208
    v_xor_b32 v221, 208, v208
    v_xor_b32 v222, 224, v208
    v_xor_b32 v223, 240, v208
    v_add_u32 v208, s35, v208
    v_add_u32 v209, s35, v209
    v_add_u32 v210, s35, v210
    v_add_u32 v211, s35, v211
    v_add_u32 v212, s35, v212
    v_add_u32 v213, s35, v213
    v_add_u32 v214, s35, v214
    v_add_u32 v215, s35, v215
    v_add_u32 v216, s35, v216
    v_add_u32 v217, s35, v217
    v_add_u32 v218, s35, v218
    v_add_u32 v219, s35, v219
    v_add_u32 v220, s35, v220
    v_add_u32 v221, s35, v221
    v_add_u32 v222, s35, v222
    v_add_u32 v223, s35, v223
    v_and_b32 v2, 15, v1
    v_lshrrev_b32 v3, 5, v1
    v_xor_b32 v3, v3, v2
    v_lshlrev_b32 v3, 4, v3
    v_and_b32 v2, 31, v1
    v_lshl_add_u32 v224, v2, 9, v3
    v_xor_b32 v225, 32, v224
    v_xor_b32 v226, 64, v224
    v_xor_b32 v227, 96, v224
    v_xor_b32 v228, 128, v224
    v_xor_b32 v229, 160, v224
    v_xor_b32 v230, 192, v224
    v_xor_b32 v231, 224, v224
    v_add_u32 v224, s35, v224
    v_add_u32 v225, s35, v225
    v_add_u32 v226, s35, v226
    v_add_u32 v227, s35, v227
    v_add_u32 v228, s35, v228
    v_add_u32 v229, s35, v229
    v_add_u32 v230, s35, v230
    v_add_u32 v231, s35, v231
    s_mov_b32 s36, 0x3fb8aa3b
    s_mov_b32 s37, 0x32a57060
    s_mov_b32 s38, 0x3f317218
    s_mov_b32 s39, 0x31dc9c88
    s_cmp_ge_u32 s3, 4
    s_cbranch_scc1 S_pre
    s_waitcnt vmcnt(10)
    v_lshlrev_b32 v9, 16, v9
    v_mul_f32 v11, s36, v9
    v_fma_f32 v12, v9, s36, -v11
    v_fma_f32 v12, v9, s37, v12
    v_exp_f32 v11, v11
    v_mul_f32 v12, s38, v12
    v_fma_f32 v10, v11, v12, v11
    v_cvt_pk_bf16_f32 v10, v10, v10
    v_and_b32 v10, 0xffff0000, v10
    v_lshlrev_b32 v60, 16, v5
    v_and_b32 v61, 0xffff0000, v5
    v_lshlrev_b32 v62, 16, v6
    v_and_b32 v63, 0xffff0000, v6
    v_mul_f32 v11, s36, v60
    v_fma_f32 v12, v60, s36, -v11
    v_fma_f32 v12, v60, s37, v12
    v_exp_f32 v11, v11
    v_mul_f32 v12, s38, v12
    v_fma_f32 v60, v11, v12, v11
    v_cvt_pk_bf16_f32 v60, v60, v60
    v_and_b32 v60, 0xffff0000, v60
    v_mul_f32_e64 v60, -v60, v10
    v_mul_f32 v62, v62, v10
    v_mul_f32 v11, s36, v61
    v_fma_f32 v12, v61, s36, -v11
    v_fma_f32 v12, v61, s37, v12
    v_exp_f32 v11, v11
    v_mul_f32 v12, s38, v12
    v_fma_f32 v61, v11, v12, v11
    v_cvt_pk_bf16_f32 v61, v61, v61
    v_and_b32 v61, 0xffff0000, v61
    v_mul_f32_e64 v61, -v61, v10
    v_mul_f32 v63, v63, v10
    s_mov_b32 s40, 0x4138aa3b
    s_mov_b32 s41, 0x41000000
    v_mul_f32 v52, s40, v60
    v_mul_f32 v54, s40, v61
    v_mul_f32 v56, s41, v62
    v_mul_f32 v58, s41, v63
    v_exp_f32 v52, v52
    v_exp_f32 v54, v54
    v_mul_f32 v57, 0.15915494, v56
    v_mul_f32 v59, 0.15915494, v58
    v_fma_f32 v53, v56, 0.15915494, -v57
    v_fma_f32 v55, v58, 0.15915494, -v59
    v_fma_f32 v53, v56, s39, v53
    v_fma_f32 v55, v58, s39, v55
    v_fract_f32 v57, v57
    v_fract_f32 v59, v59
    v_add_f32 v57, v57, v53
    v_add_f32 v59, v59, v55
    v_cos_f32 v20, v57
    v_cos_f32 v22, v59
    v_sin_f32 v21, v57
    v_sin_f32 v23, v59
    v_mul_f32 v20, v20, v52
    v_mul_f32 v22, v22, v54
    v_mul_f32 v21, v21, v52
    v_mul_f32 v23, v23, v54
    s_mov_b32 s40, 0x3fb8aa3b
    s_mov_b32 s41, 0x3f800000
    v_mul_f32 v52, s40, v60
    v_mul_f32 v54, s40, v61
    v_mul_f32 v56, s41, v62
    v_mul_f32 v58, s41, v63
    v_exp_f32 v52, v52
    v_exp_f32 v54, v54
    v_mul_f32 v57, 0.15915494, v56
    v_mul_f32 v59, 0.15915494, v58
    v_fma_f32 v53, v56, 0.15915494, -v57
    v_fma_f32 v55, v58, 0.15915494, -v59
    v_fma_f32 v53, v56, s39, v53
    v_fma_f32 v55, v58, s39, v55
    v_fract_f32 v57, v57
    v_fract_f32 v59, v59
    v_add_f32 v57, v57, v53
    v_add_f32 v59, v59, v55
    v_cos_f32 v16, v57
    v_cos_f32 v18, v59
    v_sin_f32 v17, v57
    v_sin_f32 v19, v59
    v_mul_f32 v16, v16, v52
    v_mul_f32 v18, v18, v54
    v_mul_f32 v17, v17, v52
    v_mul_f32 v19, v19, v54
    s_mov_b32 s40, 0x43b8aa3b
    s_mov_b32 s41, 0x43800000
    v_mul_f32 v52, s40, v60
    v_mul_f32 v54, s40, v61
    v_mul_f32 v56, s41, v62
    v_mul_f32 v58, s41, v63
    v_exp_f32 v52, v52
    v_exp_f32 v54, v54
    v_mul_f32 v57, 0.15915494, v56
    v_mul_f32 v59, 0.15915494, v58
    v_fma_f32 v53, v56, 0.15915494, -v57
    v_fma_f32 v55, v58, 0.15915494, -v59
    v_fma_f32 v53, v56, s39, v53
    v_fma_f32 v55, v58, s39, v55
    v_fract_f32 v57, v57
    v_fract_f32 v59, v59
    v_add_f32 v57, v57, v53
    v_add_f32 v59, v59, v55
    v_cos_f32 v24, v57
    v_cos_f32 v26, v59
    v_sin_f32 v25, v57
    v_sin_f32 v27, v59
    v_mul_f32 v24, v24, v52
    v_mul_f32 v26, v26, v54
    v_mul_f32 v25, v25, v52
    v_mul_f32 v27, v27, v54
    s_branch S_ln
S_pre:
    s_waitcnt vmcnt(0)
    buffer_load_dwordx4 v[72:75], v15, s[8:11], s32 offen offset:0
    v_lshlrev_b32 v9, 16, v9
    v_mul_f32 v11, s36, v9
    v_fma_f32 v12, v9, s36, -v11
    v_fma_f32 v12, v9, s37, v12
    v_exp_f32 v11, v11
    v_mul_f32 v12, s38, v12
    v_fma_f32 v10, v11, v12, v11
    v_cvt_pk_bf16_f32 v10, v10, v10
    v_and_b32 v10, 0xffff0000, v10
    v_lshlrev_b32 v60, 16, v5
    v_and_b32 v61, 0xffff0000, v5
    v_lshlrev_b32 v62, 16, v6
    v_and_b32 v63, 0xffff0000, v6
    v_mul_f32 v11, s36, v60
    v_fma_f32 v12, v60, s36, -v11
    v_fma_f32 v12, v60, s37, v12
    v_exp_f32 v11, v11
    v_mul_f32 v12, s38, v12
    buffer_load_dwordx4 v[76:79], v15, s[8:11], s32 offen offset:256
    v_fma_f32 v60, v11, v12, v11
    v_cvt_pk_bf16_f32 v60, v60, v60
    v_and_b32 v60, 0xffff0000, v60
    v_mul_f32_e64 v60, -v60, v10
    v_mul_f32 v62, v62, v10
    v_mul_f32 v11, s36, v61
    v_fma_f32 v12, v61, s36, -v11
    v_fma_f32 v12, v61, s37, v12
    v_exp_f32 v11, v11
    v_mul_f32 v12, s38, v12
    v_fma_f32 v61, v11, v12, v11
    v_cvt_pk_bf16_f32 v61, v61, v61
    v_and_b32 v61, 0xffff0000, v61
    v_mul_f32_e64 v61, -v61, v10
    v_mul_f32 v63, v63, v10
    s_mov_b32 s40, 0x4138aa3b
    s_mov_b32 s41, 0x41000000
    v_mul_f32 v52, s40, v60
    buffer_load_dwordx4 v[80:83], v15, s[8:11], s32 offen offset:512
    v_mul_f32 v54, s40, v61
    v_mul_f32 v56, s41, v62
    v_mul_f32 v58, s41, v63
    v_exp_f32 v52, v52
    v_exp_f32 v54, v54
    v_mul_f32 v57, 0.15915494, v56
    v_mul_f32 v59, 0.15915494, v58
    v_fma_f32 v53, v56, 0.15915494, -v57
    v_fma_f32 v55, v58, 0.15915494, -v59
    v_fma_f32 v53, v56, s39, v53
    v_fma_f32 v55, v58, s39, v55
    v_fract_f32 v57, v57
    v_fract_f32 v59, v59
    v_add_f32 v57, v57, v53
    v_add_f32 v59, v59, v55
    v_cos_f32 v20, v57
    v_cos_f32 v22, v59
    v_sin_f32 v21, v57
    buffer_load_dwordx4 v[84:87], v15, s[8:11], s32 offen offset:768
    v_sin_f32 v23, v59
    v_mul_f32 v20, v20, v52
    v_mul_f32 v22, v22, v54
    v_mul_f32 v21, v21, v52
    v_mul_f32 v23, v23, v54
    s_mov_b32 s40, 0x3fb8aa3b
    s_mov_b32 s41, 0x3f800000
    v_mul_f32 v52, s40, v60
    v_mul_f32 v54, s40, v61
    v_mul_f32 v56, s41, v62
    v_mul_f32 v58, s41, v63
    v_exp_f32 v52, v52
    v_exp_f32 v54, v54
    v_mul_f32 v57, 0.15915494, v56
    v_mul_f32 v59, 0.15915494, v58
    v_fma_f32 v53, v56, 0.15915494, -v57
    v_fma_f32 v55, v58, 0.15915494, -v59
    v_fma_f32 v53, v56, s39, v53
    buffer_load_dwordx4 v[88:91], v15, s[8:11], s32 offen offset:1024
    v_fma_f32 v55, v58, s39, v55
    v_fract_f32 v57, v57
    v_fract_f32 v59, v59
    v_add_f32 v57, v57, v53
    v_add_f32 v59, v59, v55
    v_cos_f32 v16, v57
    v_cos_f32 v18, v59
    v_sin_f32 v17, v57
    v_sin_f32 v19, v59
    v_mul_f32 v16, v16, v52
    v_mul_f32 v18, v18, v54
    v_mul_f32 v17, v17, v52
    v_mul_f32 v19, v19, v54
    s_mov_b32 s40, 0x43b8aa3b
    s_mov_b32 s41, 0x43800000
    v_mul_f32 v52, s40, v60
    v_mul_f32 v54, s40, v61
    v_mul_f32 v56, s41, v62
    buffer_load_dwordx4 v[92:95], v15, s[8:11], s32 offen offset:1280
    v_mul_f32 v58, s41, v63
    v_exp_f32 v52, v52
    v_exp_f32 v54, v54
    v_mul_f32 v57, 0.15915494, v56
    v_mul_f32 v59, 0.15915494, v58
    v_fma_f32 v53, v56, 0.15915494, -v57
    v_fma_f32 v55, v58, 0.15915494, -v59
    v_fma_f32 v53, v56, s39, v53
    v_fma_f32 v55, v58, s39, v55
    v_fract_f32 v57, v57
    v_fract_f32 v59, v59
    v_add_f32 v57, v57, v53
    v_add_f32 v59, v59, v55
    v_cos_f32 v24, v57
    v_cos_f32 v26, v59
    v_sin_f32 v25, v57
    v_sin_f32 v27, v59
    v_mul_f32 v24, v24, v52
    buffer_load_dwordx4 v[96:99], v15, s[8:11], s32 offen offset:1536
    v_mul_f32 v26, v26, v54
    v_mul_f32 v25, v25, v52
    v_mul_f32 v27, v27, v54
    v_mov_b32 v70, 0x3c00
    v_mov_b32 v71, 0x3c00
    ds_write_b64 v208, v[70:71]
    v_cvt_pk_f16_f32 v232, v20, v21
    v_cvt_pk_f16_f32 v233, v22, v23
    ds_write_b64 v209, v[232:233] offset:512
    v_mul_f32 v28, v20, v20
    v_mul_f32 v29, v21, v20
    v_mul_f32 v30, v22, v22
    v_mul_f32 v31, v23, v22
    v_fma_f32 v28, -v21, v21, v28
    v_fmac_f32 v29, v20, v21
    v_fma_f32 v30, -v23, v23, v30
    v_fmac_f32 v31, v22, v23
    v_cvt_pk_f16_f32 v234, v28, v29
    buffer_load_dwordx4 v[100:103], v15, s[8:11], s32 offen offset:1792
    v_cvt_pk_f16_f32 v235, v30, v31
    ds_write_b64 v210, v[234:235] offset:1024
    v_mul_f32 v44, v28, v20
    v_mul_f32 v45, v29, v20
    v_mul_f32 v46, v30, v22
    v_mul_f32 v47, v31, v22
    v_fma_f32 v44, -v29, v21, v44
    v_fmac_f32 v45, v28, v21
    v_fma_f32 v46, -v31, v23, v46
    v_fmac_f32 v47, v30, v23
    v_cvt_pk_f16_f32 v236, v44, v45
    v_cvt_pk_f16_f32 v237, v46, v47
    ds_write_b64 v211, v[236:237] offset:1536
    v_mul_f32 v32, v28, v28
    v_mul_f32 v33, v29, v28
    v_mul_f32 v34, v30, v30
    v_mul_f32 v35, v31, v30
    v_fma_f32 v32, -v29, v29, v32
    buffer_load_dwordx4 v[104:107], v15, s[8:11], s32 offen offset:2048
    v_fmac_f32 v33, v28, v29
    v_fma_f32 v34, -v31, v31, v34
    v_fmac_f32 v35, v30, v31
    v_cvt_pk_f16_f32 v250, v32, v33
    v_cvt_pk_f16_f32 v251, v34, v35
    ds_write_b64 v212, v[250:251] offset:2048
    v_pk_mul_f16 v64, v250, v232 op_sel_hi:[1,0]
    v_pk_mul_f16 v65, v251, v233 op_sel_hi:[1,0]
    v_pk_fma_f16 v64, v250, v232, v64 op_sel:[1,1,0] op_sel_hi:[0,1,1] neg_lo:[1,0,0]
    v_pk_fma_f16 v65, v251, v233, v65 op_sel:[1,1,0] op_sel_hi:[0,1,1] neg_lo:[1,0,0]
    ds_write_b64 v213, v[64:65] offset:2560
    v_pk_mul_f16 v66, v250, v234 op_sel_hi:[1,0]
    v_pk_mul_f16 v67, v251, v235 op_sel_hi:[1,0]
    v_pk_fma_f16 v66, v250, v234, v66 op_sel:[1,1,0] op_sel_hi:[0,1,1] neg_lo:[1,0,0]
    v_pk_fma_f16 v67, v251, v235, v67 op_sel:[1,1,0] op_sel_hi:[0,1,1] neg_lo:[1,0,0]
    ds_write_b64 v214, v[66:67] offset:3072
    v_pk_mul_f16 v68, v250, v236 op_sel_hi:[1,0]
    v_pk_mul_f16 v69, v251, v237 op_sel_hi:[1,0]
    buffer_load_dwordx4 v[108:111], v15, s[8:11], s32 offen offset:2304
    v_pk_fma_f16 v68, v250, v236, v68 op_sel:[1,1,0] op_sel_hi:[0,1,1] neg_lo:[1,0,0]
    v_pk_fma_f16 v69, v251, v237, v69 op_sel:[1,1,0] op_sel_hi:[0,1,1] neg_lo:[1,0,0]
    ds_write_b64 v215, v[68:69] offset:3584
    v_mul_f32 v44, v32, v32
    v_mul_f32 v45, v33, v32
    v_mul_f32 v46, v34, v34
    v_mul_f32 v47, v35, v34
    v_fma_f32 v44, -v33, v33, v44
    v_fmac_f32 v45, v32, v33
    v_fma_f32 v46, -v35, v35, v46
    v_fmac_f32 v47, v34, v35
    v_cvt_pk_f16_f32 v248, v44, v45
    v_cvt_pk_f16_f32 v249, v46, v47
    ds_write_b64 v216, v[248:249] offset:4096
    v_pk_mul_f16 v70, v248, v232 op_sel_hi:[1,0]
    v_pk_mul_f16 v71, v249, v233 op_sel_hi:[1,0]
    v_pk_fma_f16 v70, v248, v232, v70 op_sel:[1,1,0] op_sel_hi:[0,1,1] neg_lo:[1,0,0]
    v_pk_fma_f16 v71, v249, v233, v71 op_sel:[1,1,0] op_sel_hi:[0,1,1] neg_lo:[1,0,0]
    ds_write_b64 v217, v[70:71] offset:4608
    v_pk_mul_f16 v64, v248, v234 op_sel_hi:[1,0]
    v_pk_mul_f16 v65, v249, v235 op_sel_hi:[1,0]
    v_pk_fma_f16 v64, v248, v234, v64 op_sel:[1,1,0] op_sel_hi:[0,1,1] neg_lo:[1,0,0]
    v_pk_fma_f16 v65, v249, v235, v65 op_sel:[1,1,0] op_sel_hi:[0,1,1] neg_lo:[1,0,0]
    ds_write_b64 v218, v[64:65] offset:5120
    v_pk_mul_f16 v66, v248, v236 op_sel_hi:[1,0]
    v_pk_mul_f16 v67, v249, v237 op_sel_hi:[1,0]
    v_pk_fma_f16 v66, v248, v236, v66 op_sel:[1,1,0] op_sel_hi:[0,1,1] neg_lo:[1,0,0]
    v_pk_fma_f16 v67, v249, v237, v67 op_sel:[1,1,0] op_sel_hi:[0,1,1] neg_lo:[1,0,0]
    ds_write_b64 v219, v[66:67] offset:5632
    v_mul_f32 v48, v44, v32
    v_mul_f32 v49, v45, v32
    v_mul_f32 v50, v46, v34
    v_mul_f32 v51, v47, v34
    v_fma_f32 v48, -v45, v33, v48
    v_fmac_f32 v49, v44, v33
    v_fma_f32 v50, -v47, v35, v50
    v_fmac_f32 v51, v46, v35
    v_cvt_pk_f16_f32 v250, v48, v49
    v_cvt_pk_f16_f32 v251, v50, v51
    ds_write_b64 v220, v[250:251] offset:6144
    v_pk_mul_f16 v68, v250, v232 op_sel_hi:[1,0]
    v_pk_mul_f16 v69, v251, v233 op_sel_hi:[1,0]
    v_pk_fma_f16 v68, v250, v232, v68 op_sel:[1,1,0] op_sel_hi:[0,1,1] neg_lo:[1,0,0]
    v_pk_fma_f16 v69, v251, v233, v69 op_sel:[1,1,0] op_sel_hi:[0,1,1] neg_lo:[1,0,0]
    ds_write_b64 v221, v[68:69] offset:6656
    v_pk_mul_f16 v70, v250, v234 op_sel_hi:[1,0]
    v_pk_mul_f16 v71, v251, v235 op_sel_hi:[1,0]
    v_pk_fma_f16 v70, v250, v234, v70 op_sel:[1,1,0] op_sel_hi:[0,1,1] neg_lo:[1,0,0]
    v_pk_fma_f16 v71, v251, v235, v71 op_sel:[1,1,0] op_sel_hi:[0,1,1] neg_lo:[1,0,0]
    ds_write_b64 v222, v[70:71] offset:7168
    v_pk_mul_f16 v64, v250, v236 op_sel_hi:[1,0]
    v_pk_mul_f16 v65, v251, v237 op_sel_hi:[1,0]
    v_pk_fma_f16 v64, v250, v236, v64 op_sel:[1,1,0] op_sel_hi:[0,1,1] neg_lo:[1,0,0]
    v_pk_fma_f16 v65, v251, v237, v65 op_sel:[1,1,0] op_sel_hi:[0,1,1] neg_lo:[1,0,0]
    ds_write_b64 v223, v[64:65] offset:7680
    v_mul_f32 v44, v48, v32
    v_mul_f32 v45, v49, v32
    v_mul_f32 v46, v50, v34
    v_mul_f32 v47, v51, v34
    v_fma_f32 v44, -v49, v33, v44
    v_fmac_f32 v45, v48, v33
    v_fma_f32 v46, -v51, v35, v46
    v_fmac_f32 v47, v50, v35
    v_cvt_pk_f16_f32 v248, v44, v45
    v_cvt_pk_f16_f32 v249, v46, v47
    ds_write_b64 v208, v[248:249] offset:8192
    v_pk_mul_f16 v66, v248, v232 op_sel_hi:[1,0]
    v_pk_mul_f16 v67, v249, v233 op_sel_hi:[1,0]
    v_pk_fma_f16 v66, v248, v232, v66 op_sel:[1,1,0] op_sel_hi:[0,1,1] neg_lo:[1,0,0]
    v_pk_fma_f16 v67, v249, v233, v67 op_sel:[1,1,0] op_sel_hi:[0,1,1] neg_lo:[1,0,0]
    ds_write_b64 v209, v[66:67] offset:8704
    v_pk_mul_f16 v68, v248, v234 op_sel_hi:[1,0]
    v_pk_mul_f16 v69, v249, v235 op_sel_hi:[1,0]
    v_pk_fma_f16 v68, v248, v234, v68 op_sel:[1,1,0] op_sel_hi:[0,1,1] neg_lo:[1,0,0]
    v_pk_fma_f16 v69, v249, v235, v69 op_sel:[1,1,0] op_sel_hi:[0,1,1] neg_lo:[1,0,0]
    ds_write_b64 v210, v[68:69] offset:9216
    v_pk_mul_f16 v70, v248, v236 op_sel_hi:[1,0]
    v_pk_mul_f16 v71, v249, v237 op_sel_hi:[1,0]
    v_pk_fma_f16 v70, v248, v236, v70 op_sel:[1,1,0] op_sel_hi:[0,1,1] neg_lo:[1,0,0]
    v_pk_fma_f16 v71, v249, v237, v71 op_sel:[1,1,0] op_sel_hi:[0,1,1] neg_lo:[1,0,0]
    ds_write_b64 v211, v[70:71] offset:9728
    v_mul_f32 v48, v44, v32
    v_mul_f32 v49, v45, v32
    v_mul_f32 v50, v46, v34
    v_mul_f32 v51, v47, v34
    v_fma_f32 v48, -v45, v33, v48
    v_fmac_f32 v49, v44, v33
    v_fma_f32 v50, -v47, v35, v50
    v_fmac_f32 v51, v46, v35
    v_cvt_pk_f16_f32 v250, v48, v49
    v_cvt_pk_f16_f32 v251, v50, v51
    ds_write_b64 v212, v[250:251] offset:10240
    v_pk_mul_f16 v64, v250, v232 op_sel_hi:[1,0]
    v_pk_mul_f16 v65, v251, v233 op_sel_hi:[1,0]
    v_pk_fma_f16 v64, v250, v232, v64 op_sel:[1,1,0] op_sel_hi:[0,1,1] neg_lo:[1,0,0]
    v_pk_fma_f16 v65, v251, v233, v65 op_sel:[1,1,0] op_sel_hi:[0,1,1] neg_lo:[1,0,0]
    ds_write_b64 v213, v[64:65] offset:10752
    v_pk_mul_f16 v66, v250, v234 op_sel_hi:[1,0]
    v_pk_mul_f16 v67, v251, v235 op_sel_hi:[1,0]
    v_pk_fma_f16 v66, v250, v234, v66 op_sel:[1,1,0] op_sel_hi:[0,1,1] neg_lo:[1,0,0]
    v_pk_fma_f16 v67, v251, v235, v67 op_sel:[1,1,0] op_sel_hi:[0,1,1] neg_lo:[1,0,0]
    ds_write_b64 v214, v[66:67] offset:11264
    v_pk_mul_f16 v68, v250, v236 op_sel_hi:[1,0]
    v_pk_mul_f16 v69, v251, v237 op_sel_hi:[1,0]
    v_pk_fma_f16 v68, v250, v236, v68 op_sel:[1,1,0] op_sel_hi:[0,1,1] neg_lo:[1,0,0]
    v_pk_fma_f16 v69, v251, v237, v69 op_sel:[1,1,0] op_sel_hi:[0,1,1] neg_lo:[1,0,0]
    ds_write_b64 v215, v[68:69] offset:11776
    v_mul_f32 v44, v48, v32
    v_mul_f32 v45, v49, v32
    v_mul_f32 v46, v50, v34
    v_mul_f32 v47, v51, v34
    v_fma_f32 v44, -v49, v33, v44
    v_fmac_f32 v45, v48, v33
    v_fma_f32 v46, -v51, v35, v46
    v_fmac_f32 v47, v50, v35
    v_cvt_pk_f16_f32 v248, v44, v45
    v_cvt_pk_f16_f32 v249, v46, v47
    ds_write_b64 v216, v[248:249] offset:12288
    v_pk_mul_f16 v70, v248, v232 op_sel_hi:[1,0]
    v_pk_mul_f16 v71, v249, v233 op_sel_hi:[1,0]
    v_pk_fma_f16 v70, v248, v232, v70 op_sel:[1,1,0] op_sel_hi:[0,1,1] neg_lo:[1,0,0]
    v_pk_fma_f16 v71, v249, v233, v71 op_sel:[1,1,0] op_sel_hi:[0,1,1] neg_lo:[1,0,0]
    ds_write_b64 v217, v[70:71] offset:12800
    v_pk_mul_f16 v64, v248, v234 op_sel_hi:[1,0]
    v_pk_mul_f16 v65, v249, v235 op_sel_hi:[1,0]
    v_pk_fma_f16 v64, v248, v234, v64 op_sel:[1,1,0] op_sel_hi:[0,1,1] neg_lo:[1,0,0]
    v_pk_fma_f16 v65, v249, v235, v65 op_sel:[1,1,0] op_sel_hi:[0,1,1] neg_lo:[1,0,0]
    ds_write_b64 v218, v[64:65] offset:13312
    v_pk_mul_f16 v66, v248, v236 op_sel_hi:[1,0]
    v_pk_mul_f16 v67, v249, v237 op_sel_hi:[1,0]
    v_pk_fma_f16 v66, v248, v236, v66 op_sel:[1,1,0] op_sel_hi:[0,1,1] neg_lo:[1,0,0]
    v_pk_fma_f16 v67, v249, v237, v67 op_sel:[1,1,0] op_sel_hi:[0,1,1] neg_lo:[1,0,0]
    ds_write_b64 v219, v[66:67] offset:13824
    v_mul_f32 v48, v44, v32
    v_mul_f32 v49, v45, v32
    v_mul_f32 v50, v46, v34
    v_mul_f32 v51, v47, v34
    v_fma_f32 v48, -v45, v33, v48
    v_fmac_f32 v49, v44, v33
    v_fma_f32 v50, -v47, v35, v50
    v_fmac_f32 v51, v46, v35
    v_cvt_pk_f16_f32 v250, v48, v49
    v_cvt_pk_f16_f32 v251, v50, v51
    ds_write_b64 v220, v[250:251] offset:14336
    v_pk_mul_f16 v68, v250, v232 op_sel_hi:[1,0]
    v_pk_mul_f16 v69, v251, v233 op_sel_hi:[1,0]
    v_pk_fma_f16 v68, v250, v232, v68 op_sel:[1,1,0] op_sel_hi:[0,1,1] neg_lo:[1,0,0]
    v_pk_fma_f16 v69, v251, v233, v69 op_sel:[1,1,0] op_sel_hi:[0,1,1] neg_lo:[1,0,0]
    ds_write_b64 v221, v[68:69] offset:14848
    v_pk_mul_f16 v70, v250, v234 op_sel_hi:[1,0]
    v_pk_mul_f16 v71, v251, v235 op_sel_hi:[1,0]
    v_pk_fma_f16 v70, v250, v234, v70 op_sel:[1,1,0] op_sel_hi:[0,1,1] neg_lo:[1,0,0]
    v_pk_fma_f16 v71, v251, v235, v71 op_sel:[1,1,0] op_sel_hi:[0,1,1] neg_lo:[1,0,0]
    ds_write_b64 v222, v[70:71] offset:15360
    v_pk_mul_f16 v64, v250, v236 op_sel_hi:[1,0]
    v_pk_mul_f16 v65, v251, v237 op_sel_hi:[1,0]
    v_pk_fma_f16 v64, v250, v236, v64 op_sel:[1,1,0] op_sel_hi:[0,1,1] neg_lo:[1,0,0]
    v_pk_fma_f16 v65, v251, v237, v65 op_sel:[1,1,0] op_sel_hi:[0,1,1] neg_lo:[1,0,0]
    ds_write_b64 v223, v[64:65] offset:15872
S_ln:
    s_setprio 2
    v_mov_b32 v34, 0
    buffer_load_dwordx2 v[36:37], v34, s[28:31], 0 offen sc1
    v_and_b32 v28, 15, v1
    v_lshrrev_b32 v29, 4, v1
    v_lshlrev_b32 v32, 4, v29
    v_cmp_eq_u32 vcc, 0, v28
    v_mov_b32 v33, 0x7ff00000
    s_nop 0
    v_cndmask_b32 v32, v33, v32, vcc
    s_mov_b32 s40, 0x3acccccd
    s_mov_b32 s41, 0xffff0000
    s_lshl_b32 s42, s3, 2
    v_add_u32 v31, s42, v29
    v_and_b32 v33, 7, v28
    v_lshlrev_b32 v33, 2, v33
    v_xor_b32 v31, v31, v33
    v_lshlrev_b32 v31, 2, v31
    v_lshl_add_u32 v31, v28, 10, v31
    v_add_u32 v35, 49152, v31
    s_waitcnt vmcnt(6)
    v_lshlrev_b32 v112, 16, v72
    v_and_b32 v113, s41, v72
    v_lshlrev_b32 v114, 16, v73
    v_and_b32 v115, s41, v73
    v_lshlrev_b32 v116, 16, v74
    v_and_b32 v117, s41, v74
    v_lshlrev_b32 v118, 16, v75
    v_and_b32 v119, s41, v75
    v_lshlrev_b32 v120, 16, v76
    v_and_b32 v121, s41, v76
    v_lshlrev_b32 v122, 16, v77
    v_and_b32 v123, s41, v77
    v_lshlrev_b32 v124, 16, v78
    v_and_b32 v125, s41, v78
    v_lshlrev_b32 v126, 16, v79
    v_and_b32 v127, s41, v79
    v_lshlrev_b32 v128, 16, v80
    v_and_b32 v129, s41, v80
    v_lshlrev_b32 v130, 16, v81
    v_and_b32 v131, s41, v81
    v_lshlrev_b32 v132, 16, v82
    v_and_b32 v133, s41, v82
    v_lshlrev_b32 v134, 16, v83
    v_and_b32 v135, s41, v83
    v_lshlrev_b32 v136, 16, v84
    v_and_b32 v137, s41, v84
    v_lshlrev_b32 v138, 16, v85
    v_and_b32 v139, s41, v85
    v_lshlrev_b32 v140, 16, v86
    v_and_b32 v141, s41, v86
    v_lshlrev_b32 v142, 16, v87
    v_and_b32 v143, s41, v87
    v_lshlrev_b32 v144, 16, v88
    v_and_b32 v145, s41, v88
    v_lshlrev_b32 v146, 16, v89
    v_and_b32 v147, s41, v89
    v_lshlrev_b32 v148, 16, v90
    v_and_b32 v149, s41, v90
    v_lshlrev_b32 v150, 16, v91
    v_and_b32 v151, s41, v91
    s_waitcnt vmcnt(1)
    v_lshlrev_b32 v152, 16, v92
    v_and_b32 v153, s41, v92
    v_lshlrev_b32 v154, 16, v93
    v_and_b32 v155, s41, v93
    v_lshlrev_b32 v156, 16, v94
    v_and_b32 v157, s41, v94
    v_lshlrev_b32 v158, 16, v95
    v_and_b32 v159, s41, v95
    v_lshlrev_b32 v160, 16, v96
    v_and_b32 v161, s41, v96
    v_lshlrev_b32 v162, 16, v97
    v_and_b32 v163, s41, v97
    v_lshlrev_b32 v164, 16, v98
    v_and_b32 v165, s41, v98
    v_lshlrev_b32 v166, 16, v99
    v_and_b32 v167, s41, v99
    v_lshlrev_b32 v168, 16, v100
    v_and_b32 v169, s41, v100
    v_lshlrev_b32 v170, 16, v101
    v_and_b32 v171, s41, v101
    v_lshlrev_b32 v172, 16, v102
    v_and_b32 v173, s41, v102
    v_lshlrev_b32 v174, 16, v103
    v_and_b32 v175, s41, v103
    v_lshlrev_b32 v176, 16, v104
    v_and_b32 v177, s41, v104
    v_lshlrev_b32 v178, 16, v105
    v_and_b32 v179, s41, v105
    v_lshlrev_b32 v180, 16, v106
    v_and_b32 v181, s41, v106
    v_lshlrev_b32 v182, 16, v107
    v_and_b32 v183, s41, v107
    v_lshlrev_b32 v184, 16, v108
    v_and_b32 v185, s41, v108
    v_lshlrev_b32 v186, 16, v109
    v_and_b32 v187, s41, v109
    v_lshlrev_b32 v188, 16, v110
    v_and_b32 v189, s41, v110
    v_lshlrev_b32 v190, 16, v111
    v_and_b32 v191, s41, v111
    v_pk_add_f32 v[192:193], v[112:113], v[120:121]
    v_pk_add_f32 v[200:201], v[152:153], v[160:161]
    v_pk_add_f32 v[194:195], v[114:115], v[122:123]
    v_pk_add_f32 v[202:203], v[154:155], v[162:163]
    v_pk_add_f32 v[196:197], v[116:117], v[124:125]
    v_pk_add_f32 v[204:205], v[156:157], v[164:165]
    v_pk_add_f32 v[198:199], v[118:119], v[126:127]
    v_pk_add_f32 v[206:207], v[158:159], v[166:167]
    v_pk_add_f32 v[192:193], v[192:193], v[128:129]
    v_pk_add_f32 v[200:201], v[200:201], v[168:169]
    v_pk_add_f32 v[194:195], v[194:195], v[130:131]
    v_pk_add_f32 v[202:203], v[202:203], v[170:171]
    v_pk_add_f32 v[196:197], v[196:197], v[132:133]
    v_pk_add_f32 v[204:205], v[204:205], v[172:173]
    v_pk_add_f32 v[198:199], v[198:199], v[134:135]
    v_pk_add_f32 v[206:207], v[206:207], v[174:175]
    v_pk_add_f32 v[192:193], v[192:193], v[136:137]
    v_pk_add_f32 v[200:201], v[200:201], v[176:177]
    v_pk_add_f32 v[194:195], v[194:195], v[138:139]
    v_pk_add_f32 v[202:203], v[202:203], v[178:179]
    v_pk_add_f32 v[196:197], v[196:197], v[140:141]
    v_pk_add_f32 v[204:205], v[204:205], v[180:181]
    v_pk_add_f32 v[198:199], v[198:199], v[142:143]
    v_pk_add_f32 v[206:207], v[206:207], v[182:183]
    v_pk_add_f32 v[192:193], v[192:193], v[144:145]
    v_pk_add_f32 v[200:201], v[200:201], v[184:185]
    v_pk_add_f32 v[194:195], v[194:195], v[146:147]
    v_pk_add_f32 v[202:203], v[202:203], v[186:187]
    v_pk_add_f32 v[196:197], v[196:197], v[148:149]
    v_pk_add_f32 v[204:205], v[204:205], v[188:189]
    v_pk_add_f32 v[198:199], v[198:199], v[150:151]
    v_pk_add_f32 v[206:207], v[206:207], v[190:191]
    v_pk_add_f32 v[192:193], v[192:193], v[194:195]
    v_pk_add_f32 v[200:201], v[200:201], v[202:203]
    v_pk_add_f32 v[196:197], v[196:197], v[198:199]
    v_pk_add_f32 v[204:205], v[204:205], v[206:207]
    v_pk_add_f32 v[192:193], v[192:193], v[196:197]
    v_pk_add_f32 v[200:201], v[200:201], v[204:205]
    v_add_f32 v208, v192, v193
    v_add_f32 v214, v200, v201
    s_nop 0
    v_add_f32_dpp v208, v208, v208 row_ror:8 row_mask:0xf bank_mask:0xf
    v_add_f32_dpp v214, v214, v214 row_ror:8 row_mask:0xf bank_mask:0xf
    s_nop 0
    v_add_f32_dpp v208, v208, v208 row_ror:4 row_mask:0xf bank_mask:0xf
    v_add_f32_dpp v214, v214, v214 row_ror:4 row_mask:0xf bank_mask:0xf
    s_nop 0
    v_add_f32_dpp v208, v208, v208 row_ror:2 row_mask:0xf bank_mask:0xf
    v_add_f32_dpp v214, v214, v214 row_ror:2 row_mask:0xf bank_mask:0xf
    s_nop 0
    v_add_f32_dpp v208, v208, v208 row_ror:1 row_mask:0xf bank_mask:0xf
    v_add_f32_dpp v214, v214, v214 row_ror:1 row_mask:0xf bank_mask:0xf
    v_mul_f32 v208, s40, v208
    v_mul_f32 v214, s40, v214
    v_pk_add_f32 v[112:113], v[112:113], v[208:209] op_sel_hi:[1,0] neg_lo:[0,1] neg_hi:[0,1]
    v_pk_add_f32 v[152:153], v[152:153], v[214:215] op_sel_hi:[1,0] neg_lo:[0,1] neg_hi:[0,1]
    v_pk_add_f32 v[114:115], v[114:115], v[208:209] op_sel_hi:[1,0] neg_lo:[0,1] neg_hi:[0,1]
    v_pk_add_f32 v[154:155], v[154:155], v[214:215] op_sel_hi:[1,0] neg_lo:[0,1] neg_hi:[0,1]
    v_pk_add_f32 v[116:117], v[116:117], v[208:209] op_sel_hi:[1,0] neg_lo:[0,1] neg_hi:[0,1]
    v_pk_add_f32 v[156:157], v[156:157], v[214:215] op_sel_hi:[1,0] neg_lo:[0,1] neg_hi:[0,1]
    v_pk_add_f32 v[118:119], v[118:119], v[208:209] op_sel_hi:[1,0] neg_lo:[0,1] neg_hi:[0,1]
    v_pk_add_f32 v[158:159], v[158:159], v[214:215] op_sel_hi:[1,0] neg_lo:[0,1] neg_hi:[0,1]
    v_pk_add_f32 v[120:121], v[120:121], v[208:209] op_sel_hi:[1,0] neg_lo:[0,1] neg_hi:[0,1]
    v_pk_add_f32 v[160:161], v[160:161], v[214:215] op_sel_hi:[1,0] neg_lo:[0,1] neg_hi:[0,1]
    v_pk_add_f32 v[122:123], v[122:123], v[208:209] op_sel_hi:[1,0] neg_lo:[0,1] neg_hi:[0,1]
    v_pk_add_f32 v[162:163], v[162:163], v[214:215] op_sel_hi:[1,0] neg_lo:[0,1] neg_hi:[0,1]
    v_pk_add_f32 v[124:125], v[124:125], v[208:209] op_sel_hi:[1,0] neg_lo:[0,1] neg_hi:[0,1]
    v_pk_add_f32 v[164:165], v[164:165], v[214:215] op_sel_hi:[1,0] neg_lo:[0,1] neg_hi:[0,1]
    v_pk_add_f32 v[126:127], v[126:127], v[208:209] op_sel_hi:[1,0] neg_lo:[0,1] neg_hi:[0,1]
    v_pk_add_f32 v[166:167], v[166:167], v[214:215] op_sel_hi:[1,0] neg_lo:[0,1] neg_hi:[0,1]
    v_pk_add_f32 v[128:129], v[128:129], v[208:209] op_sel_hi:[1,0] neg_lo:[0,1] neg_hi:[0,1]
    v_pk_add_f32 v[168:169], v[168:169], v[214:215] op_sel_hi:[1,0] neg_lo:[0,1] neg_hi:[0,1]
    v_pk_add_f32 v[130:131], v[130:131], v[208:209] op_sel_hi:[1,0] neg_lo:[0,1] neg_hi:[0,1]
    v_pk_add_f32 v[170:171], v[170:171], v[214:215] op_sel_hi:[1,0] neg_lo:[0,1] neg_hi:[0,1]
    v_pk_add_f32 v[132:133], v[132:133], v[208:209] op_sel_hi:[1,0] neg_lo:[0,1] neg_hi:[0,1]
    v_pk_add_f32 v[172:173], v[172:173], v[214:215] op_sel_hi:[1,0] neg_lo:[0,1] neg_hi:[0,1]
    v_pk_add_f32 v[134:135], v[134:135], v[208:209] op_sel_hi:[1,0] neg_lo:[0,1] neg_hi:[0,1]
    v_pk_add_f32 v[174:175], v[174:175], v[214:215] op_sel_hi:[1,0] neg_lo:[0,1] neg_hi:[0,1]
    v_pk_add_f32 v[136:137], v[136:137], v[208:209] op_sel_hi:[1,0] neg_lo:[0,1] neg_hi:[0,1]
    v_pk_add_f32 v[176:177], v[176:177], v[214:215] op_sel_hi:[1,0] neg_lo:[0,1] neg_hi:[0,1]
    v_pk_add_f32 v[138:139], v[138:139], v[208:209] op_sel_hi:[1,0] neg_lo:[0,1] neg_hi:[0,1]
    v_pk_add_f32 v[178:179], v[178:179], v[214:215] op_sel_hi:[1,0] neg_lo:[0,1] neg_hi:[0,1]
    v_pk_add_f32 v[140:141], v[140:141], v[208:209] op_sel_hi:[1,0] neg_lo:[0,1] neg_hi:[0,1]
    v_pk_add_f32 v[180:181], v[180:181], v[214:215] op_sel_hi:[1,0] neg_lo:[0,1] neg_hi:[0,1]
    v_pk_add_f32 v[142:143], v[142:143], v[208:209] op_sel_hi:[1,0] neg_lo:[0,1] neg_hi:[0,1]
    v_pk_add_f32 v[182:183], v[182:183], v[214:215] op_sel_hi:[1,0] neg_lo:[0,1] neg_hi:[0,1]
    v_pk_add_f32 v[144:145], v[144:145], v[208:209] op_sel_hi:[1,0] neg_lo:[0,1] neg_hi:[0,1]
    v_pk_add_f32 v[184:185], v[184:185], v[214:215] op_sel_hi:[1,0] neg_lo:[0,1] neg_hi:[0,1]
    v_pk_add_f32 v[146:147], v[146:147], v[208:209] op_sel_hi:[1,0] neg_lo:[0,1] neg_hi:[0,1]
    v_pk_add_f32 v[186:187], v[186:187], v[214:215] op_sel_hi:[1,0] neg_lo:[0,1] neg_hi:[0,1]
    v_pk_add_f32 v[148:149], v[148:149], v[208:209] op_sel_hi:[1,0] neg_lo:[0,1] neg_hi:[0,1]
    v_pk_add_f32 v[188:189], v[188:189], v[214:215] op_sel_hi:[1,0] neg_lo:[0,1] neg_hi:[0,1]
    v_pk_add_f32 v[150:151], v[150:151], v[208:209] op_sel_hi:[1,0] neg_lo:[0,1] neg_hi:[0,1]
    v_pk_add_f32 v[190:191], v[190:191], v[214:215] op_sel_hi:[1,0] neg_lo:[0,1] neg_hi:[0,1]
    v_pk_mul_f32 v[192:193], v[112:113], v[112:113]
    v_pk_mul_f32 v[200:201], v[152:153], v[152:153]
    v_pk_mul_f32 v[194:195], v[114:115], v[114:115]
    v_pk_mul_f32 v[202:203], v[154:155], v[154:155]
    v_pk_mul_f32 v[196:197], v[116:117], v[116:117]
    v_pk_mul_f32 v[204:205], v[156:157], v[156:157]
    v_pk_mul_f32 v[198:199], v[118:119], v[118:119]
    v_pk_mul_f32 v[206:207], v[158:159], v[158:159]
    v_pk_fma_f32 v[192:193], v[120:121], v[120:121], v[192:193]
    v_pk_fma_f32 v[200:201], v[160:161], v[160:161], v[200:201]
    v_pk_fma_f32 v[194:195], v[122:123], v[122:123], v[194:195]
    v_pk_fma_f32 v[202:203], v[162:163], v[162:163], v[202:203]
    v_pk_fma_f32 v[196:197], v[124:125], v[124:125], v[196:197]
    v_pk_fma_f32 v[204:205], v[164:165], v[164:165], v[204:205]
    v_pk_fma_f32 v[198:199], v[126:127], v[126:127], v[198:199]
    v_pk_fma_f32 v[206:207], v[166:167], v[166:167], v[206:207]
    v_pk_fma_f32 v[192:193], v[128:129], v[128:129], v[192:193]
    v_pk_fma_f32 v[200:201], v[168:169], v[168:169], v[200:201]
    v_pk_fma_f32 v[194:195], v[130:131], v[130:131], v[194:195]
    v_pk_fma_f32 v[202:203], v[170:171], v[170:171], v[202:203]
    v_pk_fma_f32 v[196:197], v[132:133], v[132:133], v[196:197]
    v_pk_fma_f32 v[204:205], v[172:173], v[172:173], v[204:205]
    v_pk_fma_f32 v[198:199], v[134:135], v[134:135], v[198:199]
    v_pk_fma_f32 v[206:207], v[174:175], v[174:175], v[206:207]
    v_pk_fma_f32 v[192:193], v[136:137], v[136:137], v[192:193]
    v_pk_fma_f32 v[200:201], v[176:177], v[176:177], v[200:201]
    v_pk_fma_f32 v[194:195], v[138:139], v[138:139], v[194:195]
    v_pk_fma_f32 v[202:203], v[178:179], v[178:179], v[202:203]
    v_pk_fma_f32 v[196:197], v[140:141], v[140:141], v[196:197]
    v_pk_fma_f32 v[204:205], v[180:181], v[180:181], v[204:205]
    v_pk_fma_f32 v[198:199], v[142:143], v[142:143], v[198:199]
    v_pk_fma_f32 v[206:207], v[182:183], v[182:183], v[206:207]
    v_pk_fma_f32 v[192:193], v[144:145], v[144:145], v[192:193]
    v_pk_fma_f32 v[200:201], v[184:185], v[184:185], v[200:201]
    v_pk_fma_f32 v[194:195], v[146:147], v[146:147], v[194:195]
    v_pk_fma_f32 v[202:203], v[186:187], v[186:187], v[202:203]
    v_pk_fma_f32 v[196:197], v[148:149], v[148:149], v[196:197]
    v_pk_fma_f32 v[204:205], v[188:189], v[188:189], v[204:205]
    v_pk_fma_f32 v[198:199], v[150:151], v[150:151], v[198:199]
    v_pk_fma_f32 v[206:207], v[190:191], v[190:191], v[206:207]
    v_pk_add_f32 v[192:193], v[192:193], v[194:195]
    v_pk_add_f32 v[200:201], v[200:201], v[202:203]
    v_pk_add_f32 v[196:197], v[196:197], v[198:199]
    v_pk_add_f32 v[204:205], v[204:205], v[206:207]
    v_pk_add_f32 v[192:193], v[192:193], v[196:197]
    v_pk_add_f32 v[200:201], v[200:201], v[204:205]
    v_add_f32 v210, v192, v193
    v_add_f32 v216, v200, v201
    s_nop 0
    v_add_f32_dpp v210, v210, v210 row_ror:8 row_mask:0xf bank_mask:0xf
    v_add_f32_dpp v216, v216, v216 row_ror:8 row_mask:0xf bank_mask:0xf
    s_nop 0
    v_add_f32_dpp v210, v210, v210 row_ror:4 row_mask:0xf bank_mask:0xf
    v_add_f32_dpp v216, v216, v216 row_ror:4 row_mask:0xf bank_mask:0xf
    s_nop 0
    v_add_f32_dpp v210, v210, v210 row_ror:2 row_mask:0xf bank_mask:0xf
    v_add_f32_dpp v216, v216, v216 row_ror:2 row_mask:0xf bank_mask:0xf
    s_nop 0
    v_add_f32_dpp v210, v210, v210 row_ror:1 row_mask:0xf bank_mask:0xf
    v_add_f32_dpp v216, v216, v216 row_ror:1 row_mask:0xf bank_mask:0xf
    v_mul_f32 v210, s40, v210
    v_mul_f32 v216, s40, v216
    v_cvt_pk_bf16_f32 v220, v208, v208
    v_cvt_pk_bf16_f32 v222, v214, v214
    v_and_b32 v220, 0xffff0000, v220
    v_and_b32 v222, 0xffff0000, v222
    v_cvt_pk_bf16_f32 v210, v210, v210
    v_cvt_pk_bf16_f32 v216, v216, v216
    v_and_b32 v210, 0xffff0000, v210
    v_and_b32 v216, 0xffff0000, v216
    v_add_f32 v210, 0x3727c5ac, v210
    v_add_f32 v216, 0x3727c5ac, v216
    v_cvt_pk_bf16_f32 v210, v210, v210
    v_cvt_pk_bf16_f32 v216, v216, v216
    v_and_b32 v210, 0xffff0000, v210
    v_and_b32 v216, 0xffff0000, v216
    v_sqrt_f32 v210, v210
    v_sqrt_f32 v216, v216
    v_cvt_pk_bf16_f32 v210, v210, v210
    v_cvt_pk_bf16_f32 v216, v216, v216
    v_and_b32 v210, 0xffff0000, v210
    v_and_b32 v216, 0xffff0000, v216
    v_rcp_f32 v210, v210
    v_rcp_f32 v216, v216
    v_sub_f32 v212, v208, v220
    v_sub_f32 v218, v214, v222
    v_mul_f32 v221, v210, v210
    v_mul_f32 v223, v216, v216
    v_mul_f32 v212, v212, v210
    v_mul_f32 v218, v218, v216
    buffer_store_dwordx4 v[220:223], v32, s[12:15], s56 offen sc1
    v_pk_fma_f32 v[112:113], v[112:113], v[210:211], v[212:213] op_sel_hi:[1,0,0]
    v_pk_fma_f32 v[152:153], v[152:153], v[216:217], v[218:219] op_sel_hi:[1,0,0]
    v_pk_fma_f32 v[114:115], v[114:115], v[210:211], v[212:213] op_sel_hi:[1,0,0]
    v_pk_fma_f32 v[154:155], v[154:155], v[216:217], v[218:219] op_sel_hi:[1,0,0]
    v_cvt_pk_bf16_f32 v72, v112, v152
    ds_write_b32 v31, v72 offset:0
    v_cvt_pk_bf16_f32 v73, v113, v153
    ds_write_b32 v31, v73 offset:128
    v_pk_fma_f32 v[116:117], v[116:117], v[210:211], v[212:213] op_sel_hi:[1,0,0]
    v_pk_fma_f32 v[156:157], v[156:157], v[216:217], v[218:219] op_sel_hi:[1,0,0]
    v_cvt_pk_bf16_f32 v74, v114, v154
    ds_write_b32 v31, v74 offset:256
    v_cvt_pk_bf16_f32 v75, v115, v155
    ds_write_b32 v31, v75 offset:384
    v_pk_fma_f32 v[118:119], v[118:119], v[210:211], v[212:213] op_sel_hi:[1,0,0]
    v_pk_fma_f32 v[158:159], v[158:159], v[216:217], v[218:219] op_sel_hi:[1,0,0]
    v_cvt_pk_bf16_f32 v76, v116, v156
    ds_write_b32 v31, v76 offset:512
    v_cvt_pk_bf16_f32 v77, v117, v157
    ds_write_b32 v31, v77 offset:640
    v_pk_fma_f32 v[120:121], v[120:121], v[210:211], v[212:213] op_sel_hi:[1,0,0]
    v_pk_fma_f32 v[160:161], v[160:161], v[216:217], v[218:219] op_sel_hi:[1,0,0]
    v_cvt_pk_bf16_f32 v78, v118, v158
    ds_write_b32 v31, v78 offset:768
    v_cvt_pk_bf16_f32 v79, v119, v159
    ds_write_b32 v31, v79 offset:896
    v_pk_fma_f32 v[122:123], v[122:123], v[210:211], v[212:213] op_sel_hi:[1,0,0]
    v_pk_fma_f32 v[162:163], v[162:163], v[216:217], v[218:219] op_sel_hi:[1,0,0]
    v_cvt_pk_bf16_f32 v80, v120, v160
    ds_write_b32 v31, v80 offset:16384
    v_cvt_pk_bf16_f32 v81, v121, v161
    ds_write_b32 v31, v81 offset:16512
    v_pk_fma_f32 v[124:125], v[124:125], v[210:211], v[212:213] op_sel_hi:[1,0,0]
    v_pk_fma_f32 v[164:165], v[164:165], v[216:217], v[218:219] op_sel_hi:[1,0,0]
    v_cvt_pk_bf16_f32 v82, v122, v162
    ds_write_b32 v31, v82 offset:16640
    v_cvt_pk_bf16_f32 v83, v123, v163
    ds_write_b32 v31, v83 offset:16768
    v_pk_fma_f32 v[126:127], v[126:127], v[210:211], v[212:213] op_sel_hi:[1,0,0]
    v_pk_fma_f32 v[166:167], v[166:167], v[216:217], v[218:219] op_sel_hi:[1,0,0]
    v_cvt_pk_bf16_f32 v84, v124, v164
    ds_write_b32 v31, v84 offset:16896
    v_cvt_pk_bf16_f32 v85, v125, v165
    ds_write_b32 v31, v85 offset:17024
    v_pk_fma_f32 v[128:129], v[128:129], v[210:211], v[212:213] op_sel_hi:[1,0,0]
    v_pk_fma_f32 v[168:169], v[168:169], v[216:217], v[218:219] op_sel_hi:[1,0,0]
    v_cvt_pk_bf16_f32 v86, v126, v166
    ds_write_b32 v31, v86 offset:17152
    v_cvt_pk_bf16_f32 v87, v127, v167
    ds_write_b32 v31, v87 offset:17280
    v_pk_fma_f32 v[130:131], v[130:131], v[210:211], v[212:213] op_sel_hi:[1,0,0]
    v_pk_fma_f32 v[170:171], v[170:171], v[216:217], v[218:219] op_sel_hi:[1,0,0]
    v_cvt_pk_bf16_f32 v88, v128, v168
    ds_write_b32 v31, v88 offset:32768
    v_cvt_pk_bf16_f32 v89, v129, v169
    ds_write_b32 v31, v89 offset:32896
    v_pk_fma_f32 v[132:133], v[132:133], v[210:211], v[212:213] op_sel_hi:[1,0,0]
    v_pk_fma_f32 v[172:173], v[172:173], v[216:217], v[218:219] op_sel_hi:[1,0,0]
    v_cvt_pk_bf16_f32 v90, v130, v170
    ds_write_b32 v31, v90 offset:33024
    v_cvt_pk_bf16_f32 v91, v131, v171
    ds_write_b32 v31, v91 offset:33152
    v_pk_fma_f32 v[134:135], v[134:135], v[210:211], v[212:213] op_sel_hi:[1,0,0]
    v_pk_fma_f32 v[174:175], v[174:175], v[216:217], v[218:219] op_sel_hi:[1,0,0]
    v_cvt_pk_bf16_f32 v92, v132, v172
    ds_write_b32 v31, v92 offset:33280
    v_cvt_pk_bf16_f32 v93, v133, v173
    ds_write_b32 v31, v93 offset:33408
    v_pk_fma_f32 v[136:137], v[136:137], v[210:211], v[212:213] op_sel_hi:[1,0,0]
    v_pk_fma_f32 v[176:177], v[176:177], v[216:217], v[218:219] op_sel_hi:[1,0,0]
    v_cvt_pk_bf16_f32 v94, v134, v174
    ds_write_b32 v31, v94 offset:33536
    v_cvt_pk_bf16_f32 v95, v135, v175
    ds_write_b32 v31, v95 offset:33664
    v_pk_fma_f32 v[138:139], v[138:139], v[210:211], v[212:213] op_sel_hi:[1,0,0]
    v_pk_fma_f32 v[178:179], v[178:179], v[216:217], v[218:219] op_sel_hi:[1,0,0]
    v_cvt_pk_bf16_f32 v96, v136, v176
    ds_write_b32 v35, v96 offset:0
    v_cvt_pk_bf16_f32 v97, v137, v177
    ds_write_b32 v35, v97 offset:128
    v_pk_fma_f32 v[140:141], v[140:141], v[210:211], v[212:213] op_sel_hi:[1,0,0]
    v_pk_fma_f32 v[180:181], v[180:181], v[216:217], v[218:219] op_sel_hi:[1,0,0]
    v_cvt_pk_bf16_f32 v98, v138, v178
    ds_write_b32 v35, v98 offset:256
    v_cvt_pk_bf16_f32 v99, v139, v179
    ds_write_b32 v35, v99 offset:384
    v_pk_fma_f32 v[142:143], v[142:143], v[210:211], v[212:213] op_sel_hi:[1,0,0]
    v_pk_fma_f32 v[182:183], v[182:183], v[216:217], v[218:219] op_sel_hi:[1,0,0]
    v_cvt_pk_bf16_f32 v100, v140, v180
    ds_write_b32 v35, v100 offset:512
    v_cvt_pk_bf16_f32 v101, v141, v181
    ds_write_b32 v35, v101 offset:640
    v_pk_fma_f32 v[144:145], v[144:145], v[210:211], v[212:213] op_sel_hi:[1,0,0]
    v_pk_fma_f32 v[184:185], v[184:185], v[216:217], v[218:219] op_sel_hi:[1,0,0]
    v_cvt_pk_bf16_f32 v102, v142, v182
    ds_write_b32 v35, v102 offset:768
    v_cvt_pk_bf16_f32 v103, v143, v183
    ds_write_b32 v35, v103 offset:896
    v_pk_fma_f32 v[146:147], v[146:147], v[210:211], v[212:213] op_sel_hi:[1,0,0]
    v_pk_fma_f32 v[186:187], v[186:187], v[216:217], v[218:219] op_sel_hi:[1,0,0]
    v_cvt_pk_bf16_f32 v104, v144, v184
    ds_write_b32 v35, v104 offset:16384
    v_cvt_pk_bf16_f32 v105, v145, v185
    ds_write_b32 v35, v105 offset:16512
    v_pk_fma_f32 v[148:149], v[148:149], v[210:211], v[212:213] op_sel_hi:[1,0,0]
    v_pk_fma_f32 v[188:189], v[188:189], v[216:217], v[218:219] op_sel_hi:[1,0,0]
    v_cvt_pk_bf16_f32 v106, v146, v186
    ds_write_b32 v35, v106 offset:16640
    v_cvt_pk_bf16_f32 v107, v147, v187
    ds_write_b32 v35, v107 offset:16768
    v_pk_fma_f32 v[150:151], v[150:151], v[210:211], v[212:213] op_sel_hi:[1,0,0]
    v_pk_fma_f32 v[190:191], v[190:191], v[216:217], v[218:219] op_sel_hi:[1,0,0]
    v_cvt_pk_bf16_f32 v108, v148, v188
    ds_write_b32 v35, v108 offset:16896
    v_cvt_pk_bf16_f32 v109, v149, v189
    ds_write_b32 v35, v109 offset:17024
    v_cvt_pk_bf16_f32 v110, v150, v190
    ds_write_b32 v35, v110 offset:17152
    v_cvt_pk_bf16_f32 v111, v151, v191
    ds_write_b32 v35, v111 offset:17280
    v_mov_b32 v40, 163776
    v_mov_b32 v41, 1
    s_waitcnt lgkmcnt(0)
    s_mov_b64 exec, 1
    ds_add_u32 v40, v41
    s_mov_b64 exec, -1
    v_lshrrev_b32 v42, 3, v1
    v_and_b32 v43, 7, v1
    v_lshlrev_b32 v44, 7, v42
    s_mul_i32 s42, s3, 10240
    v_add_u32 v44, s42, v44
    s_lshl_b32 s43, s3, 1
    s_add_u32 s40, s43, 0
    s_and_b32 s40, s40, 7
    v_xor_b32 v33, s40, v43
    v_lshl_add_u32 v112, v33, 4, v44
    s_add_u32 s40, s43, 1
    s_and_b32 s40, s40, 7
    v_xor_b32 v33, s40, v43
    v_lshl_add_u32 v113, v33, 4, v44
    s_add_u32 s40, s43, 2
    s_and_b32 s40, s40, 7
    v_xor_b32 v33, s40, v43
    v_lshl_add_u32 v114, v33, 4, v44
    s_add_u32 s40, s43, 3
    s_and_b32 s40, s40, 7
    v_xor_b32 v33, s40, v43
    v_lshl_add_u32 v115, v33, 4, v44
    s_add_u32 s40, s43, 4
    s_and_b32 s40, s40, 7
    v_xor_b32 v33, s40, v43
    v_lshl_add_u32 v116, v33, 4, v44
    s_add_u32 s40, s43, 5
    s_and_b32 s40, s40, 7
    v_xor_b32 v33, s40, v43
    v_lshl_add_u32 v117, v33, 4, v44
    s_add_u32 s40, s43, 6
    s_and_b32 s40, s40, 7
    v_xor_b32 v33, s40, v43
    v_lshl_add_u32 v118, v33, 4, v44
    s_add_u32 s40, s43, 7
    s_and_b32 s40, s40, 7
    v_xor_b32 v33, s40, v43
    v_lshl_add_u32 v119, v33, 4, v44
    v_lshlrev_b32 v42, 12, v42
    v_lshl_add_u32 v42, v43, 4, v42
    s_mul_i32 s40, s3, 327680
    s_lshl_b32 s41, s46, 7
    s_add_u32 s40, s40, s41
    v_mov_b32 v40, 163776
    s_mov_b32 s53, 0
LS_63:
    ds_read_b32 v41, v40
    s_waitcnt lgkmcnt(0)
    v_readfirstlane_b32 s54, v41
    s_nop 0
    s_cmp_ge_u32 s54, 8
    s_cbranch_scc1 LD_64
    s_add_u32 s53, s53, 1
    s_cmp_gt_u32 s53, 3200000
    s_cbranch_scc1 LD_64
    s_sleep 1
    s_branch LS_63
LD_64:
    ds_read_b128 v[120:123], v112 offset:0
    ds_read_b128 v[124:127], v113 offset:1024
    ds_read_b128 v[128:131], v114 offset:2048
    ds_read_b128 v[132:135], v115 offset:3072
    ds_read_b128 v[136:139], v116 offset:4096
    ds_read_b128 v[140:143], v117 offset:5120
    ds_read_b128 v[144:147], v118 offset:6144
    ds_read_b128 v[148:151], v119 offset:7168
    ds_read_b128 v[152:155], v112 offset:8192
    ds_read_b128 v[156:159], v113 offset:9216
    s_mov_b32 s53, 0
    s_waitcnt vmcnt(0)
TG_65:
    v_readfirstlane_b32 s50, v36
    v_readfirstlane_b32 s51, v37
    s_cmp_lg_u32 s50, 0
    s_cbranch_scc1 TD_66
    s_add_u32 s53, s53, 1
    s_cmp_gt_u32 s53, 200000
    s_cbranch_scc1 TD_66
    s_sleep 2
    buffer_load_dwordx2 v[36:37], v34, s[28:31], 0 offen sc1
    s_waitcnt vmcnt(0)
    s_branch TG_65
TD_66:
    s_waitcnt lgkmcnt(9)
    buffer_store_dwordx4 v[120:123], v42, s[16:19], s40 offen sc1
    s_add_u32 s40, s40, 32768
    s_waitcnt lgkmcnt(8)
    buffer_store_dwordx4 v[124:127], v42, s[16:19], s40 offen sc1
    s_add_u32 s40, s40, 32768
    s_waitcnt lgkmcnt(7)
    buffer_store_dwordx4 v[128:131], v42, s[16:19], s40 offen sc1
    s_add_u32 s40, s40, 32768
    s_waitcnt lgkmcnt(6)
    buffer_store_dwordx4 v[132:135], v42, s[16:19], s40 offen sc1
    s_add_u32 s40, s40, 32768
    s_waitcnt lgkmcnt(5)
    buffer_store_dwordx4 v[136:139], v42, s[16:19], s40 offen sc1
    s_add_u32 s40, s40, 32768
    s_waitcnt lgkmcnt(4)
    buffer_store_dwordx4 v[140:143], v42, s[16:19], s40 offen sc1
    s_add_u32 s40, s40, 32768
    s_waitcnt lgkmcnt(3)
    buffer_store_dwordx4 v[144:147], v42, s[16:19], s40 offen sc1
    s_add_u32 s40, s40, 32768
    s_waitcnt lgkmcnt(2)
    buffer_store_dwordx4 v[148:151], v42, s[16:19], s40 offen sc1
    s_add_u32 s40, s40, 32768
    s_waitcnt lgkmcnt(1)
    buffer_store_dwordx4 v[152:155], v42, s[16:19], s40 offen sc1
    s_add_u32 s40, s40, 32768
    s_waitcnt lgkmcnt(0)
    buffer_store_dwordx4 v[156:159], v42, s[16:19], s40 offen sc1
    s_add_u32 s40, s40, 32768
    v_mov_b32 v40, 163780
    v_mov_b32 v41, 1
    s_waitcnt lgkmcnt(0)
    s_mov_b64 exec, 1
    ds_add_u32 v40, v41
    s_mov_b64 exec, -1
    v_lshlrev_b32 v208, 3, v1
    v_xor_b32 v209, 16, v208
    v_xor_b32 v210, 32, v208
    v_xor_b32 v211, 48, v208
    v_xor_b32 v212, 64, v208
    v_xor_b32 v213, 80, v208
    v_xor_b32 v214, 96, v208
    v_xor_b32 v215, 112, v208
    v_xor_b32 v216, 128, v208
    v_xor_b32 v217, 144, v208
    v_xor_b32 v218, 160, v208
    v_xor_b32 v219, 176, v208
    v_xor_b32 v220, 192, v208
    v_xor_b32 v221, 208, v208
    v_xor_b32 v222, 224, v208
    v_xor_b32 v223, 240, v208
    v_add_u32 v208, s35, v208
    v_add_u32 v209, s35, v209
    v_add_u32 v210, s35, v210
    v_add_u32 v211, s35, v211
    v_add_u32 v212, s35, v212
    v_add_u32 v213, s35, v213
    v_add_u32 v214, s35, v214
    v_add_u32 v215, s35, v215
    v_add_u32 v216, s35, v216
    v_add_u32 v217, s35, v217
    v_add_u32 v218, s35, v218
    v_add_u32 v219, s35, v219
    v_add_u32 v220, s35, v220
    v_add_u32 v221, s35, v221
    v_add_u32 v222, s35, v222
    v_add_u32 v223, s35, v223
    v_and_b32 v2, 15, v1
    v_lshrrev_b32 v3, 5, v1
    v_xor_b32 v3, v3, v2
    v_lshlrev_b32 v3, 4, v3
    v_and_b32 v2, 31, v1
    v_lshl_add_u32 v224, v2, 9, v3
    v_xor_b32 v225, 32, v224
    v_xor_b32 v226, 64, v224
    v_xor_b32 v227, 96, v224
    v_xor_b32 v228, 128, v224
    v_xor_b32 v229, 160, v224
    v_xor_b32 v230, 192, v224
    v_xor_b32 v231, 224, v224
    v_add_u32 v224, s35, v224
    v_add_u32 v225, s35, v225
    v_add_u32 v226, s35, v226
    v_add_u32 v227, s35, v227
    v_add_u32 v228, s35, v228
    v_add_u32 v229, s35, v229
    v_add_u32 v230, s35, v230
    v_add_u32 v231, s35, v231
    s_mov_b32 s36, 0x3fb8aa3b
    s_mov_b32 s37, 0x32a57060
    s_mov_b32 s38, 0x3f317218
    s_mov_b32 s39, 0x31dc9c88
    v_mov_b32 v28, 163816
    v_mov_b32 v29, 1
    s_lshl_b32 s32, s46, 7
    s_waitcnt vmcnt(0)
    s_mov_b64 exec, 1
    ds_add_rtn_u32 v29, v28, v29
    s_waitcnt lgkmcnt(0)
    v_readfirstlane_b32 s33, v29
    s_nop 0
    s_cmp_lg_u32 s33, 7
    s_cbranch_scc1 LN_67
    v_mov_b32 v28, 0
    v_mov_b32 v30, s50
    v_mov_b32 v31, s51
    buffer_store_dwordx2 v[30:31], v28, s[4:7], s32 offen offset:0 sc1
LN_67:
    s_mov_b64 exec, -1
    s_setprio 1
    s_cmp_ge_u32 s3, 4
    s_cbranch_scc1 SK_fr
    s_setprio 0
    v_mov_b32 v2, 163780
    s_mov_b32 s53, 0
LS_68:
    ds_read_b32 v3, v2
    s_waitcnt lgkmcnt(0)
    v_readfirstlane_b32 s54, v3
    s_nop 0
    s_cmp_ge_u32 s54, 8
    s_cbranch_scc1 LD_69
    s_add_u32 s53, s53, 1
    s_cmp_gt_u32 s53, 3200000
    s_cbranch_scc1 LD_69
    s_sleep 1
    s_branch LS_68
LD_69:
    v_cvt_pk_f16_f32 v232, v20, v21
    v_cvt_pk_f16_f32 v233, v22, v23
    s_cmp_lt_u32 s3, 2
    s_cbranch_scc1 SK_g
    s_add_u32 s20, s86, 0x1400000
    s_addc_u32 s21, s87, 0
    s_mov_b32 s22, 0x280000
    s_mov_b32 s23, 0x20000
    v_mov_b32 v72, 0x7fa57fa5
    v_lshlrev_b32 v76, 4, v1
    s_add_u32 s42, s3, 4
    s_mul_i32 s42, s42, s46
    s_cmp_eq_u32 s3, 3
    s_cselect_b32 s41, 0, 224
    s_cselect_b32 s43, 0, 0x7ff00000
    s_add_u32 s42, s42, s41
    s_add_u32 s42, s42, 224
    s_lshl_b32 s42, s42, 12
    s_add_u32 s43, s43, 4096
    v_mov_b32 v70, 0x3c00
    v_mov_b32 v71, 0x3c00
    ds_write_b64 v208, v[70:71]
    v_cvt_pk_f16_f32 v232, v20, v21
    v_cvt_pk_f16_f32 v233, v22, v23
    buffer_store_dwordx4 v[72:75], v76, s[20:23], s42 offen offset:0 sc1
    ds_write_b64 v209, v[232:233] offset:512
    v_mul_f32 v28, v20, v20
    v_mul_f32 v29, v21, v20
    v_mul_f32 v30, v22, v22
    v_mul_f32 v31, v23, v22
    v_fma_f32 v28, -v21, v21, v28
    v_fmac_f32 v29, v20, v21
    buffer_store_dwordx4 v[72:75], v76, s[20:23], s42 offen offset:1024 sc1
    v_fma_f32 v30, -v23, v23, v30
    v_fmac_f32 v31, v22, v23
    v_cvt_pk_f16_f32 v234, v28, v29
    v_cvt_pk_f16_f32 v235, v30, v31
    ds_write_b64 v210, v[234:235] offset:1024
    v_mul_f32 v44, v28, v20
    v_mul_f32 v45, v29, v20
    buffer_store_dwordx4 v[72:75], v76, s[20:23], s42 offen offset:2048 sc1
    v_mul_f32 v46, v30, v22
    v_mul_f32 v47, v31, v22
    v_fma_f32 v44, -v29, v21, v44
    v_fmac_f32 v45, v28, v21
    v_fma_f32 v46, -v31, v23, v46
    v_fmac_f32 v47, v30, v23
    v_cvt_pk_f16_f32 v236, v44, v45
    buffer_store_dwordx4 v[72:75], v76, s[20:23], s42 offen offset:3072 sc1
    s_add_u32 s42, s42, 4096
    v_cvt_pk_f16_f32 v237, v46, v47
    ds_write_b64 v211, v[236:237] offset:1536
    v_mul_f32 v32, v28, v28
    v_mul_f32 v33, v29, v28
    v_mul_f32 v34, v30, v30
    v_mul_f32 v35, v31, v30
    v_fma_f32 v32, -v29, v29, v32
    buffer_store_dwordx4 v[72:75], v76, s[20:23], s42 offen offset:0 sc1
    v_fmac_f32 v33, v28, v29
    v_fma_f32 v34, -v31, v31, v34
    v_fmac_f32 v35, v30, v31
    v_cvt_pk_f16_f32 v250, v32, v33
    v_cvt_pk_f16_f32 v251, v34, v35
    ds_write_b64 v212, v[250:251] offset:2048
    v_pk_mul_f16 v64, v250, v232 op_sel_hi:[1,0]
    buffer_store_dwordx4 v[72:75], v76, s[20:23], s42 offen offset:1024 sc1
    v_pk_mul_f16 v65, v251, v233 op_sel_hi:[1,0]
    v_pk_fma_f16 v64, v250, v232, v64 op_sel:[1,1,0] op_sel_hi:[0,1,1] neg_lo:[1,0,0]
    v_pk_fma_f16 v65, v251, v233, v65 op_sel:[1,1,0] op_sel_hi:[0,1,1] neg_lo:[1,0,0]
    ds_write_b64 v213, v[64:65] offset:2560
    v_pk_mul_f16 v66, v250, v234 op_sel_hi:[1,0]
    v_pk_mul_f16 v67, v251, v235 op_sel_hi:[1,0]
    v_pk_fma_f16 v66, v250, v234, v66 op_sel:[1,1,0] op_sel_hi:[0,1,1] neg_lo:[1,0,0]
    buffer_store_dwordx4 v[72:75], v76, s[20:23], s42 offen offset:2048 sc1
    v_pk_fma_f16 v67, v251, v235, v67 op_sel:[1,1,0] op_sel_hi:[0,1,1] neg_lo:[1,0,0]
    ds_write_b64 v214, v[66:67] offset:3072
    v_pk_mul_f16 v68, v250, v236 op_sel_hi:[1,0]
    v_pk_mul_f16 v69, v251, v237 op_sel_hi:[1,0]
    v_pk_fma_f16 v68, v250, v236, v68 op_sel:[1,1,0] op_sel_hi:[0,1,1] neg_lo:[1,0,0]
    v_pk_fma_f16 v69, v251, v237, v69 op_sel:[1,1,0] op_sel_hi:[0,1,1] neg_lo:[1,0,0]
    ds_write_b64 v215, v[68:69] offset:3584
    buffer_store_dwordx4 v[72:75], v76, s[20:23], s42 offen offset:3072 sc1
    s_add_u32 s42, s42, 4096
    v_mul_f32 v44, v32, v32
    v_mul_f32 v45, v33, v32
    v_mul_f32 v46, v34, v34
    v_mul_f32 v47, v35, v34
    v_fma_f32 v44, -v33, v33, v44
    v_fmac_f32 v45, v32, v33
    v_fma_f32 v46, -v35, v35, v46
    buffer_store_dwordx4 v[72:75], v76, s[20:23], s42 offen offset:0 sc1
    v_fmac_f32 v47, v34, v35
    v_cvt_pk_f16_f32 v248, v44, v45
    v_cvt_pk_f16_f32 v249, v46, v47
    ds_write_b64 v216, v[248:249] offset:4096
    v_pk_mul_f16 v70, v248, v232 op_sel_hi:[1,0]
    v_pk_mul_f16 v71, v249, v233 op_sel_hi:[1,0]
    v_pk_fma_f16 v70, v248, v232, v70 op_sel:[1,1,0] op_sel_hi:[0,1,1] neg_lo:[1,0,0]
    buffer_store_dwordx4 v[72:75], v76, s[20:23], s42 offen offset:1024 sc1
    v_pk_fma_f16 v71, v249, v233, v71 op_sel:[1,1,0] op_sel_hi:[0,1,1] neg_lo:[1,0,0]
    ds_write_b64 v217, v[70:71] offset:4608
    v_pk_mul_f16 v64, v248, v234 op_sel_hi:[1,0]
    v_pk_mul_f16 v65, v249, v235 op_sel_hi:[1,0]
    v_pk_fma_f16 v64, v248, v234, v64 op_sel:[1,1,0] op_sel_hi:[0,1,1] neg_lo:[1,0,0]
    v_pk_fma_f16 v65, v249, v235, v65 op_sel:[1,1,0] op_sel_hi:[0,1,1] neg_lo:[1,0,0]
    ds_write_b64 v218, v[64:65] offset:5120
    buffer_store_dwordx4 v[72:75], v76, s[20:23], s42 offen offset:2048 sc1
    v_pk_mul_f16 v66, v248, v236 op_sel_hi:[1,0]
    v_pk_mul_f16 v67, v249, v237 op_sel_hi:[1,0]
    v_pk_fma_f16 v66, v248, v236, v66 op_sel:[1,1,0] op_sel_hi:[0,1,1] neg_lo:[1,0,0]
    v_pk_fma_f16 v67, v249, v237, v67 op_sel:[1,1,0] op_sel_hi:[0,1,1] neg_lo:[1,0,0]
    ds_write_b64 v219, v[66:67] offset:5632
    v_mul_f32 v48, v44, v32
    v_mul_f32 v49, v45, v32
    buffer_store_dwordx4 v[72:75], v76, s[20:23], s42 offen offset:3072 sc1
    s_add_u32 s42, s42, 4096
    v_mul_f32 v50, v46, v34
    v_mul_f32 v51, v47, v34
    v_fma_f32 v48, -v45, v33, v48
    v_fmac_f32 v49, v44, v33
    v_fma_f32 v50, -v47, v35, v50
    v_fmac_f32 v51, v46, v35
    v_cvt_pk_f16_f32 v250, v48, v49
    buffer_store_dwordx4 v[72:75], v76, s[20:23], s42 offen offset:0 sc1
    v_cvt_pk_f16_f32 v251, v50, v51
    ds_write_b64 v220, v[250:251] offset:6144
    v_pk_mul_f16 v68, v250, v232 op_sel_hi:[1,0]
    v_pk_mul_f16 v69, v251, v233 op_sel_hi:[1,0]
    v_pk_fma_f16 v68, v250, v232, v68 op_sel:[1,1,0] op_sel_hi:[0,1,1] neg_lo:[1,0,0]
    v_pk_fma_f16 v69, v251, v233, v69 op_sel:[1,1,0] op_sel_hi:[0,1,1] neg_lo:[1,0,0]
    ds_write_b64 v221, v[68:69] offset:6656
    buffer_store_dwordx4 v[72:75], v76, s[20:23], s42 offen offset:1024 sc1
    v_pk_mul_f16 v70, v250, v234 op_sel_hi:[1,0]
    v_pk_mul_f16 v71, v251, v235 op_sel_hi:[1,0]
    v_pk_fma_f16 v70, v250, v234, v70 op_sel:[1,1,0] op_sel_hi:[0,1,1] neg_lo:[1,0,0]
    v_pk_fma_f16 v71, v251, v235, v71 op_sel:[1,1,0] op_sel_hi:[0,1,1] neg_lo:[1,0,0]
    ds_write_b64 v222, v[70:71] offset:7168
    v_pk_mul_f16 v64, v250, v236 op_sel_hi:[1,0]
    v_pk_mul_f16 v65, v251, v237 op_sel_hi:[1,0]
    buffer_store_dwordx4 v[72:75], v76, s[20:23], s42 offen offset:2048 sc1
    v_pk_fma_f16 v64, v250, v236, v64 op_sel:[1,1,0] op_sel_hi:[0,1,1] neg_lo:[1,0,0]
    v_pk_fma_f16 v65, v251, v237, v65 op_sel:[1,1,0] op_sel_hi:[0,1,1] neg_lo:[1,0,0]
    ds_write_b64 v223, v[64:65] offset:7680
    v_mul_f32 v44, v48, v32
    v_mul_f32 v45, v49, v32
    v_mul_f32 v46, v50, v34
    v_mul_f32 v47, v51, v34
    buffer_store_dwordx4 v[72:75], v76, s[20:23], s42 offen offset:3072 sc1
    s_add_u32 s42, s42, 4096
    v_fma_f32 v44, -v49, v33, v44
    v_fmac_f32 v45, v48, v33
    v_fma_f32 v46, -v51, v35, v46
    v_fmac_f32 v47, v50, v35
    v_cvt_pk_f16_f32 v248, v44, v45
    v_cvt_pk_f16_f32 v249, v46, v47
    ds_write_b64 v208, v[248:249] offset:8192
    buffer_store_dwordx4 v[72:75], v76, s[20:23], s42 offen offset:0 sc1
    v_pk_mul_f16 v66, v248, v232 op_sel_hi:[1,0]
    v_pk_mul_f16 v67, v249, v233 op_sel_hi:[1,0]
    v_pk_fma_f16 v66, v248, v232, v66 op_sel:[1,1,0] op_sel_hi:[0,1,1] neg_lo:[1,0,0]
    v_pk_fma_f16 v67, v249, v233, v67 op_sel:[1,1,0] op_sel_hi:[0,1,1] neg_lo:[1,0,0]
    ds_write_b64 v209, v[66:67] offset:8704
    v_pk_mul_f16 v68, v248, v234 op_sel_hi:[1,0]
    v_pk_mul_f16 v69, v249, v235 op_sel_hi:[1,0]
    buffer_store_dwordx4 v[72:75], v76, s[20:23], s42 offen offset:1024 sc1
    v_pk_fma_f16 v68, v248, v234, v68 op_sel:[1,1,0] op_sel_hi:[0,1,1] neg_lo:[1,0,0]
    v_pk_fma_f16 v69, v249, v235, v69 op_sel:[1,1,0] op_sel_hi:[0,1,1] neg_lo:[1,0,0]
    ds_write_b64 v210, v[68:69] offset:9216
    v_pk_mul_f16 v70, v248, v236 op_sel_hi:[1,0]
    v_pk_mul_f16 v71, v249, v237 op_sel_hi:[1,0]
    v_pk_fma_f16 v70, v248, v236, v70 op_sel:[1,1,0] op_sel_hi:[0,1,1] neg_lo:[1,0,0]
    v_pk_fma_f16 v71, v249, v237, v71 op_sel:[1,1,0] op_sel_hi:[0,1,1] neg_lo:[1,0,0]
    buffer_store_dwordx4 v[72:75], v76, s[20:23], s42 offen offset:2048 sc1
    ds_write_b64 v211, v[70:71] offset:9728
    v_mul_f32 v48, v44, v32
    v_mul_f32 v49, v45, v32
    v_mul_f32 v50, v46, v34
    v_mul_f32 v51, v47, v34
    v_fma_f32 v48, -v45, v33, v48
    v_fmac_f32 v49, v44, v33
    buffer_store_dwordx4 v[72:75], v76, s[20:23], s42 offen offset:3072 sc1
    s_add_u32 s42, s42, 4096
    v_fma_f32 v50, -v47, v35, v50
    v_fmac_f32 v51, v46, v35
    v_cvt_pk_f16_f32 v250, v48, v49
    v_cvt_pk_f16_f32 v251, v50, v51
    ds_write_b64 v212, v[250:251] offset:10240
    v_pk_mul_f16 v64, v250, v232 op_sel_hi:[1,0]
    v_pk_mul_f16 v65, v251, v233 op_sel_hi:[1,0]
    buffer_store_dwordx4 v[72:75], v76, s[20:23], s42 offen offset:0 sc1
    v_pk_fma_f16 v64, v250, v232, v64 op_sel:[1,1,0] op_sel_hi:[0,1,1] neg_lo:[1,0,0]
    v_pk_fma_f16 v65, v251, v233, v65 op_sel:[1,1,0] op_sel_hi:[0,1,1] neg_lo:[1,0,0]
    ds_write_b64 v213, v[64:65] offset:10752
    v_pk_mul_f16 v66, v250, v234 op_sel_hi:[1,0]
    v_pk_mul_f16 v67, v251, v235 op_sel_hi:[1,0]
    v_pk_fma_f16 v66, v250, v234, v66 op_sel:[1,1,0] op_sel_hi:[0,1,1] neg_lo:[1,0,0]
    v_pk_fma_f16 v67, v251, v235, v67 op_sel:[1,1,0] op_sel_hi:[0,1,1] neg_lo:[1,0,0]
    buffer_store_dwordx4 v[72:75], v76, s[20:23], s42 offen offset:1024 sc1
    ds_write_b64 v214, v[66:67] offset:11264
    v_pk_mul_f16 v68, v250, v236 op_sel_hi:[1,0]
    v_pk_mul_f16 v69, v251, v237 op_sel_hi:[1,0]
    v_pk_fma_f16 v68, v250, v236, v68 op_sel:[1,1,0] op_sel_hi:[0,1,1] neg_lo:[1,0,0]
    v_pk_fma_f16 v69, v251, v237, v69 op_sel:[1,1,0] op_sel_hi:[0,1,1] neg_lo:[1,0,0]
    ds_write_b64 v215, v[68:69] offset:11776
    v_mul_f32 v44, v48, v32
    buffer_store_dwordx4 v[72:75], v76, s[20:23], s42 offen offset:2048 sc1
    v_mul_f32 v45, v49, v32
    v_mul_f32 v46, v50, v34
    v_mul_f32 v47, v51, v34
    v_fma_f32 v44, -v49, v33, v44
    v_fmac_f32 v45, v48, v33
    v_fma_f32 v46, -v51, v35, v46
    v_fmac_f32 v47, v50, v35
    buffer_store_dwordx4 v[72:75], v76, s[20:23], s42 offen offset:3072 sc1
    s_add_u32 s42, s42, s43
    v_cvt_pk_f16_f32 v248, v44, v45
    v_cvt_pk_f16_f32 v249, v46, v47
    ds_write_b64 v216, v[248:249] offset:12288
    v_pk_mul_f16 v70, v248, v232 op_sel_hi:[1,0]
    v_pk_mul_f16 v71, v249, v233 op_sel_hi:[1,0]
    v_pk_fma_f16 v70, v248, v232, v70 op_sel:[1,1,0] op_sel_hi:[0,1,1] neg_lo:[1,0,0]
    v_pk_fma_f16 v71, v249, v233, v71 op_sel:[1,1,0] op_sel_hi:[0,1,1] neg_lo:[1,0,0]
    buffer_store_dwordx4 v[72:75], v76, s[20:23], s42 offen offset:0 sc1
    ds_write_b64 v217, v[70:71] offset:12800
    v_pk_mul_f16 v64, v248, v234 op_sel_hi:[1,0]
    v_pk_mul_f16 v65, v249, v235 op_sel_hi:[1,0]
    v_pk_fma_f16 v64, v248, v234, v64 op_sel:[1,1,0] op_sel_hi:[0,1,1] neg_lo:[1,0,0]
    v_pk_fma_f16 v65, v249, v235, v65 op_sel:[1,1,0] op_sel_hi:[0,1,1] neg_lo:[1,0,0]
    ds_write_b64 v218, v[64:65] offset:13312
    v_pk_mul_f16 v66, v248, v236 op_sel_hi:[1,0]
    buffer_store_dwordx4 v[72:75], v76, s[20:23], s42 offen offset:1024 sc1
    v_pk_mul_f16 v67, v249, v237 op_sel_hi:[1,0]
    v_pk_fma_f16 v66, v248, v236, v66 op_sel:[1,1,0] op_sel_hi:[0,1,1] neg_lo:[1,0,0]
    v_pk_fma_f16 v67, v249, v237, v67 op_sel:[1,1,0] op_sel_hi:[0,1,1] neg_lo:[1,0,0]
    ds_write_b64 v219, v[66:67] offset:13824
    v_mul_f32 v48, v44, v32
    v_mul_f32 v49, v45, v32
    v_mul_f32 v50, v46, v34
    buffer_store_dwordx4 v[72:75], v76, s[20:23], s42 offen offset:2048 sc1
    v_mul_f32 v51, v47, v34
    v_fma_f32 v48, -v45, v33, v48
    v_fmac_f32 v49, v44, v33
    v_fma_f32 v50, -v47, v35, v50
    v_fmac_f32 v51, v46, v35
    v_cvt_pk_f16_f32 v250, v48, v49
    v_cvt_pk_f16_f32 v251, v50, v51
    buffer_store_dwordx4 v[72:75], v76, s[20:23], s42 offen offset:3072 sc1
    ds_write_b64 v220, v[250:251] offset:14336
    v_pk_mul_f16 v68, v250, v232 op_sel_hi:[1,0]
    v_pk_mul_f16 v69, v251, v233 op_sel_hi:[1,0]
    v_pk_fma_f16 v68, v250, v232, v68 op_sel:[1,1,0] op_sel_hi:[0,1,1] neg_lo:[1,0,0]
    v_pk_fma_f16 v69, v251, v233, v69 op_sel:[1,1,0] op_sel_hi:[0,1,1] neg_lo:[1,0,0]
    ds_write_b64 v221, v[68:69] offset:14848
    v_pk_mul_f16 v70, v250, v234 op_sel_hi:[1,0]
    v_pk_mul_f16 v71, v251, v235 op_sel_hi:[1,0]
    v_pk_fma_f16 v70, v250, v234, v70 op_sel:[1,1,0] op_sel_hi:[0,1,1] neg_lo:[1,0,0]
    v_pk_fma_f16 v71, v251, v235, v71 op_sel:[1,1,0] op_sel_hi:[0,1,1] neg_lo:[1,0,0]
    ds_write_b64 v222, v[70:71] offset:15360
    v_pk_mul_f16 v64, v250, v236 op_sel_hi:[1,0]
    v_pk_mul_f16 v65, v251, v237 op_sel_hi:[1,0]
    v_pk_fma_f16 v64, v250, v236, v64 op_sel:[1,1,0] op_sel_hi:[0,1,1] neg_lo:[1,0,0]
    v_pk_fma_f16 v65, v251, v237, v65 op_sel:[1,1,0] op_sel_hi:[0,1,1] neg_lo:[1,0,0]
    ds_write_b64 v223, v[64:65] offset:15872
S_u:
    v_mov_b32 v62, 163824
    v_mov_b32 v63, 1
    s_waitcnt lgkmcnt(0)
    s_mov_b64 exec, 1
    ds_add_u32 v62, v63
    s_mov_b64 exec, -1
    s_waitcnt vmcnt(0)
    v_mov_b32 v62, 163812
    v_mov_b32 v63, 1
    s_waitcnt lgkmcnt(0)
    s_mov_b64 exec, 1
    ds_add_u32 v62, v63
    s_mov_b64 exec, -1
    s_cmp_eq_u32 s3, 3
    s_cbranch_scc1 S_wd
    s_lshl_b32 s33, s46, 7
    s_add_u32 s33, s33, 155648
    v_mov_b32 v62, 163812
    s_mov_b32 s53, 0
LS_70:
    ds_read_b32 v63, v62
    s_waitcnt lgkmcnt(0)
    v_readfirstlane_b32 s54, v63
    s_nop 0
    s_cmp_ge_u32 s54, 2
    s_cbranch_scc1 LD_71
    s_add_u32 s53, s53, 1
    s_cmp_gt_u32 s53, 3200000
    s_cbranch_scc1 LD_71
    s_sleep 1
    s_branch LS_70
LD_71:
    s_mov_b64 exec, 1
    v_mov_b32 v62, s50
    v_mov_b32 v63, s51
    buffer_store_dwordx2 v[62:63], v4, s[4:7], s33 offen offset:0 sc1
    s_mov_b64 exec, -1
    s_branch S_g2
S_wd:
    s_lshl_b32 s33, s48, 3
    s_mov_b32 s40, 0x41291200
    s_mov_b32 s41, 0xb0998270
    s_lshr_b64 s[40:41], s[40:41], s33
    s_and_b32 s32, s40, 0xff
    v_add_u32 v61, s32, v1
    s_mov_b32 s40, 0x6a584029
    s_mov_b32 s41, 0xdac8b099
    s_lshr_b64 s[40:41], s[40:41], s33
    s_and_b32 s32, s40, 0xff
    v_min_u32 v61, s32, v61
    v_lshlrev_b32 v61, 7, v61
    v_add_u32 v61, 65536, v61
    s_mov_b64 s[56:57], -1
    buffer_load_dwordx2 v[62:63], v61, s[4:7], 0 offen offset:0 sc1
    s_mov_b32 s53, 0
    s_waitcnt vmcnt(0)
PL_72:
    v_cmp_eq_u64 vcc, s[50:51], v[62:63]
    s_nop 0
    s_andn2_b64 s[54:55], s[56:57], vcc
    s_cbranch_scc0 PD_73
    s_add_u32 s53, s53, 1
    s_cmp_gt_u32 s53, 200000
    s_cbranch_scc1 PD_73
    s_sleep 4
    buffer_load_dwordx2 v[62:63], v61, s[4:7], 0 offen offset:0 sc1
    s_waitcnt vmcnt(0)
    s_branch PL_72
PD_73:
    v_mov_b32 v4, 163820
    v_mov_b32 v5, 1
    s_waitcnt lgkmcnt(0)
    s_mov_b64 exec, 1
    ds_add_u32 v4, v5
    s_mov_b64 exec, -1
S_g2:
    v_mov_b32 v4, 163820
    s_mov_b32 s53, 0
LS_74:
    ds_read_b32 v5, v4
    s_waitcnt lgkmcnt(0)
    v_readfirstlane_b32 s54, v5
    s_nop 0
    s_cmp_ge_u32 s54, 1
    s_cbranch_scc1 LD_75
    s_add_u32 s53, s53, 1
    s_cmp_gt_u32 s53, 3200000
    s_cbranch_scc1 LD_75
    s_sleep 1
    s_branch LS_74
LD_75:
    s_mov_b32 s35, 0x7ff00000
    s_branch GEMM2
SK_fr:
    ds_read_b128 v[72:75], v224 offset:0
    ds_read_b128 v[76:79], v225 offset:0
    ds_read_b128 v[80:83], v226 offset:0
    ds_read_b128 v[84:87], v227 offset:0
    ds_read_b128 v[88:91], v228 offset:0
    ds_read_b128 v[92:95], v229 offset:0
    ds_read_b128 v[96:99], v230 offset:0
    ds_read_b128 v[100:103], v231 offset:0
    ds_read_b128 v[104:107], v224 offset:256
    ds_read_b128 v[108:111], v225 offset:256
    ds_read_b128 v[112:115], v226 offset:256
    ds_read_b128 v[116:119], v227 offset:256
    ds_read_b128 v[120:123], v228 offset:256
    ds_read_b128 v[124:127], v229 offset:256
    ds_read_b128 v[128:131], v230 offset:256
    ds_read_b128 v[132:135], v231 offset:256
SK_g:
    v_lshlrev_b32 v36, 16, v7
    v_and_b32 v38, 0xffff0000, v7
    v_lshlrev_b32 v37, 16, v8
    v_and_b32 v39, 0xffff0000, v8
    v_max_f32_e64 v11, abs(v36), abs(v37)
    v_max3_f32 v11, abs(v38), abs(v39), v11
    s_nop 1
    v_max_f32_dpp v11, v11, v11 row_ror:8 row_mask:0xf bank_mask:0xf
    s_nop 1
    v_max_f32_dpp v11, v11, v11 row_ror:4 row_mask:0xf bank_mask:0xf
    s_nop 1
    v_max_f32_dpp v11, v11, v11 row_ror:2 row_mask:0xf bank_mask:0xf
    s_nop 1
    v_max_f32_dpp v11, v11, v11 row_ror:1 row_mask:0xf bank_mask:0xf
    s_nop 0
    v_readlane_b32 s40, v11, 0
    v_readlane_b32 s41, v11, 16
    v_readlane_b32 s42, v11, 32
    v_readlane_b32 s43, v11, 48
    s_max_u32 s40, s40, s41
    s_max_u32 s42, s42, s43
    s_max_u32 s40, s40, s42
    s_lshr_b32 s40, s40, 23
    s_min_u32 s40, s40, 253
    s_sub_u32 s41, 254, s40
    s_lshl_b32 s41, s41, 23
    s_lshl_b32 s40, s40, 23
    v_mul_f32 v14, s40, v10
    v_add_f32 v14, v14, v14
    v_mul_f32 v36, s41, v36
    v_mul_f32 v37, s41, v37
    v_mul_f32 v38, s41, v38
    v_mul_f32 v39, s41, v39
    v_cvt_pk_f16_f32 v238, v16, v17
    v_cvt_pk_f16_f32 v239, v18, v19
    v_mul_f32 v28, v16, v16
    v_mul_f32 v29, v17, v16
    v_mul_f32 v30, v18, v18
    v_mul_f32 v31, v19, v18
    v_fma_f32 v28, -v17, v17, v28
    v_fmac_f32 v29, v16, v17
    v_fma_f32 v30, -v19, v19, v30
    v_fmac_f32 v31, v18, v19
    v_cvt_pk_f16_f32 v240, v28, v29
    v_cvt_pk_f16_f32 v241, v30, v31
    v_mul_f32 v44, v28, v16
    v_mul_f32 v45, v29, v16
    v_mul_f32 v46, v30, v18
    v_mul_f32 v47, v31, v18
    v_fma_f32 v44, -v29, v17, v44
    v_fmac_f32 v45, v28, v17
    v_fma_f32 v46, -v31, v19, v46
    v_fmac_f32 v47, v30, v19
    v_cvt_pk_f16_f32 v242, v44, v45
    v_cvt_pk_f16_f32 v243, v46, v47
    v_mul_f32 v32, v28, v28
    v_mul_f32 v33, v29, v28
    v_mul_f32 v34, v30, v30
    v_mul_f32 v35, v31, v30
    v_fma_f32 v32, -v29, v29, v32
    v_fmac_f32 v33, v28, v29
    v_fma_f32 v34, -v31, v31, v34
    v_fmac_f32 v35, v30, v31
    v_cvt_pk_f16_f32 v244, v32, v33
    v_cvt_pk_f16_f32 v245, v34, v35
    v_mul_f32 v48, v44, v44
    v_mul_f32 v49, v45, v44
    v_mul_f32 v50, v46, v46
    v_mul_f32 v51, v47, v46
    v_fma_f32 v48, -v45, v45, v48
    v_fmac_f32 v49, v44, v45
    v_fma_f32 v50, -v47, v47, v50
    v_fmac_f32 v51, v46, v47
    v_cvt_pk_f16_f32 v246, v48, v49
    v_cvt_pk_f16_f32 v247, v50, v51
    v_cvt_pk_f16_f32 v248, v36, -v37
    v_cvt_pk_f16_f32 v249, v38, -v39
    ds_write_b64 v208, v[248:249] offset:0
    v_mul_f32 v44, v36, v32
    v_mul_f32 v45, v37, v32
    v_mul_f32 v46, v38, v34
    v_mul_f32 v47, v39, v34
    v_fma_f32 v44, -v37, v33, v44
    v_fmac_f32 v45, v36, v33
    v_fma_f32 v46, -v39, v35, v46
    v_fmac_f32 v47, v38, v35
    v_pk_mul_f16 v64, v248, v238 op_sel_hi:[1,0]
    v_pk_mul_f16 v65, v249, v239 op_sel_hi:[1,0]
    v_pk_fma_f16 v64, v248, v238, v64 op_sel:[1,1,0] op_sel_hi:[0,1,1] neg_hi:[1,0,0]
    v_pk_fma_f16 v65, v249, v239, v65 op_sel:[1,1,0] op_sel_hi:[0,1,1] neg_hi:[1,0,0]
    ds_write_b64 v209, v[64:65] offset:512
    v_pk_mul_f16 v66, v248, v240 op_sel_hi:[1,0]
    v_pk_mul_f16 v67, v249, v241 op_sel_hi:[1,0]
    v_pk_fma_f16 v66, v248, v240, v66 op_sel:[1,1,0] op_sel_hi:[0,1,1] neg_hi:[1,0,0]
    v_pk_fma_f16 v67, v249, v241, v67 op_sel:[1,1,0] op_sel_hi:[0,1,1] neg_hi:[1,0,0]
    ds_write_b64 v210, v[66:67] offset:1024
    v_pk_mul_f16 v68, v248, v242 op_sel_hi:[1,0]
    v_pk_mul_f16 v69, v249, v243 op_sel_hi:[1,0]
    v_pk_fma_f16 v68, v248, v242, v68 op_sel:[1,1,0] op_sel_hi:[0,1,1] neg_hi:[1,0,0]
    v_pk_fma_f16 v69, v249, v243, v69 op_sel:[1,1,0] op_sel_hi:[0,1,1] neg_hi:[1,0,0]
    ds_write_b64 v211, v[68:69] offset:1536
    v_pk_mul_f16 v70, v248, v232 op_sel_hi:[1,0]
    v_pk_mul_f16 v71, v249, v233 op_sel_hi:[1,0]
    v_pk_fma_f16 v70, v248, v232, v70 op_sel:[1,1,0] op_sel_hi:[0,1,1] neg_hi:[1,0,0]
    v_pk_fma_f16 v71, v249, v233, v71 op_sel:[1,1,0] op_sel_hi:[0,1,1] neg_hi:[1,0,0]
    ds_write_b64 v223, v[70:71] offset:7680
    v_cvt_pk_f16_f32 v234, v44, -v45
    v_cvt_pk_f16_f32 v235, v46, -v47
    ds_write_b64 v212, v[234:235] offset:2048
    ds_write_b64 v219, v[234:235] offset:5632
    v_mul_f32 v40, v36, v24
    v_mul_f32 v41, v37, v24
    v_mul_f32 v42, v38, v26
    v_mul_f32 v43, v39, v26
    v_fma_f32 v40, -v37, v25, v40
    v_fmac_f32 v41, v36, v25
    v_fma_f32 v42, -v39, v27, v42
    v_fmac_f32 v43, v38, v27
    v_pk_mul_f16 v64, v234, v238 op_sel_hi:[1,0]
    v_pk_mul_f16 v65, v235, v239 op_sel_hi:[1,0]
    v_pk_fma_f16 v64, v234, v238, v64 op_sel:[1,1,0] op_sel_hi:[0,1,1] neg_hi:[1,0,0]
    v_pk_fma_f16 v65, v235, v239, v65 op_sel:[1,1,0] op_sel_hi:[0,1,1] neg_hi:[1,0,0]
    ds_write_b64 v213, v[64:65] offset:2560
    v_pk_mul_f16 v66, v234, v240 op_sel_hi:[1,0]
    v_pk_mul_f16 v67, v235, v241 op_sel_hi:[1,0]
    v_pk_fma_f16 v66, v234, v240, v66 op_sel:[1,1,0] op_sel_hi:[0,1,1] neg_hi:[1,0,0]
    v_pk_fma_f16 v67, v235, v241, v67 op_sel:[1,1,0] op_sel_hi:[0,1,1] neg_hi:[1,0,0]
    ds_write_b64 v214, v[66:67] offset:3072
    v_pk_mul_f16 v68, v234, v242 op_sel_hi:[1,0]
    v_pk_mul_f16 v69, v235, v243 op_sel_hi:[1,0]
    v_pk_fma_f16 v68, v234, v242, v68 op_sel:[1,1,0] op_sel_hi:[0,1,1] neg_hi:[1,0,0]
    v_pk_fma_f16 v69, v235, v243, v69 op_sel:[1,1,0] op_sel_hi:[0,1,1] neg_hi:[1,0,0]
    ds_write_b64 v215, v[68:69] offset:3584
    v_cvt_pk_f16_f32 v250, v40, -v41
    v_cvt_pk_f16_f32 v251, v42, -v43
    v_mul_f32 v44, v40, v24
    v_mul_f32 v45, v41, v24
    v_mul_f32 v46, v42, v26
    v_mul_f32 v47, v43, v26
    v_fma_f32 v44, -v41, v25, v44
    v_fmac_f32 v45, v40, v25
    v_fma_f32 v46, -v43, v27, v46
    v_fmac_f32 v47, v42, v27
    v_cvt_pk_f16_f32 v248, v44, -v45
    v_cvt_pk_f16_f32 v249, v46, -v47
    ds_write_b64 v216, v[248:249] offset:4096
    v_mul_f32 v48, v44, v24
    v_mul_f32 v49, v45, v24
    v_mul_f32 v50, v46, v26
    v_mul_f32 v51, v47, v26
    v_fma_f32 v48, -v45, v25, v48
    v_fmac_f32 v49, v44, v25
    v_fma_f32 v50, -v47, v27, v50
    v_fmac_f32 v51, v46, v27
    v_pk_mul_f16 v70, v248, v244 op_sel_hi:[1,0]
    v_pk_mul_f16 v71, v249, v245 op_sel_hi:[1,0]
    v_pk_fma_f16 v70, v248, v244, v70 op_sel:[1,1,0] op_sel_hi:[0,1,1] neg_hi:[1,0,0]
    v_pk_fma_f16 v71, v249, v245, v71 op_sel:[1,1,0] op_sel_hi:[0,1,1] neg_hi:[1,0,0]
    ds_write_b64 v217, v[70:71] offset:4608
    v_pk_mul_f16 v64, v248, v232 op_sel_hi:[1,0]
    v_pk_mul_f16 v65, v249, v233 op_sel_hi:[1,0]
    v_pk_fma_f16 v64, v248, v232, v64 op_sel:[1,1,0] op_sel_hi:[0,1,1] neg_hi:[1,0,0]
    v_pk_fma_f16 v65, v249, v233, v65 op_sel:[1,1,0] op_sel_hi:[0,1,1] neg_hi:[1,0,0]
    ds_write_b64 v218, v[64:65] offset:5120
    v_cvt_pk_f16_f32 v234, v48, -v49
    v_cvt_pk_f16_f32 v235, v50, -v51
    ds_write_b64 v220, v[234:235] offset:6144
    v_mul_f32 v44, v48, v24
    v_mul_f32 v45, v49, v24
    v_mul_f32 v46, v50, v26
    v_mul_f32 v47, v51, v26
    v_fma_f32 v44, -v49, v25, v44
    v_fmac_f32 v45, v48, v25
    v_fma_f32 v46, -v51, v27, v46
    v_fmac_f32 v47, v50, v27
    v_pk_mul_f16 v66, v234, v244 op_sel_hi:[1,0]
    v_pk_mul_f16 v67, v235, v245 op_sel_hi:[1,0]
    v_pk_fma_f16 v66, v234, v244, v66 op_sel:[1,1,0] op_sel_hi:[0,1,1] neg_hi:[1,0,0]
    v_pk_fma_f16 v67, v235, v245, v67 op_sel:[1,1,0] op_sel_hi:[0,1,1] neg_hi:[1,0,0]
    ds_write_b64 v221, v[66:67] offset:6656
    v_pk_mul_f16 v68, v234, v232 op_sel_hi:[1,0]
    v_pk_mul_f16 v69, v235, v233 op_sel_hi:[1,0]
    v_pk_fma_f16 v68, v234, v232, v68 op_sel:[1,1,0] op_sel_hi:[0,1,1] neg_hi:[1,0,0]
    v_pk_fma_f16 v69, v235, v233, v69 op_sel:[1,1,0] op_sel_hi:[0,1,1] neg_hi:[1,0,0]
    ds_write_b64 v222, v[68:69] offset:7168
    v_and_b32 v204, 31, v1
    v_lshlrev_b32 v204, 7, v204
    buffer_load_dwordx2 v[206:207], v204, s[4:7], 0 offen offset:0 sc1
    ds_write_b64 v216, v[250:251] offset:12288
    v_pk_mul_f16 v70, v250, v240 op_sel_hi:[1,0]
    v_pk_mul_f16 v71, v251, v241 op_sel_hi:[1,0]
    v_pk_fma_f16 v70, v250, v240, v70 op_sel:[1,1,0] op_sel_hi:[0,1,1] neg_hi:[1,0,0]
    v_pk_fma_f16 v71, v251, v241, v71 op_sel:[1,1,0] op_sel_hi:[0,1,1] neg_hi:[1,0,0]
    ds_write_b64 v217, v[70:71] offset:12800
    v_pk_mul_f16 v64, v250, v244 op_sel_hi:[1,0]
    v_pk_mul_f16 v65, v251, v245 op_sel_hi:[1,0]
    v_pk_fma_f16 v64, v250, v244, v64 op_sel:[1,1,0] op_sel_hi:[0,1,1] neg_hi:[1,0,0]
    v_pk_fma_f16 v65, v251, v245, v65 op_sel:[1,1,0] op_sel_hi:[0,1,1] neg_hi:[1,0,0]
    ds_write_b64 v218, v[64:65] offset:13312
    ds_write_b64 v220, v[64:65] offset:14336
    v_pk_mul_f16 v66, v250, v246 op_sel_hi:[1,0]
    v_pk_mul_f16 v67, v251, v247 op_sel_hi:[1,0]
    v_pk_fma_f16 v66, v250, v246, v66 op_sel:[1,1,0] op_sel_hi:[0,1,1] neg_hi:[1,0,0]
    v_pk_fma_f16 v67, v251, v247, v67 op_sel:[1,1,0] op_sel_hi:[0,1,1] neg_hi:[1,0,0]
    ds_write_b64 v221, v[66:67] offset:14848
    v_pk_mul_f16 v68, v250, v232 op_sel_hi:[1,0]
    v_pk_mul_f16 v69, v251, v233 op_sel_hi:[1,0]
    v_pk_fma_f16 v68, v250, v232, v68 op_sel:[1,1,0] op_sel_hi:[0,1,1] neg_hi:[1,0,0]
    v_pk_fma_f16 v69, v251, v233, v69 op_sel:[1,1,0] op_sel_hi:[0,1,1] neg_hi:[1,0,0]
    ds_write_b64 v222, v[68:69] offset:15360
    v_cvt_pk_f16_f32 v248, v44, -v45
    v_cvt_pk_f16_f32 v249, v46, -v47
    ds_write_b64 v208, v[248:249] offset:8192
    v_mul_f32 v48, v44, v24
    v_mul_f32 v49, v45, v24
    v_mul_f32 v50, v46, v26
    v_mul_f32 v51, v47, v26
    v_fma_f32 v48, -v45, v25, v48
    v_fmac_f32 v49, v44, v25
    v_fma_f32 v50, -v47, v27, v50
    v_fmac_f32 v51, v46, v27
    v_pk_mul_f16 v70, v248, v232 op_sel_hi:[1,0]
    v_pk_mul_f16 v71, v249, v233 op_sel_hi:[1,0]
    v_pk_fma_f16 v70, v248, v232, v70 op_sel:[1,1,0] op_sel_hi:[0,1,1] neg_hi:[1,0,0]
    v_pk_fma_f16 v71, v249, v233, v71 op_sel:[1,1,0] op_sel_hi:[0,1,1] neg_hi:[1,0,0]
    ds_write_b64 v209, v[70:71] offset:8704
    v_cvt_pk_f16_f32 v234, v48, -v49
    v_cvt_pk_f16_f32 v235, v50, -v51
    ds_write_b64 v210, v[234:235] offset:9216
    v_mul_f32 v44, v48, v24
    v_mul_f32 v45, v49, v24
    v_mul_f32 v46, v50, v26
    v_mul_f32 v47, v51, v26
    v_fma_f32 v44, -v49, v25, v44
    v_fmac_f32 v45, v48, v25
    v_fma_f32 v46, -v51, v27, v46
    v_fmac_f32 v47, v50, v27
    v_pk_mul_f16 v64, v234, v232 op_sel_hi:[1,0]
    v_pk_mul_f16 v65, v235, v233 op_sel_hi:[1,0]
    v_pk_fma_f16 v64, v234, v232, v64 op_sel:[1,1,0] op_sel_hi:[0,1,1] neg_hi:[1,0,0]
    v_pk_fma_f16 v65, v235, v233, v65 op_sel:[1,1,0] op_sel_hi:[0,1,1] neg_hi:[1,0,0]
    ds_write_b64 v211, v[64:65] offset:9728
    v_cvt_pk_f16_f32 v248, v44, -v45
    v_cvt_pk_f16_f32 v249, v46, -v47
    ds_write_b64 v212, v[248:249] offset:10240
    v_mul_f32 v48, v44, v24
    v_mul_f32 v49, v45, v24
    v_mul_f32 v50, v46, v26
    v_mul_f32 v51, v47, v26
    v_fma_f32 v48, -v45, v25, v48
    v_fmac_f32 v49, v44, v25
    v_fma_f32 v50, -v47, v27, v50
    v_fmac_f32 v51, v46, v27
    v_pk_mul_f16 v66, v248, v232 op_sel_hi:[1,0]
    v_pk_mul_f16 v67, v249, v233 op_sel_hi:[1,0]
    v_pk_fma_f16 v66, v248, v232, v66 op_sel:[1,1,0] op_sel_hi:[0,1,1] neg_hi:[1,0,0]
    v_pk_fma_f16 v67, v249, v233, v67 op_sel:[1,1,0] op_sel_hi:[0,1,1] neg_hi:[1,0,0]
    ds_write_b64 v213, v[66:67] offset:10752
    v_cvt_pk_f16_f32 v234, v48, -v49
    v_cvt_pk_f16_f32 v235, v50, -v51
    ds_write_b64 v214, v[234:235] offset:11264
    v_pk_mul_f16 v68, v234, v232 op_sel_hi:[1,0]
    v_pk_mul_f16 v69, v235, v233 op_sel_hi:[1,0]
    v_pk_fma_f16 v68, v234, v232, v68 op_sel:[1,1,0] op_sel_hi:[0,1,1] neg_hi:[1,0,0]
    v_pk_fma_f16 v69, v235, v233, v69 op_sel:[1,1,0] op_sel_hi:[0,1,1] neg_hi:[1,0,0]
    ds_write_b64 v215, v[68:69] offset:11776
    ds_read_b128 v[136:139], v224 offset:0
    ds_read_b128 v[140:143], v225 offset:0
    ds_read_b128 v[144:147], v226 offset:0
    ds_read_b128 v[148:151], v227 offset:0
    ds_read_b128 v[152:155], v228 offset:0
    ds_read_b128 v[156:159], v229 offset:0
    ds_read_b128 v[160:163], v230 offset:0
    ds_read_b128 v[164:167], v231 offset:0
    ds_read_b128 v[168:171], v224 offset:256
    ds_read_b128 v[172:175], v225 offset:256
    ds_read_b128 v[176:179], v226 offset:256
    ds_read_b128 v[180:183], v227 offset:256
    ds_read_b128 v[184:187], v228 offset:256
    ds_read_b128 v[188:191], v229 offset:256
    ds_read_b128 v[192:195], v230 offset:256
    ds_read_b128 v[196:199], v231 offset:256
    v_lshlrev_b32 v205, 4, v1
    s_cmp_ge_u32 s3, 4
    s_cbranch_scc1 SK_r
    v_mov_b32 v200, 163824
    s_mov_b32 s53, 0
LS_76:
    ds_read_b32 v201, v200
    s_waitcnt lgkmcnt(0)
    v_readfirstlane_b32 s54, v201
    s_nop 0
    s_cmp_ge_u32 s54, 2
    s_cbranch_scc1 LD_77
    s_add_u32 s53, s53, 1
    s_cmp_gt_u32 s53, 3200000
    s_cbranch_scc1 LD_77
    s_sleep 1
    s_branch LS_76
LD_77:
    ds_read_b128 v[72:75], v224 offset:32768
    ds_read_b128 v[76:79], v225 offset:32768
    ds_read_b128 v[80:83], v226 offset:32768
    ds_read_b128 v[84:87], v227 offset:32768
    ds_read_b128 v[88:91], v228 offset:32768
    ds_read_b128 v[92:95], v229 offset:32768
    ds_read_b128 v[96:99], v230 offset:32768
    ds_read_b128 v[100:103], v231 offset:32768
    ds_read_b128 v[104:107], v224 offset:33024
    ds_read_b128 v[108:111], v225 offset:33024
    ds_read_b128 v[112:115], v226 offset:33024
    ds_read_b128 v[116:119], v227 offset:33024
    ds_read_b128 v[120:123], v228 offset:33024
    ds_read_b128 v[124:127], v229 offset:33024
    ds_read_b128 v[128:131], v230 offset:33024
    ds_read_b128 v[132:135], v231 offset:33024
    v_mov_b32 v200, 163808
    s_mov_b32 s53, 0
LS_78:
    ds_read_b32 v201, v200
    s_waitcnt lgkmcnt(0)
    v_readfirstlane_b32 s54, v201
    s_nop 0
    s_cmp_ge_u32 s54, 2
    s_cbranch_scc1 LD_79
    s_add_u32 s53, s53, 1
    s_cmp_gt_u32 s53, 3200000
    s_cbranch_scc1 LD_79
    s_sleep 1
    s_branch LS_78
LD_79:
    s_branch SK_t
SK_r:
    s_mov_b64 s[56:57], -1
    s_mov_b32 s53, 0
    s_waitcnt vmcnt(0)
PL_80:
    v_cmp_eq_u64 vcc, s[50:51], v[206:207]
    s_nop 0
    s_andn2_b64 s[54:55], s[56:57], vcc
    s_cbranch_scc0 PD_81
    s_add_u32 s53, s53, 1
    s_cmp_gt_u32 s53, 200000
    s_cbranch_scc1 PD_81
    s_sleep 2
    buffer_load_dwordx2 v[206:207], v204, s[4:7], 0 offen offset:0 sc1
    s_waitcnt vmcnt(0)
    s_branch PL_80
PD_81:
    s_lshl_b32 s32, s49, 12
    buffer_load_dwordx4 v[16:19], v205, s[16:19], s32 offen offset:0 sc1
    buffer_load_dwordx4 v[20:23], v205, s[16:19], s32 offen offset:1024 sc1
    buffer_load_dwordx4 v[24:27], v205, s[16:19], s32 offen offset:2048 sc1
    buffer_load_dwordx4 v[28:31], v205, s[16:19], s32 offen offset:3072 sc1
    s_mov_b32 s40, s32
    v_lshlrev_b32 v204, 4, v1
    s_getpc_b64 s[32:33]
BX_82:
    v_add_u32 v204, K_box - BX_82 + 2048, v204
    global_load_dwordx4 v[48:51], v204, s[32:33] offset:-2048
    global_load_dwordx4 v[52:55], v204, s[32:33] offset:-1024
    global_load_dwordx4 v[56:59], v204, s[32:33] offset:0
    global_load_dwordx4 v[60:63], v204, s[32:33] offset:1024
    global_load_dwordx4 v[64:67], v204, s[32:33] offset:2048
    s_mov_b32 s32, s40
SK_t:
    s_waitcnt lgkmcnt(0)
    v_mfma_f32_32x32x16_f16 v[240:255], v[136:139], v[72:75], 0
    v_mov_b32 v32, 0
    v_mov_b32 v33, 0
    v_mfma_f32_32x32x16_f16 v[240:255], v[140:143], v[76:79], v[240:255]
    v_mov_b32 v34, 0
    v_mov_b32 v35, 0
    v_mfma_f32_32x32x16_f16 v[240:255], v[144:147], v[80:83], v[240:255]
    v_lshl_add_u32 v203, v1, 4, s34
    ds_write_b128 v203, v[32:35] offset:2048
    v_mfma_f32_32x32x16_f16 v[240:255], v[148:151], v[84:87], v[240:255]
    ds_write_b128 v203, v[32:35] offset:6208
    v_and_b32 v200, 31, v1
    v_mfma_f32_32x32x16_f16 v[240:255], v[152:155], v[88:91], v[240:255]
    v_lshrrev_b32 v201, 5, v1
    v_lshlrev_b32 v202, 4, v200
    v_mfma_f32_32x32x16_f16 v[240:255], v[156:159], v[92:95], v[240:255]
    v_sub_u32 v202, s34, v202
    v_lshlrev_b32 v203, 3, v201
    v_mfma_f32_32x32x16_f16 v[240:255], v[160:163], v[96:99], v[240:255]
    v_sub_u32 v202, v202, v203
    v_lshrrev_b32 v200, 1, v200
    v_mfma_f32_32x32x16_f16 v[240:255], v[164:167], v[100:103], v[240:255]
    v_lshlrev_b32 v200, 2, v200
    v_sub_u32 v203, s34, v200
    v_mfma_f32_32x32x16_f16 v[240:255], v[168:171], v[104:107], v[240:255]
    v_and_b32 v204, 1, v1
    v_lshlrev_b32 v200, 6, v201
    v_mfma_f32_32x32x16_f16 v[240:255], v[172:175], v[108:111], v[240:255]
    v_sub_u32 v203, v203, v200
    v_sub_u32 v12, v203, v200
    v_mfma_f32_32x32x16_f16 v[240:255], v[176:179], v[112:115], v[240:255]
    v_mul_u32_u24 v200, 192, v204
    v_add_u32 v203, v203, v200
    v_mfma_f32_32x32x16_f16 v[240:255], v[180:183], v[116:119], v[240:255]
    v_lshl_add_u32 v12, v204, 10, v12
    v_lshlrev_b32 v200, 4, v204
    v_mfma_f32_32x32x16_f16 v[240:255], v[184:187], v[120:123], v[240:255]
    v_bfe_u32 v201, v1, 1, 1
    v_mul_u32_u24 v201, 4160, v201
    v_mfma_f32_32x32x16_f16 v[240:255], v[188:191], v[124:127], v[240:255]
    v_add3_u32 v200, v200, v201, s34
    v_mov_b32 v204, s34
    v_mfma_f32_32x32x16_f16 v[240:255], v[192:195], v[128:131], v[240:255]
    v_add_u32 v201, 2048, v204
    v_mfma_f32_32x32x16_f16 v[240:255], v[196:199], v[132:135], v[240:255]
    s_nop 11
    v_mul_f32 v72, v240, v14
    v_mul_f32 v73, v241, v14
    v_mul_f32 v74, v242, v14
    v_mul_f32 v75, v243, v14
    v_mul_f32 v79, v247, v14
    v_mul_f32 v84, v252, v14
    v_mul_f32 v85, v253, v14
    v_mul_f32 v86, v254, v14
    v_mul_f32 v76, v244, v14
    v_mul_f32 v77, v245, v14
    v_mul_f32 v78, v246, v14
    v_mul_f32 v80, v248, v14
    v_mul_f32 v81, v249, v14
    v_mul_f32 v82, v250, v14
    v_mul_f32 v83, v251, v14
    v_cvt_pk_bf16_f32 v88, v75, v74
    v_cvt_pk_bf16_f32 v89, v73, v72
    v_cvt_pk_bf16_f32 v104, v79, v75
    v_cvt_pk_bf16_f32 v105, v74, v73
    v_cvt_pk_bf16_f32 v11, v72, 0
    ds_write_b64 v202, v[88:89] offset:4088
    ds_write_b64 v202, v[104:105] offset:8248
    v_cvt_pk_bf16_f32 v90, v86, v85
    v_cvt_pk_bf16_f32 v91, v84, v84
    v_cvt_pk_bf16_f32 v106, v86, v86
    v_cvt_pk_bf16_f32 v107, v85, v84
    v_readfirstlane_b32 s40, v11
    ds_write_b64 v202, v[90:91] offset:3576
    ds_write_b64 v202, v[106:107] offset:7736
    v_cvt_pk_bf16_f32 v92, v77, v78
    v_cvt_pk_bf16_f32 v93, v80, v81
    v_cvt_pk_bf16_f32 v94, v82, v83
    v_cvt_pk_bf16_f32 v109, v76, v76
    v_cvt_pk_bf16_f32 v110, v80, v80
    v_writelane_b32 v32, s40, 2
    ds_write_b32 v203, v92 offset:2236
    ds_write_b32 v12, v93 offset:1820
    ds_write_b32 v12, v94 offset:1756
    v_and_b32 v108, 0xffff0000, v109
    v_and_b32 v111, 0xffff0000, v110
    v_and_b32 v112, 0xffff, v110
    s_mov_b64 exec, 15
    ds_write_b128 v200, v[32:35] offset:4096
    s_mov_b64 exec, 1
    ds_write2_b32 v201, v108, v109 offset0:254 offset1:255
    ds_write2_b32 v201, v111, v112 offset0:125 offset1:126
    ds_write_b32 v204, v109 offset:7228
    ds_write_b32 v204, v110 offset:6712
    s_mov_b64 exec, -1
    v_mov_b32 v36, 163804
    v_mov_b32 v37, 1
    s_waitcnt lgkmcnt(0)
    s_mov_b64 exec, 1
    ds_add_u32 v36, v37
    s_mov_b64 exec, -1
    s_cmp_ge_u32 s3, 4
    s_cbranch_scc1 SK_a
    s_branch S_g2
SK_a:
    v_mov_b32 v13, 0
    s_mov_b32 s24, s72
    s_mov_b32 s25, s73
    s_mov_b32 s26, 0x500
    s_mov_b32 s27, 0x20000
    s_lshl_b32 s33, s49, 1
    buffer_load_ushort v207, v4, s[24:27], s33 offen
    buffer_load_ushort v206, v4, s[24:27], s33 offen offset:4
    s_cmp_ge_u32 s3, 6
    s_cbranch_scc1 SK_67
    s_add_u32 s32, s32, 16384
    s_add_u32 m0, s44, 13440
    s_nop 0
    buffer_load_dwordx4 v205, s[16:19], s32 offen offset:0 sc1 lds
    buffer_load_dwordx4 v205, s[16:19], s32 offen offset:1024 sc1 lds
    buffer_load_dwordx4 v205, s[16:19], s32 offen offset:2048 sc1 lds
    buffer_load_dwordx4 v205, s[16:19], s32 offen offset:3072 sc1 lds
    s_waitcnt vmcnt(4)
    s_branch SK_w
SK_67:
    v_mov_b32 v36, 163808
    v_mov_b32 v37, 1
    s_waitcnt lgkmcnt(0)
    s_mov_b64 exec, 1
    ds_add_u32 v36, v37
    s_mov_b64 exec, -1
    s_waitcnt vmcnt(0)
SK_w:
    v_add_u32 v205, s44, v205
    ds_write_b128 v205, v[16:19] offset:512
    ds_write_b128 v205, v[20:23] offset:1536
    ds_write_b128 v205, v[24:27] offset:2560
    ds_write_b128 v205, v[28:31] offset:3584
    s_cmp_eq_u32 s3, 6
    s_cselect_b32 s37, 17536, 0
    s_add_u32 s37, s37, 141632
    s_add_u32 s34, s44, 4608
    v_mov_b32 v40, 0
    v_mov_b32 v41, 0
    v_lshlrev_b32 v42, 3, v1
    v_add_u32 v42, s44, v42
    ds_write_b64 v42, v[40:41]
    v_and_b32 v2, 15, v1
    v_lshrrev_b32 v3, 4, v1
    v_lshlrev_b32 v15, 5, v2
    v_lshl_add_u32 v7, v3, 4, v15
    s_add_u32 s33, s44, 32
    v_add_u32 v7, s33, v7
    v_and_b32 v44, 1, v1
    v_mul_u32_u24 v4, 4160, v44
    v_lshlrev_b32 v68, 4, v3
    v_sub_u32 v68, v68, v4
    v_add_u32 v4, 1, v2
    v_lshrrev_b32 v4, 1, v4
    v_lshlrev_b32 v4, 2, v4
    v_sub_u32 v68, v68, v4
    s_add_u32 s33, s34, 7264
    v_add_u32 v68, s33, v68
    v_subrev_u32 v69, 576, v68
    v_lshlrev_b32 v4, 2, v3
    v_sub_u32 v4, v4, v2
    s_add_u32 s33, s34, 2108
    v_lshl_add_u32 v70, v4, 2, s33
    v_lshrrev_b32 v4, 2, v2
    v_lshlrev_b32 v15, 7, v4
    v_and_b32 v4, 3, v2
    v_lshl_add_u32 v15, v4, 4, v15
    v_lshrrev_b32 v4, 1, v3
    v_lshl_add_u32 v15, v4, 6, v15
    v_and_b32 v4, 1, v3
    v_lshl_add_u32 v15, v4, 9, v15
    v_lshlrev_b32 v4, 3, v3
    v_sub_u32 v4, v2, v4
    v_add_u32 v4, 16, v4
    v_ashrrev_i32 v4, 1, v4
    v_lshlrev_b32 v44, 4, v44
    s_waitcnt vmcnt(4)
    v_lshlrev_b32 v44, v44, v207
    v_cmp_eq_u32 vcc, 0, v4
    s_nop 1
    v_cndmask_b32 v40, 0, v44, vcc
    v_cmp_eq_u32 vcc, 1, v4
    s_nop 1
    v_cndmask_b32 v41, 0, v44, vcc
    v_cmp_eq_u32 vcc, 2, v4
    s_nop 1
    v_cndmask_b32 v42, 0, v44, vcc
    v_cmp_eq_u32 vcc, 3, v4
    s_nop 1
    v_cndmask_b32 v43, 0, v44, vcc
    s_branch CONV
C_idle:
    s_waitcnt vmcnt(0)
    s_setprio 0
    s_add_u32 s16, s86, 0x1400000
    s_addc_u32 s17, s87, 0
    s_mov_b32 s18, 0x280000
    s_mov_b32 s19, 0x20000
    s_add_u32 s20, s86, 0x1800000
    s_addc_u32 s21, s87, 0
    s_mov_b32 s22, 0x4b000
    s_mov_b32 s23, 0x20000
    s_lshl_b32 s40, s44, 1
    s_add_u32 s40, s40, s3
    s_sub_u32 s40, s40, 2
    s_mul_i32 s41, s40, 28672
    s_lshl_b32 s40, s40, 7
    s_add_u32 s40, s40, 151552
    v_mov_b32 v16, 0x7fa57fa5
    v_lshlrev_b32 v20, 4, v1
    s_mov_b32 s24, s84
    s_mov_b32 s25, s85
    s_mov_b32 s26, 0x100
    s_mov_b32 s27, 0x20000
    v_mov_b32 v22, 0
    s_barrier
    buffer_load_dwordx2 v[24:25], v22, s[24:27], 0 offen sc1
    buffer_store_dwordx4 v[16:19], v20, s[16:19], s41 offen offset:0 sc1
    buffer_store_dwordx4 v[16:19], v20, s[16:19], s41 offen offset:1024 sc1
    buffer_store_dwordx4 v[16:19], v20, s[16:19], s41 offen offset:2048 sc1
    buffer_store_dwordx4 v[16:19], v20, s[16:19], s41 offen offset:3072 sc1
    s_add_u32 s41, s41, 4096
    buffer_store_dwordx4 v[16:19], v20, s[16:19], s41 offen offset:0 sc1
    buffer_store_dwordx4 v[16:19], v20, s[16:19], s41 offen offset:1024 sc1
    buffer_store_dwordx4 v[16:19], v20, s[16:19], s41 offen offset:2048 sc1
    s_barrier
    buffer_store_dwordx4 v[16:19], v20, s[16:19], s41 offen offset:3072 sc1
    s_add_u32 s41, s41, 4096
    buffer_store_dwordx4 v[16:19], v20, s[16:19], s41 offen offset:0 sc1
    buffer_store_dwordx4 v[16:19], v20, s[16:19], s41 offen offset:1024 sc1
    buffer_store_dwordx4 v[16:19], v20, s[16:19], s41 offen offset:2048 sc1
    buffer_store_dwordx4 v[16:19], v20, s[16:19], s41 offen offset:3072 sc1
    s_add_u32 s41, s41, 4096
    buffer_store_dwordx4 v[16:19], v20, s[16:19], s41 offen offset:0 sc1
    buffer_store_dwordx4 v[16:19], v20, s[16:19], s41 offen offset:1024 sc1
    s_barrier
    buffer_store_dwordx4 v[16:19], v20, s[16:19], s41 offen offset:2048 sc1
    buffer_store_dwordx4 v[16:19], v20, s[16:19], s41 offen offset:3072 sc1
    s_add_u32 s41, s41, 4096
    buffer_store_dwordx4 v[16:19], v20, s[16:19], s41 offen offset:0 sc1
    buffer_store_dwordx4 v[16:19], v20, s[16:19], s41 offen offset:1024 sc1
    buffer_store_dwordx4 v[16:19], v20, s[16:19], s41 offen offset:2048 sc1
    buffer_store_dwordx4 v[16:19], v20, s[16:19], s41 offen offset:3072 sc1
    s_add_u32 s41, s41, 4096
    buffer_store_dwordx4 v[16:19], v20, s[16:19], s41 offen offset:0 sc1
    s_barrier
    buffer_store_dwordx4 v[16:19], v20, s[16:19], s41 offen offset:1024 sc1
    buffer_store_dwordx4 v[16:19], v20, s[16:19], s41 offen offset:2048 sc1
    buffer_store_dwordx4 v[16:19], v20, s[16:19], s41 offen offset:3072 sc1
    s_add_u32 s41, s41, 4096
    buffer_store_dwordx4 v[16:19], v20, s[16:19], s41 offen offset:0 sc1
    buffer_store_dwordx4 v[16:19], v20, s[16:19], s41 offen offset:1024 sc1
    buffer_store_dwordx4 v[16:19], v20, s[16:19], s41 offen offset:2048 sc1
    buffer_store_dwordx4 v[16:19], v20, s[16:19], s41 offen offset:3072 sc1
    s_add_u32 s41, s41, 4096
    s_barrier
    s_barrier
    s_barrier
    s_barrier
    s_mov_b32 s53, 0
    s_waitcnt vmcnt(0)
TG_83:
    v_readfirstlane_b32 s50, v24
    v_readfirstlane_b32 s51, v25
    s_cmp_lg_u32 s50, 0
    s_cbranch_scc1 TD_84
    s_add_u32 s53, s53, 1
    s_cmp_gt_u32 s53, 200000
    s_cbranch_scc1 TD_84
    s_sleep 2
    buffer_load_dwordx2 v[24:25], v22, s[24:27], 0 offen sc1
    s_waitcnt vmcnt(0)
    s_branch TG_83
TD_84:
    s_mov_b64 exec, 1
    v_mov_b32 v26, s50
    v_mov_b32 v27, s51
    buffer_store_dwordx2 v[26:27], v22, s[20:23], s40 offen offset:0 sc1
    s_mov_b64 exec, -1
    s_barrier
    s_barrier
    s_barrier
    s_barrier
    s_barrier
    s_barrier
    s_barrier
    s_barrier
    s_barrier
    s_barrier
    s_barrier
    s_setprio 2
    s_branch C_last
COMPUTE:
    s_setprio 2
    s_and_b32 s57, s2, 7
    s_mul_i32 s57, s57, 4
    s_mov_b32 s40, 0x33333333
    s_mov_b32 s41, 0x0
    s_lshr_b64 s[40:41], s[40:41], s57
    s_and_b32 s57, s40, 0xf
    s_lshr_b32 s56, s46, 3
    s_mul_i32 s56, s56, s57
    s_add_u32 s56, s56, s3
    s_cmp_ge_u32 s3, s57
    s_cselect_b32 s56, 600, s56
    s_and_b32 s57, s2, 7
    s_mul_i32 s57, s57, 8
    s_mov_b32 s40, 0x44444444
    s_mov_b32 s41, 0x43434343
    s_lshr_b64 s[40:41], s[40:41], s57
    s_and_b32 s57, s40, 0xff
    s_cmp_ge_u32 s56, s57
    s_cselect_b32 s56, 600, s56
    s_and_b32 s57, s2, 7
    s_mul_i32 s57, s57, 8
    s_mov_b32 s40, 0x520e8700
    s_mov_b32 s41, 0xd996cb44
    s_lshr_b64 s[40:41], s[40:41], s57
    s_and_b32 s57, s40, 0xff
    s_and_b32 s58, s2, 7
    s_mul_i32 s58, s58, 4
    s_mov_b32 s40, 0x11001100
    s_mov_b32 s41, 0x0
    s_lshr_b64 s[40:41], s[40:41], s58
    s_and_b32 s58, s40, 0xf
    s_lshl_b32 s58, s58, 8
    s_add_u32 s56, s56, s57
    s_add_u32 s56, s56, s58
    v_lshrrev_b32 v65, 4, v1
    v_lshlrev_b32 v65, 1, v65
    v_and_b32 v64, 7, v1
    v_xor_b32 v64, v64, v65
    v_lshlrev_b32 v64, 4, v64
    v_lshrrev_b32 v65, 3, v1
    v_mul_u32_u24 v65, 1280, v65
    v_add_u32 v64, v64, v65
    s_mul_hi_u32 s58, s56, 0x4bda130
    s_mul_i32 s57, s58, 54
    s_sub_u32 s57, s56, s57
    s_cmp_ge_u32 s58, 10
    s_cselect_b32 s57, 60, s57
    s_mul_i32 s42, s57, 40960
    s_lshl_b32 s43, s58, 7
    s_add_u32 s42, s42, s43
    s_lshl_b32 s59, s3, 12
    s_add_u32 s59, s59, 16384
    s_waitcnt lgkmcnt(0)
    s_mov_b32 s4, s80
    s_mov_b32 s5, s81
    s_mov_b32 s6, 0x21c000
    s_mov_b32 s7, 0x20000
    s_mov_b32 s28, s42
    s_add_u32 m0, s59, 0
    s_nop 0
    buffer_load_dwordx4 v64, s[4:7], s28 offen nt lds
    s_add_u32 s28, s28, 10240
    s_add_u32 m0, s59, 1024
    s_nop 0
    buffer_load_dwordx4 v64, s[4:7], s28 offen nt lds
    s_add_u32 s28, s28, 10240
    s_add_u32 m0, s59, 2048
    s_nop 0
    buffer_load_dwordx4 v64, s[4:7], s28 offen nt lds
    s_add_u32 s28, s28, 10240
    s_add_u32 m0, s59, 3072
    s_nop 0
    buffer_load_dwordx4 v64, s[4:7], s28 offen nt lds
    s_add_u32 s8, s86, 0x900000
    s_addc_u32 s9, s87, 0
    s_mov_b32 s10, 0x21c000
    s_mov_b32 s11, 0x20000
    s_lshr_b32 s32, s44, 3
    s_mul_i32 s32, s32, 5
    s_add_u32 s32, s32, 1
    s_cmp_ge_u32 s3, 2
    s_cbranch_scc1 XT_w
    s_mov_b32 s16, s60
    s_mov_b32 s17, s61
    s_mov_b32 s18, 0x280000
    s_mov_b32 s19, 0x20000
    s_lshl_b32 s33, s3, 1
    s_add_u32 s32, s32, s33
    v_and_b32 v16, 1, v1
    v_lshrrev_b32 v17, 1, v1
    s_and_b32 s34, s45, 3
    s_lshl_b32 s35, s44, 2
    s_add_u32 s34, s34, s35
    s_lshl_b32 s34, s34, 5
    v_add_u32 v17, s34, v17
    v_mul_u32_u24 v17, 1280, v17
    s_movk_i32 s33, 128
    s_mov_b32 s18, 0
    s_branch XT_j
XT_w:
    s_cmp_eq_u32 s3, 2
    s_cselect_b32 s16, s76, s78
    s_cselect_b32 s17, s77, s79
    s_mov_b32 s18, 0x21c000
    s_mov_b32 s19, 0x20000
    v_lshrrev_b32 v16, 4, v1
    v_bfe_u32 v17, v1, 1, 3
    s_and_b32 s34, s44, 7
    s_lshl_b32 s34, s34, 3
    v_add_u32 v17, s34, v17
    v_mul_u32_u24 v17, 3456, v17
    v_and_b32 v18, 1, v1
    s_cmp_eq_u32 s45, 13
    s_cselect_b32 s34, 30, 7
    v_lshl_add_u32 v17, v18, s34, v17
    s_lshl_b32 s34, s45, 8
    v_add_u32 v17, s34, v17
    s_mov_b32 s33, 221184
XT_j:
    v_add_u32 v16, s32, v16
    v_subrev_u32 v18, 10, v16
    v_min_u32 v16, v16, v18
    v_mul_lo_u32 v18, v16, s33
    v_add_u32 v252, v18, v17
    v_add_u32 v16, 4, v16
    v_subrev_u32 v18, 10, v16
    v_min_u32 v16, v16, v18
    v_mul_lo_u32 v18, v16, s33
    v_add_u32 v253, v18, v17
    s_add_u32 s12, s86, 0x1710000
    s_addc_u32 s13, s87, 0
    s_mov_b32 s14, 0x23000
    s_mov_b32 s15, 0x20000
    v_lshrrev_b32 v11, 4, v1
    v_bfe_u32 v12, v1, 2, 2
    v_and_b32 v13, 3, v1
    v_lshl_add_u32 v2, v11, 3, v12
    v_lshlrev_b32 v2, 8, v2
    v_lshl_add_u32 v2, v13, 3, v2
    v_and_b32 v14, 1, v11
    v_lshl_or_b32 v14, v14, 2, v12
    s_lshl_b32 s34, s3, 1
    v_xor_b32 v14, s34, v14
    v_lshl_add_u32 v2, v14, 5, v2
    v_xor_b32 v3, 32, v2
    v_and_b32 v14, 15, v1
    v_cmp_eq_u32 vcc, 0, v14
    v_lshlrev_b32 v4, 7, v14
    v_lshrrev_b32 v14, 1, v14
    v_xor_b32 v14, v14, v11
    v_lshl_add_u32 v4, v14, 4, v4
    v_xor_b32 v5, 64, v4
    v_lshlrev_b32 v10, 4, v11
    v_mov_b32 v14, 0x7ff00000
    v_cndmask_b32 v10, v14, v10, vcc
    v_mov_b32 v12, 0x3f803f80
    v_mov_b32 v13, 0x3f803f80
    v_mov_b32 v14, 0x3f803f80
    v_mov_b32 v15, 0x3f803f80
    s_and_b32 s37, s44, 7
    s_lshr_b32 s38, s44, 3
    s_mul_i32 s38, s38, 5
    s_add_u32 s38, s38, s37
    s_mul_i32 s38, s38, 14
    s_add_u32 s38, s38, s45
    s_lshl_b32 s38, s38, 3
    s_add_u32 s38, s38, s3
    s_lshl_b32 s38, s38, 7
    v_lshrrev_b32 v65, 2, v1
    v_lshlrev_b32 v66, 7, v65
    v_bfe_u32 v65, v1, 3, 2
    v_lshl_add_u32 v66, v65, 5, v66
    v_and_b32 v65, 3, v1
    v_lshl_add_u32 v66, v65, 3, v66
    v_add_u32 v66, s59, v66
    v_xor_b32 v67, 32, v66
    v_xor_b32 v68, 64, v66
    v_xor_b32 v69, 96, v66
    v_lshlrev_b32 v70, 4, v1
    s_lshl_b32 s42, s58, 2
    s_add_u32 s42, s42, 0
    s_mul_hi_u32 s43, s42, 0x33333334
    s_mul_i32 s40, s43, 5
    s_sub_u32 s40, s42, s40
    s_mul_i32 s43, s43, 54
    s_add_u32 s43, s43, s57
    s_mul_i32 s43, s43, 5
    s_add_u32 s43, s43, s40
    s_lshl_b32 s43, s43, 10
    s_cmp_ge_u32 s57, 54
    s_cselect_b32 s24, 0x7ff00000, s43
    s_lshl_b32 s42, s58, 2
    s_add_u32 s42, s42, 1
    s_mul_hi_u32 s43, s42, 0x33333334
    s_mul_i32 s40, s43, 5
    s_sub_u32 s40, s42, s40
    s_mul_i32 s43, s43, 54
    s_add_u32 s43, s43, s57
    s_mul_i32 s43, s43, 5
    s_add_u32 s43, s43, s40
    s_lshl_b32 s43, s43, 10
    s_cmp_ge_u32 s57, 54
    s_cselect_b32 s25, 0x7ff00000, s43
    s_lshl_b32 s42, s58, 2
    s_add_u32 s42, s42, 2
    s_mul_hi_u32 s43, s42, 0x33333334
    s_mul_i32 s40, s43, 5
    s_sub_u32 s40, s42, s40
    s_mul_i32 s43, s43, 54
    s_add_u32 s43, s43, s57
    s_mul_i32 s43, s43, 5
    s_add_u32 s43, s43, s40
    s_lshl_b32 s43, s43, 10
    s_cmp_ge_u32 s57, 54
    s_cselect_b32 s26, 0x7ff00000, s43
    s_lshl_b32 s42, s58, 2
    s_add_u32 s42, s42, 3
    s_mul_hi_u32 s43, s42, 0x33333334
    s_mul_i32 s40, s43, 5
    s_sub_u32 s40, s42, s40
    s_mul_i32 s43, s43, 54
    s_add_u32 s43, s43, s57
    s_mul_i32 s43, s43, 5
    s_add_u32 s43, s43, s40
    s_lshl_b32 s43, s43, 10
    s_cmp_ge_u32 s57, 54
    s_cselect_b32 s27, 0x7ff00000, s43
    v_add_u32 v6, 114688, v2
    v_add_u32 v7, 114688, v3
    v_add_u32 v2, 32768, v2
    v_add_u32 v3, 32768, v3
    v_add_u32 v8, 81920, v4
    v_add_u32 v9, 81920, v5
    s_lshl_b32 s34, s45, 2
    s_add_u32 s34, s34, s3
    s_barrier
    ds_read_b128 v[32:35], v8 offset:0
    ds_read_b64_tr_b16 v[16:17], v2 offset:0
    ds_read_b64_tr_b16 v[18:19], v2 offset:1024
    ds_read_b64_tr_b16 v[20:21], v3 offset:0
    ds_read_b64_tr_b16 v[22:23], v3 offset:1024
    ds_read_b64_tr_b16 v[24:25], v2 offset:8192
    ds_read_b64_tr_b16 v[26:27], v2 offset:9216
    ds_read_b64_tr_b16 v[28:29], v3 offset:8192
    ds_read_b64_tr_b16 v[30:31], v3 offset:9216
    ds_read_b128 v[36:39], v8 offset:2048
    ds_read_b128 v[40:43], v8 offset:4096
    ds_read_b128 v[44:47], v8 offset:6144
    ds_read_b128 v[48:51], v8 offset:8192
    ds_read_b128 v[52:55], v8 offset:10240
    ds_read_b128 v[56:59], v8 offset:12288
    ds_read_b128 v[60:63], v8 offset:14336
    s_waitcnt vmcnt(0)
    ds_read_b64_tr_b16 v[72:73], v66 offset:0
    ds_read_b64_tr_b16 v[74:75], v66 offset:2048
    ds_read_b64_tr_b16 v[76:77], v67 offset:0
    ds_read_b64_tr_b16 v[78:79], v67 offset:2048
    ds_read_b64_tr_b16 v[80:81], v68 offset:0
    ds_read_b64_tr_b16 v[82:83], v68 offset:2048
    ds_read_b64_tr_b16 v[84:85], v69 offset:0
    ds_read_b64_tr_b16 v[86:87], v69 offset:2048
    s_waitcnt lgkmcnt(6)
    buffer_store_dwordx4 v[72:75], v70, s[8:11], s24 offen sc1
    s_waitcnt lgkmcnt(4)
    buffer_store_dwordx4 v[76:79], v70, s[8:11], s25 offen sc1
    s_waitcnt lgkmcnt(2)
    buffer_store_dwordx4 v[80:83], v70, s[8:11], s26 offen sc1
    s_waitcnt lgkmcnt(0)
    buffer_store_dwordx4 v[84:87], v70, s[8:11], s27 offen sc1
    buffer_load_dword v0, v252, s[16:19], 0 offen
    s_cmp_ge_u32 s34, 54
    s_cbranch_scc1 C_idle
    s_waitcnt lgkmcnt(0)
    s_barrier
    v_mfma_f32_16x16x32_bf16 v[112:115], v[16:19], v[32:35], 0
    ds_read_b128 v[80:83], v9 offset:0
    v_mfma_f32_16x16x32_bf16 v[116:119], v[20:23], v[32:35], 0
    ds_read_b64_tr_b16 v[64:65], v2 offset:16384
    v_mfma_f32_16x16x32_bf16 v[120:123], v[24:27], v[32:35], 0
    ds_read_b64_tr_b16 v[66:67], v2 offset:17408
    v_mfma_f32_16x16x32_bf16 v[124:127], v[28:31], v[32:35], 0
    ds_read_b64_tr_b16 v[68:69], v3 offset:16384
    v_mfma_f32_16x16x32_bf16 v[128:131], v[16:19], v[36:39], 0
    ds_read_b64_tr_b16 v[70:71], v3 offset:17408
    v_mfma_f32_16x16x32_bf16 v[132:135], v[20:23], v[36:39], 0
    ds_read_b64_tr_b16 v[72:73], v2 offset:24576
    v_mfma_f32_16x16x32_bf16 v[136:139], v[24:27], v[36:39], 0
    ds_read_b64_tr_b16 v[74:75], v2 offset:25600
    v_mfma_f32_16x16x32_bf16 v[140:143], v[28:31], v[36:39], 0
    ds_read_b64_tr_b16 v[76:77], v3 offset:24576
    v_mfma_f32_16x16x32_bf16 v[144:147], v[16:19], v[40:43], 0
    ds_read_b64_tr_b16 v[78:79], v3 offset:25600
    v_mfma_f32_16x16x32_bf16 v[148:151], v[20:23], v[40:43], 0
    ds_read_b128 v[84:87], v9 offset:2048
    v_mfma_f32_16x16x32_bf16 v[152:155], v[24:27], v[40:43], 0
    ds_read_b128 v[88:91], v9 offset:4096
    v_mfma_f32_16x16x32_bf16 v[156:159], v[28:31], v[40:43], 0
    ds_read_b128 v[92:95], v9 offset:6144
    v_mfma_f32_16x16x32_bf16 v[160:163], v[16:19], v[44:47], 0
    ds_read_b128 v[96:99], v9 offset:8192
    v_mfma_f32_16x16x32_bf16 v[164:167], v[20:23], v[44:47], 0
    ds_read_b128 v[100:103], v9 offset:10240
    v_mfma_f32_16x16x32_bf16 v[168:171], v[24:27], v[44:47], 0
    ds_read_b128 v[104:107], v9 offset:12288
    v_mfma_f32_16x16x32_bf16 v[172:175], v[28:31], v[44:47], 0
    ds_read_b128 v[108:111], v9 offset:14336
    v_mfma_f32_16x16x32_bf16 v[176:179], v[16:19], v[48:51], 0
    v_mfma_f32_16x16x32_bf16 v[180:183], v[20:23], v[48:51], 0
    v_mfma_f32_16x16x32_bf16 v[184:187], v[24:27], v[48:51], 0
    v_mfma_f32_16x16x32_bf16 v[188:191], v[28:31], v[48:51], 0
    v_mfma_f32_16x16x32_bf16 v[192:195], v[16:19], v[52:55], 0
    v_mfma_f32_16x16x32_bf16 v[196:199], v[20:23], v[52:55], 0
    v_mfma_f32_16x16x32_bf16 v[200:203], v[24:27], v[52:55], 0
    v_mfma_f32_16x16x32_bf16 v[204:207], v[28:31], v[52:55], 0
    v_mfma_f32_16x16x32_bf16 v[208:211], v[16:19], v[56:59], 0
    v_mfma_f32_16x16x32_bf16 v[212:215], v[20:23], v[56:59], 0
    v_mfma_f32_16x16x32_bf16 v[216:219], v[24:27], v[56:59], 0
    v_mfma_f32_16x16x32_bf16 v[220:223], v[28:31], v[56:59], 0
    v_mfma_f32_16x16x32_bf16 v[224:227], v[16:19], v[60:63], 0
    v_mfma_f32_16x16x32_bf16 v[228:231], v[20:23], v[60:63], 0
    v_mfma_f32_16x16x32_bf16 v[232:235], v[24:27], v[60:63], 0
    v_mfma_f32_16x16x32_bf16 v[236:239], v[28:31], v[60:63], 0
    s_cmp_eq_u32 s37, 0
    s_cbranch_scc1 CS_0
CSR_0:
    s_waitcnt lgkmcnt(0)
    s_barrier
    v_mfma_f32_16x16x32_bf16 v[112:115], v[64:67], v[80:83], v[112:115]
    ds_read_b128 v[32:35], v8 offset:16384
    v_mfma_f32_16x16x32_bf16 v[116:119], v[68:71], v[80:83], v[116:119]
    ds_read_b64_tr_b16 v[16:17], v2 offset:32768
    v_mfma_f32_16x16x32_bf16 v[120:123], v[72:75], v[80:83], v[120:123]
    ds_read_b64_tr_b16 v[18:19], v2 offset:33792
    v_mfma_f32_16x16x32_bf16 v[124:127], v[76:79], v[80:83], v[124:127]
    ds_read_b64_tr_b16 v[20:21], v3 offset:32768
    v_mfma_f32_16x16x32_bf16 v[128:131], v[64:67], v[84:87], v[128:131]
    ds_read_b64_tr_b16 v[22:23], v3 offset:33792
    v_mfma_f32_16x16x32_bf16 v[132:135], v[68:71], v[84:87], v[132:135]
    ds_read_b64_tr_b16 v[24:25], v2 offset:40960
    v_mfma_f32_16x16x32_bf16 v[136:139], v[72:75], v[84:87], v[136:139]
    ds_read_b64_tr_b16 v[26:27], v2 offset:41984
    v_mfma_f32_16x16x32_bf16 v[140:143], v[76:79], v[84:87], v[140:143]
    ds_read_b64_tr_b16 v[28:29], v3 offset:40960
    v_mfma_f32_16x16x32_bf16 v[144:147], v[64:67], v[88:91], v[144:147]
    ds_read_b64_tr_b16 v[30:31], v3 offset:41984
    v_mfma_f32_16x16x32_bf16 v[148:151], v[68:71], v[88:91], v[148:151]
    ds_read_b128 v[36:39], v8 offset:18432
    v_mfma_f32_16x16x32_bf16 v[152:155], v[72:75], v[88:91], v[152:155]
    ds_read_b128 v[40:43], v8 offset:20480
    v_mfma_f32_16x16x32_bf16 v[156:159], v[76:79], v[88:91], v[156:159]
    ds_read_b128 v[44:47], v8 offset:22528
    v_mfma_f32_16x16x32_bf16 v[160:163], v[64:67], v[92:95], v[160:163]
    ds_read_b128 v[48:51], v8 offset:24576
    v_mfma_f32_16x16x32_bf16 v[164:167], v[68:71], v[92:95], v[164:167]
    ds_read_b128 v[52:55], v8 offset:26624
    v_mfma_f32_16x16x32_bf16 v[168:171], v[72:75], v[92:95], v[168:171]
    ds_read_b128 v[56:59], v8 offset:28672
    v_mfma_f32_16x16x32_bf16 v[172:175], v[76:79], v[92:95], v[172:175]
    ds_read_b128 v[60:63], v8 offset:30720
    v_mfma_f32_16x16x32_bf16 v[176:179], v[64:67], v[96:99], v[176:179]
    v_mfma_f32_16x16x32_bf16 v[180:183], v[68:71], v[96:99], v[180:183]
    v_mfma_f32_16x16x32_bf16 v[184:187], v[72:75], v[96:99], v[184:187]
    v_mfma_f32_16x16x32_bf16 v[188:191], v[76:79], v[96:99], v[188:191]
    v_mfma_f32_16x16x32_bf16 v[192:195], v[64:67], v[100:103], v[192:195]
    v_mfma_f32_16x16x32_bf16 v[196:199], v[68:71], v[100:103], v[196:199]
    v_mfma_f32_16x16x32_bf16 v[200:203], v[72:75], v[100:103], v[200:203]
    v_mfma_f32_16x16x32_bf16 v[204:207], v[76:79], v[100:103], v[204:207]
    v_mfma_f32_16x16x32_bf16 v[208:211], v[64:67], v[104:107], v[208:211]
    v_mfma_f32_16x16x32_bf16 v[212:215], v[68:71], v[104:107], v[212:215]
    v_mfma_f32_16x16x32_bf16 v[216:219], v[72:75], v[104:107], v[216:219]
    v_mfma_f32_16x16x32_bf16 v[220:223], v[76:79], v[104:107], v[220:223]
    v_mfma_f32_16x16x32_bf16 v[224:227], v[64:67], v[108:111], v[224:227]
    v_mfma_f32_16x16x32_bf16 v[228:231], v[68:71], v[108:111], v[228:231]
    v_mfma_f32_16x16x32_bf16 v[232:235], v[72:75], v[108:111], v[232:235]
    v_mfma_f32_16x16x32_bf16 v[236:239], v[76:79], v[108:111], v[236:239]
    s_cmp_eq_u32 s37, 0
    s_cbranch_scc1 CS_1
CSR_1:
    s_waitcnt lgkmcnt(0)
    s_barrier
    v_mfma_f32_16x16x32_bf16 v[112:115], v[16:19], v[32:35], v[112:115]
    ds_read_b128 v[80:83], v9 offset:16384
    v_mfma_f32_16x16x32_bf16 v[116:119], v[20:23], v[32:35], v[116:119]
    ds_read_b64_tr_b16 v[64:65], v6 offset:0
    v_mfma_f32_16x16x32_bf16 v[120:123], v[24:27], v[32:35], v[120:123]
    ds_read_b64_tr_b16 v[66:67], v6 offset:1024
    v_mfma_f32_16x16x32_bf16 v[124:127], v[28:31], v[32:35], v[124:127]
    ds_read_b64_tr_b16 v[68:69], v7 offset:0
    v_mfma_f32_16x16x32_bf16 v[128:131], v[16:19], v[36:39], v[128:131]
    ds_read_b64_tr_b16 v[70:71], v7 offset:1024
    v_mfma_f32_16x16x32_bf16 v[132:135], v[20:23], v[36:39], v[132:135]
    ds_read_b64_tr_b16 v[72:73], v6 offset:8192
    v_mfma_f32_16x16x32_bf16 v[136:139], v[24:27], v[36:39], v[136:139]
    ds_read_b64_tr_b16 v[74:75], v6 offset:9216
    v_mfma_f32_16x16x32_bf16 v[140:143], v[28:31], v[36:39], v[140:143]
    ds_read_b64_tr_b16 v[76:77], v7 offset:8192
    v_mfma_f32_16x16x32_bf16 v[144:147], v[16:19], v[40:43], v[144:147]
    ds_read_b64_tr_b16 v[78:79], v7 offset:9216
    v_mfma_f32_16x16x32_bf16 v[148:151], v[20:23], v[40:43], v[148:151]
    ds_read_b128 v[84:87], v9 offset:18432
    v_mfma_f32_16x16x32_bf16 v[152:155], v[24:27], v[40:43], v[152:155]
    ds_read_b128 v[88:91], v9 offset:20480
    v_mfma_f32_16x16x32_bf16 v[156:159], v[28:31], v[40:43], v[156:159]
    ds_read_b128 v[92:95], v9 offset:22528
    v_mfma_f32_16x16x32_bf16 v[160:163], v[16:19], v[44:47], v[160:163]
    ds_read_b128 v[96:99], v9 offset:24576
    v_mfma_f32_16x16x32_bf16 v[164:167], v[20:23], v[44:47], v[164:167]
    ds_read_b128 v[100:103], v9 offset:26624
    v_mfma_f32_16x16x32_bf16 v[168:171], v[24:27], v[44:47], v[168:171]
    ds_read_b128 v[104:107], v9 offset:28672
    v_mfma_f32_16x16x32_bf16 v[172:175], v[28:31], v[44:47], v[172:175]
    ds_read_b128 v[108:111], v9 offset:30720
    v_mfma_f32_16x16x32_bf16 v[176:179], v[16:19], v[48:51], v[176:179]
    v_mfma_f32_16x16x32_bf16 v[180:183], v[20:23], v[48:51], v[180:183]
    v_mfma_f32_16x16x32_bf16 v[184:187], v[24:27], v[48:51], v[184:187]
    v_mfma_f32_16x16x32_bf16 v[188:191], v[28:31], v[48:51], v[188:191]
    v_mfma_f32_16x16x32_bf16 v[192:195], v[16:19], v[52:55], v[192:195]
    v_mfma_f32_16x16x32_bf16 v[196:199], v[20:23], v[52:55], v[196:199]
    v_mfma_f32_16x16x32_bf16 v[200:203], v[24:27], v[52:55], v[200:203]
    v_mfma_f32_16x16x32_bf16 v[204:207], v[28:31], v[52:55], v[204:207]
    v_mfma_f32_16x16x32_bf16 v[208:211], v[16:19], v[56:59], v[208:211]
    v_mfma_f32_16x16x32_bf16 v[212:215], v[20:23], v[56:59], v[212:215]
    v_mfma_f32_16x16x32_bf16 v[216:219], v[24:27], v[56:59], v[216:219]
    v_mfma_f32_16x16x32_bf16 v[220:223], v[28:31], v[56:59], v[220:223]
    v_mfma_f32_16x16x32_bf16 v[224:227], v[16:19], v[60:63], v[224:227]
    v_mfma_f32_16x16x32_bf16 v[228:231], v[20:23], v[60:63], v[228:231]
    v_mfma_f32_16x16x32_bf16 v[232:235], v[24:27], v[60:63], v[232:235]
    v_mfma_f32_16x16x32_bf16 v[236:239], v[28:31], v[60:63], v[236:239]
    s_cmp_eq_u32 s37, 1
    s_cbranch_scc1 CS_2
CSR_2:
    s_waitcnt vmcnt(0) lgkmcnt(0)
    s_barrier
    v_mfma_f32_16x16x32_bf16 v[112:115], v[64:67], v[80:83], v[112:115]
    ds_read_b128 v[32:35], v4 offset:0
    v_mfma_f32_16x16x32_bf16 v[116:119], v[68:71], v[80:83], v[116:119]
    ds_read_b64_tr_b16 v[16:17], v6 offset:16384
    v_mfma_f32_16x16x32_bf16 v[120:123], v[72:75], v[80:83], v[120:123]
    ds_read_b64_tr_b16 v[18:19], v6 offset:17408
    v_mfma_f32_16x16x32_bf16 v[124:127], v[76:79], v[80:83], v[124:127]
    ds_read_b64_tr_b16 v[20:21], v7 offset:16384
    v_mfma_f32_16x16x32_bf16 v[128:131], v[64:67], v[84:87], v[128:131]
    ds_read_b64_tr_b16 v[22:23], v7 offset:17408
    v_mfma_f32_16x16x32_bf16 v[132:135], v[68:71], v[84:87], v[132:135]
    ds_read_b64_tr_b16 v[24:25], v6 offset:24576
    v_mfma_f32_16x16x32_bf16 v[136:139], v[72:75], v[84:87], v[136:139]
    ds_read_b64_tr_b16 v[26:27], v6 offset:25600
    v_mfma_f32_16x16x32_bf16 v[140:143], v[76:79], v[84:87], v[140:143]
    ds_read_b64_tr_b16 v[28:29], v7 offset:24576
    v_mfma_f32_16x16x32_bf16 v[144:147], v[64:67], v[88:91], v[144:147]
    ds_read_b64_tr_b16 v[30:31], v7 offset:25600
    v_mfma_f32_16x16x32_bf16 v[148:151], v[68:71], v[88:91], v[148:151]
    ds_read_b128 v[36:39], v4 offset:2048
    v_mfma_f32_16x16x32_bf16 v[152:155], v[72:75], v[88:91], v[152:155]
    ds_read_b128 v[40:43], v4 offset:4096
    v_mfma_f32_16x16x32_bf16 v[156:159], v[76:79], v[88:91], v[156:159]
    ds_read_b128 v[44:47], v4 offset:6144
    v_mfma_f32_16x16x32_bf16 v[160:163], v[64:67], v[92:95], v[160:163]
    ds_read_b128 v[48:51], v4 offset:8192
    v_mfma_f32_16x16x32_bf16 v[164:167], v[68:71], v[92:95], v[164:167]
    ds_read_b128 v[52:55], v4 offset:10240
    v_mfma_f32_16x16x32_bf16 v[168:171], v[72:75], v[92:95], v[168:171]
    ds_read_b128 v[56:59], v4 offset:12288
    v_mfma_f32_16x16x32_bf16 v[172:175], v[76:79], v[92:95], v[172:175]
    ds_read_b128 v[60:63], v4 offset:14336
    v_mfma_f32_16x16x32_bf16 v[176:179], v[64:67], v[96:99], v[176:179]
    v_mfma_f32_16x16x32_bf16 v[180:183], v[68:71], v[96:99], v[180:183]
    v_mfma_f32_16x16x32_bf16 v[184:187], v[72:75], v[96:99], v[184:187]
    v_mfma_f32_16x16x32_bf16 v[188:191], v[76:79], v[96:99], v[188:191]
    v_mfma_f32_16x16x32_bf16 v[192:195], v[64:67], v[100:103], v[192:195]
    v_mfma_f32_16x16x32_bf16 v[196:199], v[68:71], v[100:103], v[196:199]
    v_mfma_f32_16x16x32_bf16 v[200:203], v[72:75], v[100:103], v[200:203]
    v_mfma_f32_16x16x32_bf16 v[204:207], v[76:79], v[100:103], v[204:207]
    v_mfma_f32_16x16x32_bf16 v[208:211], v[64:67], v[104:107], v[208:211]
    v_mfma_f32_16x16x32_bf16 v[212:215], v[68:71], v[104:107], v[212:215]
    v_mfma_f32_16x16x32_bf16 v[216:219], v[72:75], v[104:107], v[216:219]
    v_mfma_f32_16x16x32_bf16 v[220:223], v[76:79], v[104:107], v[220:223]
    v_mfma_f32_16x16x32_bf16 v[224:227], v[64:67], v[108:111], v[224:227]
    v_mfma_f32_16x16x32_bf16 v[228:231], v[68:71], v[108:111], v[228:231]
    v_mfma_f32_16x16x32_bf16 v[232:235], v[72:75], v[108:111], v[232:235]
    v_mfma_f32_16x16x32_bf16 v[236:239], v[76:79], v[108:111], v[236:239]
    s_cmp_eq_u32 s37, 1
    s_cbranch_scc1 CS_3
CSR_3:
    s_waitcnt lgkmcnt(0)
    s_barrier
    v_mfma_f32_16x16x32_bf16 v[112:115], v[16:19], v[32:35], v[112:115]
    ds_read_b128 v[80:83], v5 offset:0
    v_mfma_f32_16x16x32_bf16 v[116:119], v[20:23], v[32:35], v[116:119]
    ds_read_b64_tr_b16 v[64:65], v2 offset:0
    v_mfma_f32_16x16x32_bf16 v[120:123], v[24:27], v[32:35], v[120:123]
    ds_read_b64_tr_b16 v[66:67], v2 offset:1024
    v_mfma_f32_16x16x32_bf16 v[124:127], v[28:31], v[32:35], v[124:127]
    ds_read_b64_tr_b16 v[68:69], v3 offset:0
    v_mfma_f32_16x16x32_bf16 v[128:131], v[16:19], v[36:39], v[128:131]
    ds_read_b64_tr_b16 v[70:71], v3 offset:1024
    v_mfma_f32_16x16x32_bf16 v[132:135], v[20:23], v[36:39], v[132:135]
    ds_read_b64_tr_b16 v[72:73], v2 offset:8192
    v_mfma_f32_16x16x32_bf16 v[136:139], v[24:27], v[36:39], v[136:139]
    ds_read_b64_tr_b16 v[74:75], v2 offset:9216
    v_mfma_f32_16x16x32_bf16 v[140:143], v[28:31], v[36:39], v[140:143]
    ds_read_b64_tr_b16 v[76:77], v3 offset:8192
    v_mfma_f32_16x16x32_bf16 v[144:147], v[16:19], v[40:43], v[144:147]
    ds_read_b64_tr_b16 v[78:79], v3 offset:9216
    v_mfma_f32_16x16x32_bf16 v[148:151], v[20:23], v[40:43], v[148:151]
    ds_read_b128 v[84:87], v5 offset:2048
    v_mfma_f32_16x16x32_bf16 v[152:155], v[24:27], v[40:43], v[152:155]
    ds_read_b128 v[88:91], v5 offset:4096
    v_mfma_f32_16x16x32_bf16 v[156:159], v[28:31], v[40:43], v[156:159]
    ds_read_b128 v[92:95], v5 offset:6144
    v_mfma_f32_16x16x32_bf16 v[160:163], v[16:19], v[44:47], v[160:163]
    ds_read_b128 v[96:99], v5 offset:8192
    v_mfma_f32_16x16x32_bf16 v[164:167], v[20:23], v[44:47], v[164:167]
    ds_read_b128 v[100:103], v5 offset:10240
    v_mfma_f32_16x16x32_bf16 v[168:171], v[24:27], v[44:47], v[168:171]
    ds_read_b128 v[104:107], v5 offset:12288
    v_mfma_f32_16x16x32_bf16 v[172:175], v[28:31], v[44:47], v[172:175]
    ds_read_b128 v[108:111], v5 offset:14336
    v_mfma_f32_16x16x32_bf16 v[176:179], v[16:19], v[48:51], v[176:179]
    v_mfma_f32_16x16x32_bf16 v[180:183], v[20:23], v[48:51], v[180:183]
    v_mfma_f32_16x16x32_bf16 v[184:187], v[24:27], v[48:51], v[184:187]
    v_mfma_f32_16x16x32_bf16 v[188:191], v[28:31], v[48:51], v[188:191]
    v_mfma_f32_16x16x32_bf16 v[192:195], v[16:19], v[52:55], v[192:195]
    v_mfma_f32_16x16x32_bf16 v[196:199], v[20:23], v[52:55], v[196:199]
    v_mfma_f32_16x16x32_bf16 v[200:203], v[24:27], v[52:55], v[200:203]
    v_mfma_f32_16x16x32_bf16 v[204:207], v[28:31], v[52:55], v[204:207]
    v_mfma_f32_16x16x32_bf16 v[208:211], v[16:19], v[56:59], v[208:211]
    v_mfma_f32_16x16x32_bf16 v[212:215], v[20:23], v[56:59], v[212:215]
    v_mfma_f32_16x16x32_bf16 v[216:219], v[24:27], v[56:59], v[216:219]
    v_mfma_f32_16x16x32_bf16 v[220:223], v[28:31], v[56:59], v[220:223]
    v_mfma_f32_16x16x32_bf16 v[224:227], v[16:19], v[60:63], v[224:227]
    v_mfma_f32_16x16x32_bf16 v[228:231], v[20:23], v[60:63], v[228:231]
    v_mfma_f32_16x16x32_bf16 v[232:235], v[24:27], v[60:63], v[232:235]
    v_mfma_f32_16x16x32_bf16 v[236:239], v[28:31], v[60:63], v[236:239]
    s_cmp_eq_u32 s37, 2
    s_cbranch_scc1 CS_4
CSR_4:
    s_waitcnt lgkmcnt(0)
    s_barrier
    v_mfma_f32_16x16x32_bf16 v[112:115], v[64:67], v[80:83], v[112:115]
    ds_read_b128 v[32:35], v4 offset:16384
    v_mfma_f32_16x16x32_bf16 v[116:119], v[68:71], v[80:83], v[116:119]
    ds_read_b64_tr_b16 v[16:17], v2 offset:16384
    v_mfma_f32_16x16x32_bf16 v[120:123], v[72:75], v[80:83], v[120:123]
    ds_read_b64_tr_b16 v[18:19], v2 offset:17408
    v_mfma_f32_16x16x32_bf16 v[124:127], v[76:79], v[80:83], v[124:127]
    ds_read_b64_tr_b16 v[20:21], v3 offset:16384
    v_mfma_f32_16x16x32_bf16 v[128:131], v[64:67], v[84:87], v[128:131]
    ds_read_b64_tr_b16 v[22:23], v3 offset:17408
    v_mfma_f32_16x16x32_bf16 v[132:135], v[68:71], v[84:87], v[132:135]
    ds_read_b64_tr_b16 v[24:25], v2 offset:24576
    v_mfma_f32_16x16x32_bf16 v[136:139], v[72:75], v[84:87], v[136:139]
    ds_read_b64_tr_b16 v[26:27], v2 offset:25600
    v_mfma_f32_16x16x32_bf16 v[140:143], v[76:79], v[84:87], v[140:143]
    ds_read_b64_tr_b16 v[28:29], v3 offset:24576
    v_mfma_f32_16x16x32_bf16 v[144:147], v[64:67], v[88:91], v[144:147]
    ds_read_b64_tr_b16 v[30:31], v3 offset:25600
    v_mfma_f32_16x16x32_bf16 v[148:151], v[68:71], v[88:91], v[148:151]
    ds_read_b128 v[36:39], v4 offset:18432
    v_mfma_f32_16x16x32_bf16 v[152:155], v[72:75], v[88:91], v[152:155]
    ds_read_b128 v[40:43], v4 offset:20480
    v_mfma_f32_16x16x32_bf16 v[156:159], v[76:79], v[88:91], v[156:159]
    ds_read_b128 v[44:47], v4 offset:22528
    v_mfma_f32_16x16x32_bf16 v[160:163], v[64:67], v[92:95], v[160:163]
    ds_read_b128 v[48:51], v4 offset:24576
    v_mfma_f32_16x16x32_bf16 v[164:167], v[68:71], v[92:95], v[164:167]
    ds_read_b128 v[52:55], v4 offset:26624
    v_mfma_f32_16x16x32_bf16 v[168:171], v[72:75], v[92:95], v[168:171]
    ds_read_b128 v[56:59], v4 offset:28672
    v_mfma_f32_16x16x32_bf16 v[172:175], v[76:79], v[92:95], v[172:175]
    ds_read_b128 v[60:63], v4 offset:30720
    v_mfma_f32_16x16x32_bf16 v[176:179], v[64:67], v[96:99], v[176:179]
    v_mfma_f32_16x16x32_bf16 v[180:183], v[68:71], v[96:99], v[180:183]
    v_mfma_f32_16x16x32_bf16 v[184:187], v[72:75], v[96:99], v[184:187]
    v_mfma_f32_16x16x32_bf16 v[188:191], v[76:79], v[96:99], v[188:191]
    v_mfma_f32_16x16x32_bf16 v[192:195], v[64:67], v[100:103], v[192:195]
    v_mfma_f32_16x16x32_bf16 v[196:199], v[68:71], v[100:103], v[196:199]
    v_mfma_f32_16x16x32_bf16 v[200:203], v[72:75], v[100:103], v[200:203]
    v_mfma_f32_16x16x32_bf16 v[204:207], v[76:79], v[100:103], v[204:207]
    v_mfma_f32_16x16x32_bf16 v[208:211], v[64:67], v[104:107], v[208:211]
    v_mfma_f32_16x16x32_bf16 v[212:215], v[68:71], v[104:107], v[212:215]
    v_mfma_f32_16x16x32_bf16 v[216:219], v[72:75], v[104:107], v[216:219]
    v_mfma_f32_16x16x32_bf16 v[220:223], v[76:79], v[104:107], v[220:223]
    v_mfma_f32_16x16x32_bf16 v[224:227], v[64:67], v[108:111], v[224:227]
    v_mfma_f32_16x16x32_bf16 v[228:231], v[68:71], v[108:111], v[228:231]
    v_mfma_f32_16x16x32_bf16 v[232:235], v[72:75], v[108:111], v[232:235]
    v_mfma_f32_16x16x32_bf16 v[236:239], v[76:79], v[108:111], v[236:239]
    s_cmp_eq_u32 s37, 2
    s_cbranch_scc1 CS_5
CSR_5:
    s_waitcnt lgkmcnt(0)
    s_barrier
    v_mfma_f32_16x16x32_bf16 v[112:115], v[16:19], v[32:35], v[112:115]
    ds_read_b128 v[80:83], v5 offset:16384
    v_mfma_f32_16x16x32_bf16 v[116:119], v[20:23], v[32:35], v[116:119]
    ds_read_b64_tr_b16 v[64:65], v2 offset:32768
    v_mfma_f32_16x16x32_bf16 v[120:123], v[24:27], v[32:35], v[120:123]
    ds_read_b64_tr_b16 v[66:67], v2 offset:33792
    v_mfma_f32_16x16x32_bf16 v[124:127], v[28:31], v[32:35], v[124:127]
    ds_read_b64_tr_b16 v[68:69], v3 offset:32768
    v_mfma_f32_16x16x32_bf16 v[128:131], v[16:19], v[36:39], v[128:131]
    ds_read_b64_tr_b16 v[70:71], v3 offset:33792
    v_mfma_f32_16x16x32_bf16 v[132:135], v[20:23], v[36:39], v[132:135]
    ds_read_b64_tr_b16 v[72:73], v2 offset:40960
    v_mfma_f32_16x16x32_bf16 v[136:139], v[24:27], v[36:39], v[136:139]
    ds_read_b64_tr_b16 v[74:75], v2 offset:41984
    v_mfma_f32_16x16x32_bf16 v[140:143], v[28:31], v[36:39], v[140:143]
    ds_read_b64_tr_b16 v[76:77], v3 offset:40960
    v_mfma_f32_16x16x32_bf16 v[144:147], v[16:19], v[40:43], v[144:147]
    ds_read_b64_tr_b16 v[78:79], v3 offset:41984
    v_mfma_f32_16x16x32_bf16 v[148:151], v[20:23], v[40:43], v[148:151]
    ds_read_b128 v[84:87], v5 offset:18432
    v_mfma_f32_16x16x32_bf16 v[152:155], v[24:27], v[40:43], v[152:155]
    ds_read_b128 v[88:91], v5 offset:20480
    v_mfma_f32_16x16x32_bf16 v[156:159], v[28:31], v[40:43], v[156:159]
    ds_read_b128 v[92:95], v5 offset:22528
    v_mfma_f32_16x16x32_bf16 v[160:163], v[16:19], v[44:47], v[160:163]
    ds_read_b128 v[96:99], v5 offset:24576
    v_mfma_f32_16x16x32_bf16 v[164:167], v[20:23], v[44:47], v[164:167]
    ds_read_b128 v[100:103], v5 offset:26624
    v_mfma_f32_16x16x32_bf16 v[168:171], v[24:27], v[44:47], v[168:171]
    ds_read_b128 v[104:107], v5 offset:28672
    v_mfma_f32_16x16x32_bf16 v[172:175], v[28:31], v[44:47], v[172:175]
    ds_read_b128 v[108:111], v5 offset:30720
    v_mfma_f32_16x16x32_bf16 v[176:179], v[16:19], v[48:51], v[176:179]
    v_mfma_f32_16x16x32_bf16 v[180:183], v[20:23], v[48:51], v[180:183]
    v_mfma_f32_16x16x32_bf16 v[184:187], v[24:27], v[48:51], v[184:187]
    v_mfma_f32_16x16x32_bf16 v[188:191], v[28:31], v[48:51], v[188:191]
    v_mfma_f32_16x16x32_bf16 v[192:195], v[16:19], v[52:55], v[192:195]
    v_mfma_f32_16x16x32_bf16 v[196:199], v[20:23], v[52:55], v[196:199]
    v_mfma_f32_16x16x32_bf16 v[200:203], v[24:27], v[52:55], v[200:203]
    v_mfma_f32_16x16x32_bf16 v[204:207], v[28:31], v[52:55], v[204:207]
    v_mfma_f32_16x16x32_bf16 v[208:211], v[16:19], v[56:59], v[208:211]
    v_mfma_f32_16x16x32_bf16 v[212:215], v[20:23], v[56:59], v[212:215]
    v_mfma_f32_16x16x32_bf16 v[216:219], v[24:27], v[56:59], v[216:219]
    v_mfma_f32_16x16x32_bf16 v[220:223], v[28:31], v[56:59], v[220:223]
    v_mfma_f32_16x16x32_bf16 v[224:227], v[16:19], v[60:63], v[224:227]
    v_mfma_f32_16x16x32_bf16 v[228:231], v[20:23], v[60:63], v[228:231]
    v_mfma_f32_16x16x32_bf16 v[232:235], v[24:27], v[60:63], v[232:235]
    v_mfma_f32_16x16x32_bf16 v[236:239], v[28:31], v[60:63], v[236:239]
    s_cmp_eq_u32 s37, 3
    s_cbranch_scc1 CS_6
CSR_6:
    s_waitcnt lgkmcnt(0)
    s_barrier
    v_mfma_f32_16x16x32_bf16 v[112:115], v[64:67], v[80:83], v[112:115]
    ds_read_b128 v[32:35], v8 offset:0
    v_mfma_f32_16x16x32_bf16 v[116:119], v[68:71], v[80:83], v[116:119]
    ds_read_b64_tr_b16 v[16:17], v6 offset:0
    v_mfma_f32_16x16x32_bf16 v[120:123], v[72:75], v[80:83], v[120:123]
    ds_read_b64_tr_b16 v[18:19], v6 offset:1024
    v_mfma_f32_16x16x32_bf16 v[124:127], v[76:79], v[80:83], v[124:127]
    ds_read_b64_tr_b16 v[20:21], v7 offset:0
    v_mfma_f32_16x16x32_bf16 v[128:131], v[64:67], v[84:87], v[128:131]
    ds_read_b64_tr_b16 v[22:23], v7 offset:1024
    v_mfma_f32_16x16x32_bf16 v[132:135], v[68:71], v[84:87], v[132:135]
    ds_read_b64_tr_b16 v[24:25], v6 offset:8192
    v_mfma_f32_16x16x32_bf16 v[136:139], v[72:75], v[84:87], v[136:139]
    ds_read_b64_tr_b16 v[26:27], v6 offset:9216
    v_mfma_f32_16x16x32_bf16 v[140:143], v[76:79], v[84:87], v[140:143]
    ds_read_b64_tr_b16 v[28:29], v7 offset:8192
    v_mfma_f32_16x16x32_bf16 v[144:147], v[64:67], v[88:91], v[144:147]
    ds_read_b64_tr_b16 v[30:31], v7 offset:9216
    v_mfma_f32_16x16x32_bf16 v[148:151], v[68:71], v[88:91], v[148:151]
    ds_read_b128 v[36:39], v8 offset:2048
    v_mfma_f32_16x16x32_bf16 v[152:155], v[72:75], v[88:91], v[152:155]
    ds_read_b128 v[40:43], v8 offset:4096
    v_mfma_f32_16x16x32_bf16 v[156:159], v[76:79], v[88:91], v[156:159]
    ds_read_b128 v[44:47], v8 offset:6144
    v_mfma_f32_16x16x32_bf16 v[160:163], v[64:67], v[92:95], v[160:163]
    ds_read_b128 v[48:51], v8 offset:8192
    v_mfma_f32_16x16x32_bf16 v[164:167], v[68:71], v[92:95], v[164:167]
    ds_read_b128 v[52:55], v8 offset:10240
    v_mfma_f32_16x16x32_bf16 v[168:171], v[72:75], v[92:95], v[168:171]
    ds_read_b128 v[56:59], v8 offset:12288
    v_mfma_f32_16x16x32_bf16 v[172:175], v[76:79], v[92:95], v[172:175]
    ds_read_b128 v[60:63], v8 offset:14336
    v_mfma_f32_16x16x32_bf16 v[176:179], v[64:67], v[96:99], v[176:179]
    v_mfma_f32_16x16x32_bf16 v[180:183], v[68:71], v[96:99], v[180:183]
    v_mfma_f32_16x16x32_bf16 v[184:187], v[72:75], v[96:99], v[184:187]
    v_mfma_f32_16x16x32_bf16 v[188:191], v[76:79], v[96:99], v[188:191]
    v_mfma_f32_16x16x32_bf16 v[192:195], v[64:67], v[100:103], v[192:195]
    v_mfma_f32_16x16x32_bf16 v[196:199], v[68:71], v[100:103], v[196:199]
    v_mfma_f32_16x16x32_bf16 v[200:203], v[72:75], v[100:103], v[200:203]
    v_mfma_f32_16x16x32_bf16 v[204:207], v[76:79], v[100:103], v[204:207]
    v_mfma_f32_16x16x32_bf16 v[208:211], v[64:67], v[104:107], v[208:211]
    v_mfma_f32_16x16x32_bf16 v[212:215], v[68:71], v[104:107], v[212:215]
    v_mfma_f32_16x16x32_bf16 v[216:219], v[72:75], v[104:107], v[216:219]
    v_mfma_f32_16x16x32_bf16 v[220:223], v[76:79], v[104:107], v[220:223]
    v_mfma_f32_16x16x32_bf16 v[224:227], v[64:67], v[108:111], v[224:227]
    v_mfma_f32_16x16x32_bf16 v[228:231], v[68:71], v[108:111], v[228:231]
    v_mfma_f32_16x16x32_bf16 v[232:235], v[72:75], v[108:111], v[232:235]
    v_mfma_f32_16x16x32_bf16 v[236:239], v[76:79], v[108:111], v[236:239]
    s_cmp_eq_u32 s37, 3
    s_cbranch_scc1 CS_7
CSR_7:
    s_waitcnt lgkmcnt(0)
    s_barrier
    v_mfma_f32_16x16x32_bf16 v[112:115], v[16:19], v[32:35], v[112:115]
    ds_read_b128 v[80:83], v9 offset:0
    v_mfma_f32_16x16x32_bf16 v[116:119], v[20:23], v[32:35], v[116:119]
    ds_read_b64_tr_b16 v[64:65], v6 offset:16384
    v_mfma_f32_16x16x32_bf16 v[120:123], v[24:27], v[32:35], v[120:123]
    ds_read_b64_tr_b16 v[66:67], v6 offset:17408
    v_mfma_f32_16x16x32_bf16 v[124:127], v[28:31], v[32:35], v[124:127]
    ds_read_b64_tr_b16 v[68:69], v7 offset:16384
    v_mfma_f32_16x16x32_bf16 v[128:131], v[16:19], v[36:39], v[128:131]
    ds_read_b64_tr_b16 v[70:71], v7 offset:17408
    v_mfma_f32_16x16x32_bf16 v[132:135], v[20:23], v[36:39], v[132:135]
    ds_read_b64_tr_b16 v[72:73], v6 offset:24576
    v_mfma_f32_16x16x32_bf16 v[136:139], v[24:27], v[36:39], v[136:139]
    ds_read_b64_tr_b16 v[74:75], v6 offset:25600
    v_mfma_f32_16x16x32_bf16 v[140:143], v[28:31], v[36:39], v[140:143]
    ds_read_b64_tr_b16 v[76:77], v7 offset:24576
    v_mfma_f32_16x16x32_bf16 v[144:147], v[16:19], v[40:43], v[144:147]
    ds_read_b64_tr_b16 v[78:79], v7 offset:25600
    v_mfma_f32_16x16x32_bf16 v[148:151], v[20:23], v[40:43], v[148:151]
    ds_read_b128 v[84:87], v9 offset:2048
    v_mfma_f32_16x16x32_bf16 v[152:155], v[24:27], v[40:43], v[152:155]
    ds_read_b128 v[88:91], v9 offset:4096
    v_mfma_f32_16x16x32_bf16 v[156:159], v[28:31], v[40:43], v[156:159]
    ds_read_b128 v[92:95], v9 offset:6144
    v_mfma_f32_16x16x32_bf16 v[160:163], v[16:19], v[44:47], v[160:163]
    ds_read_b128 v[96:99], v9 offset:8192
    v_mfma_f32_16x16x32_bf16 v[164:167], v[20:23], v[44:47], v[164:167]
    ds_read_b128 v[100:103], v9 offset:10240
    v_mfma_f32_16x16x32_bf16 v[168:171], v[24:27], v[44:47], v[168:171]
    ds_read_b128 v[104:107], v9 offset:12288
    v_mfma_f32_16x16x32_bf16 v[172:175], v[28:31], v[44:47], v[172:175]
    ds_read_b128 v[108:111], v9 offset:14336
    v_mfma_f32_16x16x32_bf16 v[176:179], v[16:19], v[48:51], v[176:179]
    v_mfma_f32_16x16x32_bf16 v[180:183], v[20:23], v[48:51], v[180:183]
    v_mfma_f32_16x16x32_bf16 v[184:187], v[24:27], v[48:51], v[184:187]
    v_mfma_f32_16x16x32_bf16 v[188:191], v[28:31], v[48:51], v[188:191]
    v_mfma_f32_16x16x32_bf16 v[192:195], v[16:19], v[52:55], v[192:195]
    v_mfma_f32_16x16x32_bf16 v[196:199], v[20:23], v[52:55], v[196:199]
    v_mfma_f32_16x16x32_bf16 v[200:203], v[24:27], v[52:55], v[200:203]
    v_mfma_f32_16x16x32_bf16 v[204:207], v[28:31], v[52:55], v[204:207]
    v_mfma_f32_16x16x32_bf16 v[208:211], v[16:19], v[56:59], v[208:211]
    v_mfma_f32_16x16x32_bf16 v[212:215], v[20:23], v[56:59], v[212:215]
    v_mfma_f32_16x16x32_bf16 v[216:219], v[24:27], v[56:59], v[216:219]
    v_mfma_f32_16x16x32_bf16 v[220:223], v[28:31], v[56:59], v[220:223]
    v_mfma_f32_16x16x32_bf16 v[224:227], v[16:19], v[60:63], v[224:227]
    v_mfma_f32_16x16x32_bf16 v[228:231], v[20:23], v[60:63], v[228:231]
    v_mfma_f32_16x16x32_bf16 v[232:235], v[24:27], v[60:63], v[232:235]
    v_mfma_f32_16x16x32_bf16 v[236:239], v[28:31], v[60:63], v[236:239]
    s_cmp_eq_u32 s37, 4
    s_cbranch_scc1 CS_8
CSR_8:
    s_waitcnt lgkmcnt(0)
    s_barrier
    v_mfma_f32_16x16x32_bf16 v[112:115], v[64:67], v[80:83], v[112:115]
    ds_read_b128 v[32:35], v8 offset:16384
    v_mfma_f32_16x16x32_bf16 v[116:119], v[68:71], v[80:83], v[116:119]
    ds_read_b64_tr_b16 v[16:17], v2 offset:0
    v_mfma_f32_16x16x32_bf16 v[120:123], v[72:75], v[80:83], v[120:123]
    ds_read_b64_tr_b16 v[18:19], v2 offset:1024
    v_mfma_f32_16x16x32_bf16 v[124:127], v[76:79], v[80:83], v[124:127]
    ds_read_b64_tr_b16 v[20:21], v3 offset:0
    v_mfma_f32_16x16x32_bf16 v[128:131], v[64:67], v[84:87], v[128:131]
    ds_read_b64_tr_b16 v[22:23], v3 offset:1024
    v_mfma_f32_16x16x32_bf16 v[132:135], v[68:71], v[84:87], v[132:135]
    ds_read_b64_tr_b16 v[24:25], v2 offset:8192
    v_mfma_f32_16x16x32_bf16 v[136:139], v[72:75], v[84:87], v[136:139]
    ds_read_b64_tr_b16 v[26:27], v2 offset:9216
    v_mfma_f32_16x16x32_bf16 v[140:143], v[76:79], v[84:87], v[140:143]
    ds_read_b64_tr_b16 v[28:29], v3 offset:8192
    v_mfma_f32_16x16x32_bf16 v[144:147], v[64:67], v[88:91], v[144:147]
    ds_read_b64_tr_b16 v[30:31], v3 offset:9216
    v_mfma_f32_16x16x32_bf16 v[148:151], v[68:71], v[88:91], v[148:151]
    ds_read_b128 v[36:39], v8 offset:18432
    v_mfma_f32_16x16x32_bf16 v[152:155], v[72:75], v[88:91], v[152:155]
    ds_read_b128 v[40:43], v8 offset:20480
    v_mfma_f32_16x16x32_bf16 v[156:159], v[76:79], v[88:91], v[156:159]
    ds_read_b128 v[44:47], v8 offset:22528
    v_mfma_f32_16x16x32_bf16 v[160:163], v[64:67], v[92:95], v[160:163]
    ds_read_b128 v[48:51], v8 offset:24576
    v_mfma_f32_16x16x32_bf16 v[164:167], v[68:71], v[92:95], v[164:167]
    ds_read_b128 v[52:55], v8 offset:26624
    v_mfma_f32_16x16x32_bf16 v[168:171], v[72:75], v[92:95], v[168:171]
    ds_read_b128 v[56:59], v8 offset:28672
    v_mfma_f32_16x16x32_bf16 v[172:175], v[76:79], v[92:95], v[172:175]
    ds_read_b128 v[60:63], v8 offset:30720
    v_mfma_f32_16x16x32_bf16 v[176:179], v[64:67], v[96:99], v[176:179]
    v_mfma_f32_16x16x32_bf16 v[180:183], v[68:71], v[96:99], v[180:183]
    v_mfma_f32_16x16x32_bf16 v[184:187], v[72:75], v[96:99], v[184:187]
    v_mfma_f32_16x16x32_bf16 v[188:191], v[76:79], v[96:99], v[188:191]
    v_mfma_f32_16x16x32_bf16 v[192:195], v[64:67], v[100:103], v[192:195]
    v_mfma_f32_16x16x32_bf16 v[196:199], v[68:71], v[100:103], v[196:199]
    v_mfma_f32_16x16x32_bf16 v[200:203], v[72:75], v[100:103], v[200:203]
    v_mfma_f32_16x16x32_bf16 v[204:207], v[76:79], v[100:103], v[204:207]
    v_mfma_f32_16x16x32_bf16 v[208:211], v[64:67], v[104:107], v[208:211]
    v_mfma_f32_16x16x32_bf16 v[212:215], v[68:71], v[104:107], v[212:215]
    v_mfma_f32_16x16x32_bf16 v[216:219], v[72:75], v[104:107], v[216:219]
    v_mfma_f32_16x16x32_bf16 v[220:223], v[76:79], v[104:107], v[220:223]
    v_mfma_f32_16x16x32_bf16 v[224:227], v[64:67], v[108:111], v[224:227]
    v_mfma_f32_16x16x32_bf16 v[228:231], v[68:71], v[108:111], v[228:231]
    v_mfma_f32_16x16x32_bf16 v[232:235], v[72:75], v[108:111], v[232:235]
    v_mfma_f32_16x16x32_bf16 v[236:239], v[76:79], v[108:111], v[236:239]
    s_cmp_eq_u32 s37, 4
    s_cbranch_scc1 CS_9
CSR_9:
    s_waitcnt lgkmcnt(0)
    s_barrier
    v_mfma_f32_16x16x32_bf16 v[112:115], v[16:19], v[32:35], v[112:115]
    ds_read_b128 v[80:83], v9 offset:16384
    v_mfma_f32_16x16x32_bf16 v[116:119], v[20:23], v[32:35], v[116:119]
    ds_read_b64_tr_b16 v[64:65], v2 offset:16384
    v_mfma_f32_16x16x32_bf16 v[120:123], v[24:27], v[32:35], v[120:123]
    ds_read_b64_tr_b16 v[66:67], v2 offset:17408
    v_mfma_f32_16x16x32_bf16 v[124:127], v[28:31], v[32:35], v[124:127]
    ds_read_b64_tr_b16 v[68:69], v3 offset:16384
    v_mfma_f32_16x16x32_bf16 v[128:131], v[16:19], v[36:39], v[128:131]
    ds_read_b64_tr_b16 v[70:71], v3 offset:17408
    v_mfma_f32_16x16x32_bf16 v[132:135], v[20:23], v[36:39], v[132:135]
    ds_read_b64_tr_b16 v[72:73], v2 offset:24576
    v_mfma_f32_16x16x32_bf16 v[136:139], v[24:27], v[36:39], v[136:139]
    ds_read_b64_tr_b16 v[74:75], v2 offset:25600
    v_mfma_f32_16x16x32_bf16 v[140:143], v[28:31], v[36:39], v[140:143]
    ds_read_b64_tr_b16 v[76:77], v3 offset:24576
    v_mfma_f32_16x16x32_bf16 v[144:147], v[16:19], v[40:43], v[144:147]
    ds_read_b64_tr_b16 v[78:79], v3 offset:25600
    v_mfma_f32_16x16x32_bf16 v[148:151], v[20:23], v[40:43], v[148:151]
    ds_read_b128 v[84:87], v9 offset:18432
    v_mfma_f32_16x16x32_bf16 v[152:155], v[24:27], v[40:43], v[152:155]
    ds_read_b128 v[88:91], v9 offset:20480
    v_mfma_f32_16x16x32_bf16 v[156:159], v[28:31], v[40:43], v[156:159]
    ds_read_b128 v[92:95], v9 offset:22528
    v_mfma_f32_16x16x32_bf16 v[160:163], v[16:19], v[44:47], v[160:163]
    ds_read_b128 v[96:99], v9 offset:24576
    v_mfma_f32_16x16x32_bf16 v[164:167], v[20:23], v[44:47], v[164:167]
    ds_read_b128 v[100:103], v9 offset:26624
    v_mfma_f32_16x16x32_bf16 v[168:171], v[24:27], v[44:47], v[168:171]
    ds_read_b128 v[104:107], v9 offset:28672
    v_mfma_f32_16x16x32_bf16 v[172:175], v[28:31], v[44:47], v[172:175]
    ds_read_b128 v[108:111], v9 offset:30720
    v_mfma_f32_16x16x32_bf16 v[176:179], v[16:19], v[48:51], v[176:179]
    v_mfma_f32_16x16x32_bf16 v[180:183], v[20:23], v[48:51], v[180:183]
    v_mfma_f32_16x16x32_bf16 v[184:187], v[24:27], v[48:51], v[184:187]
    v_mfma_f32_16x16x32_bf16 v[188:191], v[28:31], v[48:51], v[188:191]
    v_mfma_f32_16x16x32_bf16 v[192:195], v[16:19], v[52:55], v[192:195]
    v_mfma_f32_16x16x32_bf16 v[196:199], v[20:23], v[52:55], v[196:199]
    v_mfma_f32_16x16x32_bf16 v[200:203], v[24:27], v[52:55], v[200:203]
    v_mfma_f32_16x16x32_bf16 v[204:207], v[28:31], v[52:55], v[204:207]
    v_mfma_f32_16x16x32_bf16 v[208:211], v[16:19], v[56:59], v[208:211]
    v_mfma_f32_16x16x32_bf16 v[212:215], v[20:23], v[56:59], v[212:215]
    v_mfma_f32_16x16x32_bf16 v[216:219], v[24:27], v[56:59], v[216:219]
    v_mfma_f32_16x16x32_bf16 v[220:223], v[28:31], v[56:59], v[220:223]
    v_mfma_f32_16x16x32_bf16 v[224:227], v[16:19], v[60:63], v[224:227]
    v_mfma_f32_16x16x32_bf16 v[228:231], v[20:23], v[60:63], v[228:231]
    v_mfma_f32_16x16x32_bf16 v[232:235], v[24:27], v[60:63], v[232:235]
    v_mfma_f32_16x16x32_bf16 v[236:239], v[28:31], v[60:63], v[236:239]
    s_waitcnt lgkmcnt(0)
    s_barrier
    v_mfma_f32_16x16x32_bf16 v[112:115], v[64:67], v[80:83], v[112:115]
    ds_read_b128 v[32:35], v4 offset:0
    v_mfma_f32_16x16x32_bf16 v[116:119], v[68:71], v[80:83], v[116:119]
    ds_read_b64_tr_b16 v[16:17], v2 offset:32768
    v_mfma_f32_16x16x32_bf16 v[120:123], v[72:75], v[80:83], v[120:123]
    ds_read_b64_tr_b16 v[18:19], v2 offset:33792
    v_mfma_f32_16x16x32_bf16 v[124:127], v[76:79], v[80:83], v[124:127]
    ds_read_b64_tr_b16 v[20:21], v3 offset:32768
    v_mfma_f32_16x16x32_bf16 v[128:131], v[64:67], v[84:87], v[128:131]
    ds_read_b64_tr_b16 v[22:23], v3 offset:33792
    v_mfma_f32_16x16x32_bf16 v[132:135], v[68:71], v[84:87], v[132:135]
    ds_read_b64_tr_b16 v[24:25], v2 offset:40960
    v_mfma_f32_16x16x32_bf16 v[136:139], v[72:75], v[84:87], v[136:139]
    ds_read_b64_tr_b16 v[26:27], v2 offset:41984
    v_mfma_f32_16x16x32_bf16 v[140:143], v[76:79], v[84:87], v[140:143]
    ds_read_b64_tr_b16 v[28:29], v3 offset:40960
    v_mfma_f32_16x16x32_bf16 v[144:147], v[64:67], v[88:91], v[144:147]
    ds_read_b64_tr_b16 v[30:31], v3 offset:41984
    v_mfma_f32_16x16x32_bf16 v[148:151], v[68:71], v[88:91], v[148:151]
    ds_read_b128 v[36:39], v4 offset:2048
    v_mfma_f32_16x16x32_bf16 v[152:155], v[72:75], v[88:91], v[152:155]
    ds_read_b128 v[40:43], v4 offset:4096
    v_mfma_f32_16x16x32_bf16 v[156:159], v[76:79], v[88:91], v[156:159]
    ds_read_b128 v[44:47], v4 offset:6144
    v_mfma_f32_16x16x32_bf16 v[160:163], v[64:67], v[92:95], v[160:163]
    ds_read_b128 v[48:51], v4 offset:8192
    v_mfma_f32_16x16x32_bf16 v[164:167], v[68:71], v[92:95], v[164:167]
    ds_read_b128 v[52:55], v4 offset:10240
    v_mfma_f32_16x16x32_bf16 v[168:171], v[72:75], v[92:95], v[168:171]
    ds_read_b128 v[56:59], v4 offset:12288
    v_mfma_f32_16x16x32_bf16 v[172:175], v[76:79], v[92:95], v[172:175]
    ds_read_b128 v[60:63], v4 offset:14336
    v_mfma_f32_16x16x32_bf16 v[176:179], v[64:67], v[96:99], v[176:179]
    v_mfma_f32_16x16x32_bf16 v[180:183], v[68:71], v[96:99], v[180:183]
    v_mfma_f32_16x16x32_bf16 v[184:187], v[72:75], v[96:99], v[184:187]
    v_mfma_f32_16x16x32_bf16 v[188:191], v[76:79], v[96:99], v[188:191]
    v_mfma_f32_16x16x32_bf16 v[192:195], v[64:67], v[100:103], v[192:195]
    v_mfma_f32_16x16x32_bf16 v[196:199], v[68:71], v[100:103], v[196:199]
    v_mfma_f32_16x16x32_bf16 v[200:203], v[72:75], v[100:103], v[200:203]
    v_mfma_f32_16x16x32_bf16 v[204:207], v[76:79], v[100:103], v[204:207]
    v_mfma_f32_16x16x32_bf16 v[208:211], v[64:67], v[104:107], v[208:211]
    v_mfma_f32_16x16x32_bf16 v[212:215], v[68:71], v[104:107], v[212:215]
    v_mfma_f32_16x16x32_bf16 v[216:219], v[72:75], v[104:107], v[216:219]
    v_mfma_f32_16x16x32_bf16 v[220:223], v[76:79], v[104:107], v[220:223]
    v_mfma_f32_16x16x32_bf16 v[224:227], v[64:67], v[108:111], v[224:227]
    v_mfma_f32_16x16x32_bf16 v[228:231], v[68:71], v[108:111], v[228:231]
    v_mfma_f32_16x16x32_bf16 v[232:235], v[72:75], v[108:111], v[232:235]
    v_mfma_f32_16x16x32_bf16 v[236:239], v[76:79], v[108:111], v[236:239]
    s_waitcnt vmcnt(0) lgkmcnt(0)
    s_barrier
    v_mfma_f32_16x16x32_bf16 v[112:115], v[16:19], v[32:35], v[112:115]
    ds_read_b128 v[80:83], v5 offset:0
    v_mfma_f32_16x16x32_bf16 v[116:119], v[20:23], v[32:35], v[116:119]
    ds_read_b64_tr_b16 v[64:65], v6 offset:0
    v_mfma_f32_16x16x32_bf16 v[120:123], v[24:27], v[32:35], v[120:123]
    ds_read_b64_tr_b16 v[66:67], v6 offset:1024
    v_mfma_f32_16x16x32_bf16 v[124:127], v[28:31], v[32:35], v[124:127]
    ds_read_b64_tr_b16 v[68:69], v7 offset:0
    v_mfma_f32_16x16x32_bf16 v[128:131], v[16:19], v[36:39], v[128:131]
    ds_read_b64_tr_b16 v[70:71], v7 offset:1024
    v_mfma_f32_16x16x32_bf16 v[132:135], v[20:23], v[36:39], v[132:135]
    ds_read_b64_tr_b16 v[72:73], v6 offset:8192
    v_mfma_f32_16x16x32_bf16 v[136:139], v[24:27], v[36:39], v[136:139]
    ds_read_b64_tr_b16 v[74:75], v6 offset:9216
    v_mfma_f32_16x16x32_bf16 v[140:143], v[28:31], v[36:39], v[140:143]
    ds_read_b64_tr_b16 v[76:77], v7 offset:8192
    v_mfma_f32_16x16x32_bf16 v[144:147], v[16:19], v[40:43], v[144:147]
    ds_read_b64_tr_b16 v[78:79], v7 offset:9216
    v_mfma_f32_16x16x32_bf16 v[148:151], v[20:23], v[40:43], v[148:151]
    ds_read_b128 v[84:87], v5 offset:2048
    v_mfma_f32_16x16x32_bf16 v[152:155], v[24:27], v[40:43], v[152:155]
    ds_read_b128 v[88:91], v5 offset:4096
    v_mfma_f32_16x16x32_bf16 v[156:159], v[28:31], v[40:43], v[156:159]
    ds_read_b128 v[92:95], v5 offset:6144
    v_mfma_f32_16x16x32_bf16 v[160:163], v[16:19], v[44:47], v[160:163]
    ds_read_b128 v[96:99], v5 offset:8192
    v_mfma_f32_16x16x32_bf16 v[164:167], v[20:23], v[44:47], v[164:167]
    ds_read_b128 v[100:103], v5 offset:10240
    v_mfma_f32_16x16x32_bf16 v[168:171], v[24:27], v[44:47], v[168:171]
    ds_read_b128 v[104:107], v5 offset:12288
    v_mfma_f32_16x16x32_bf16 v[172:175], v[28:31], v[44:47], v[172:175]
    ds_read_b128 v[108:111], v5 offset:14336
    v_mfma_f32_16x16x32_bf16 v[176:179], v[16:19], v[48:51], v[176:179]
    v_mfma_f32_16x16x32_bf16 v[180:183], v[20:23], v[48:51], v[180:183]
    v_mfma_f32_16x16x32_bf16 v[184:187], v[24:27], v[48:51], v[184:187]
    v_mfma_f32_16x16x32_bf16 v[188:191], v[28:31], v[48:51], v[188:191]
    v_mfma_f32_16x16x32_bf16 v[192:195], v[16:19], v[52:55], v[192:195]
    v_mfma_f32_16x16x32_bf16 v[196:199], v[20:23], v[52:55], v[196:199]
    v_mfma_f32_16x16x32_bf16 v[200:203], v[24:27], v[52:55], v[200:203]
    v_mfma_f32_16x16x32_bf16 v[204:207], v[28:31], v[52:55], v[204:207]
    v_mfma_f32_16x16x32_bf16 v[208:211], v[16:19], v[56:59], v[208:211]
    v_mfma_f32_16x16x32_bf16 v[212:215], v[20:23], v[56:59], v[212:215]
    v_mfma_f32_16x16x32_bf16 v[216:219], v[24:27], v[56:59], v[216:219]
    v_mfma_f32_16x16x32_bf16 v[220:223], v[28:31], v[56:59], v[220:223]
    v_mfma_f32_16x16x32_bf16 v[224:227], v[16:19], v[60:63], v[224:227]
    v_mfma_f32_16x16x32_bf16 v[228:231], v[20:23], v[60:63], v[228:231]
    v_mfma_f32_16x16x32_bf16 v[232:235], v[24:27], v[60:63], v[232:235]
    v_mfma_f32_16x16x32_bf16 v[236:239], v[28:31], v[60:63], v[236:239]
    s_waitcnt lgkmcnt(0)
    s_barrier
    v_mfma_f32_16x16x32_bf16 v[112:115], v[64:67], v[80:83], v[112:115]
    ds_read_b128 v[32:35], v4 offset:16384
    v_mfma_f32_16x16x32_bf16 v[116:119], v[68:71], v[80:83], v[116:119]
    ds_read_b64_tr_b16 v[16:17], v6 offset:16384
    v_mfma_f32_16x16x32_bf16 v[120:123], v[72:75], v[80:83], v[120:123]
    ds_read_b64_tr_b16 v[18:19], v6 offset:17408
    v_mfma_f32_16x16x32_bf16 v[124:127], v[76:79], v[80:83], v[124:127]
    ds_read_b64_tr_b16 v[20:21], v7 offset:16384
    v_mfma_f32_16x16x32_bf16 v[128:131], v[64:67], v[84:87], v[128:131]
    ds_read_b64_tr_b16 v[22:23], v7 offset:17408
    v_mfma_f32_16x16x32_bf16 v[132:135], v[68:71], v[84:87], v[132:135]
    ds_read_b64_tr_b16 v[24:25], v6 offset:24576
    v_mfma_f32_16x16x32_bf16 v[136:139], v[72:75], v[84:87], v[136:139]
    ds_read_b64_tr_b16 v[26:27], v6 offset:25600
    v_mfma_f32_16x16x32_bf16 v[140:143], v[76:79], v[84:87], v[140:143]
    ds_read_b64_tr_b16 v[28:29], v7 offset:24576
    v_mfma_f32_16x16x32_bf16 v[144:147], v[64:67], v[88:91], v[144:147]
    ds_read_b64_tr_b16 v[30:31], v7 offset:25600
    v_mfma_f32_16x16x32_bf16 v[148:151], v[68:71], v[88:91], v[148:151]
    ds_read_b128 v[36:39], v4 offset:18432
    v_mfma_f32_16x16x32_bf16 v[152:155], v[72:75], v[88:91], v[152:155]
    ds_read_b128 v[40:43], v4 offset:20480
    v_mfma_f32_16x16x32_bf16 v[156:159], v[76:79], v[88:91], v[156:159]
    ds_read_b128 v[44:47], v4 offset:22528
    v_mfma_f32_16x16x32_bf16 v[160:163], v[64:67], v[92:95], v[160:163]
    ds_read_b128 v[48:51], v4 offset:24576
    v_mfma_f32_16x16x32_bf16 v[164:167], v[68:71], v[92:95], v[164:167]
    ds_read_b128 v[52:55], v4 offset:26624
    v_mfma_f32_16x16x32_bf16 v[168:171], v[72:75], v[92:95], v[168:171]
    ds_read_b128 v[56:59], v4 offset:28672
    v_mfma_f32_16x16x32_bf16 v[172:175], v[76:79], v[92:95], v[172:175]
    ds_read_b128 v[60:63], v4 offset:30720
    v_mfma_f32_16x16x32_bf16 v[176:179], v[64:67], v[96:99], v[176:179]
    v_mfma_f32_16x16x32_bf16 v[180:183], v[68:71], v[96:99], v[180:183]
    v_mfma_f32_16x16x32_bf16 v[184:187], v[72:75], v[96:99], v[184:187]
    v_mfma_f32_16x16x32_bf16 v[188:191], v[76:79], v[96:99], v[188:191]
    v_mfma_f32_16x16x32_bf16 v[192:195], v[64:67], v[100:103], v[192:195]
    v_mfma_f32_16x16x32_bf16 v[196:199], v[68:71], v[100:103], v[196:199]
    v_mfma_f32_16x16x32_bf16 v[200:203], v[72:75], v[100:103], v[200:203]
    v_mfma_f32_16x16x32_bf16 v[204:207], v[76:79], v[100:103], v[204:207]
    v_mfma_f32_16x16x32_bf16 v[208:211], v[64:67], v[104:107], v[208:211]
    v_mfma_f32_16x16x32_bf16 v[212:215], v[68:71], v[104:107], v[212:215]
    v_mfma_f32_16x16x32_bf16 v[216:219], v[72:75], v[104:107], v[216:219]
    v_mfma_f32_16x16x32_bf16 v[220:223], v[76:79], v[104:107], v[220:223]
    v_mfma_f32_16x16x32_bf16 v[224:227], v[64:67], v[108:111], v[224:227]
    v_mfma_f32_16x16x32_bf16 v[228:231], v[68:71], v[108:111], v[228:231]
    v_mfma_f32_16x16x32_bf16 v[232:235], v[72:75], v[108:111], v[232:235]
    v_mfma_f32_16x16x32_bf16 v[236:239], v[76:79], v[108:111], v[236:239]
    s_waitcnt lgkmcnt(0)
    s_barrier
    v_mfma_f32_16x16x32_bf16 v[112:115], v[16:19], v[32:35], v[112:115]
    ds_read_b128 v[80:83], v5 offset:16384
    v_mfma_f32_16x16x32_bf16 v[116:119], v[20:23], v[32:35], v[116:119]
    ds_read_b64_tr_b16 v[64:65], v2 offset:0
    v_mfma_f32_16x16x32_bf16 v[120:123], v[24:27], v[32:35], v[120:123]
    ds_read_b64_tr_b16 v[66:67], v2 offset:1024
    v_mfma_f32_16x16x32_bf16 v[124:127], v[28:31], v[32:35], v[124:127]
    ds_read_b64_tr_b16 v[68:69], v3 offset:0
    v_mfma_f32_16x16x32_bf16 v[128:131], v[16:19], v[36:39], v[128:131]
    ds_read_b64_tr_b16 v[70:71], v3 offset:1024
    v_mfma_f32_16x16x32_bf16 v[132:135], v[20:23], v[36:39], v[132:135]
    ds_read_b64_tr_b16 v[72:73], v2 offset:8192
    v_mfma_f32_16x16x32_bf16 v[136:139], v[24:27], v[36:39], v[136:139]
    ds_read_b64_tr_b16 v[74:75], v2 offset:9216
    v_mfma_f32_16x16x32_bf16 v[140:143], v[28:31], v[36:39], v[140:143]
    ds_read_b64_tr_b16 v[76:77], v3 offset:8192
    v_mfma_f32_16x16x32_bf16 v[144:147], v[16:19], v[40:43], v[144:147]
    ds_read_b64_tr_b16 v[78:79], v3 offset:9216
    v_mfma_f32_16x16x32_bf16 v[148:151], v[20:23], v[40:43], v[148:151]
    ds_read_b128 v[84:87], v5 offset:18432
    v_mfma_f32_16x16x32_bf16 v[152:155], v[24:27], v[40:43], v[152:155]
    ds_read_b128 v[88:91], v5 offset:20480
    v_mfma_f32_16x16x32_bf16 v[156:159], v[28:31], v[40:43], v[156:159]
    ds_read_b128 v[92:95], v5 offset:22528
    v_mfma_f32_16x16x32_bf16 v[160:163], v[16:19], v[44:47], v[160:163]
    ds_read_b128 v[96:99], v5 offset:24576
    v_mfma_f32_16x16x32_bf16 v[164:167], v[20:23], v[44:47], v[164:167]
    ds_read_b128 v[100:103], v5 offset:26624
    v_mfma_f32_16x16x32_bf16 v[168:171], v[24:27], v[44:47], v[168:171]
    ds_read_b128 v[104:107], v5 offset:28672
    v_mfma_f32_16x16x32_bf16 v[172:175], v[28:31], v[44:47], v[172:175]
    ds_read_b128 v[108:111], v5 offset:30720
    v_mfma_f32_16x16x32_bf16 v[176:179], v[16:19], v[48:51], v[176:179]
    v_mfma_f32_16x16x32_bf16 v[180:183], v[20:23], v[48:51], v[180:183]
    v_mfma_f32_16x16x32_bf16 v[184:187], v[24:27], v[48:51], v[184:187]
    v_mfma_f32_16x16x32_bf16 v[188:191], v[28:31], v[48:51], v[188:191]
    v_mfma_f32_16x16x32_bf16 v[192:195], v[16:19], v[52:55], v[192:195]
    v_mfma_f32_16x16x32_bf16 v[196:199], v[20:23], v[52:55], v[196:199]
    v_mfma_f32_16x16x32_bf16 v[200:203], v[24:27], v[52:55], v[200:203]
    v_mfma_f32_16x16x32_bf16 v[204:207], v[28:31], v[52:55], v[204:207]
    v_mfma_f32_16x16x32_bf16 v[208:211], v[16:19], v[56:59], v[208:211]
    v_mfma_f32_16x16x32_bf16 v[212:215], v[20:23], v[56:59], v[212:215]
    v_mfma_f32_16x16x32_bf16 v[216:219], v[24:27], v[56:59], v[216:219]
    v_mfma_f32_16x16x32_bf16 v[220:223], v[28:31], v[56:59], v[220:223]
    v_mfma_f32_16x16x32_bf16 v[224:227], v[16:19], v[60:63], v[224:227]
    v_mfma_f32_16x16x32_bf16 v[228:231], v[20:23], v[60:63], v[228:231]
    v_mfma_f32_16x16x32_bf16 v[232:235], v[24:27], v[60:63], v[232:235]
    v_mfma_f32_16x16x32_bf16 v[236:239], v[28:31], v[60:63], v[236:239]
    s_waitcnt lgkmcnt(0)
    s_barrier
    v_mfma_f32_16x16x32_bf16 v[112:115], v[64:67], v[80:83], v[112:115]
    ds_read_b128 v[32:35], v8 offset:0
    v_mfma_f32_16x16x32_bf16 v[116:119], v[68:71], v[80:83], v[116:119]
    ds_read_b64_tr_b16 v[16:17], v2 offset:16384
    v_mfma_f32_16x16x32_bf16 v[120:123], v[72:75], v[80:83], v[120:123]
    ds_read_b64_tr_b16 v[18:19], v2 offset:17408
    v_mfma_f32_16x16x32_bf16 v[124:127], v[76:79], v[80:83], v[124:127]
    ds_read_b64_tr_b16 v[20:21], v3 offset:16384
    v_mfma_f32_16x16x32_bf16 v[128:131], v[64:67], v[84:87], v[128:131]
    ds_read_b64_tr_b16 v[22:23], v3 offset:17408
    v_mfma_f32_16x16x32_bf16 v[132:135], v[68:71], v[84:87], v[132:135]
    ds_read_b64_tr_b16 v[24:25], v2 offset:24576
    v_mfma_f32_16x16x32_bf16 v[136:139], v[72:75], v[84:87], v[136:139]
    ds_read_b64_tr_b16 v[26:27], v2 offset:25600
    v_mfma_f32_16x16x32_bf16 v[140:143], v[76:79], v[84:87], v[140:143]
    ds_read_b64_tr_b16 v[28:29], v3 offset:24576
    v_mfma_f32_16x16x32_bf16 v[144:147], v[64:67], v[88:91], v[144:147]
    ds_read_b64_tr_b16 v[30:31], v3 offset:25600
    v_mfma_f32_16x16x32_bf16 v[148:151], v[68:71], v[88:91], v[148:151]
    ds_read_b128 v[36:39], v8 offset:2048
    v_mfma_f32_16x16x32_bf16 v[152:155], v[72:75], v[88:91], v[152:155]
    ds_read_b128 v[40:43], v8 offset:4096
    v_mfma_f32_16x16x32_bf16 v[156:159], v[76:79], v[88:91], v[156:159]
    ds_read_b128 v[44:47], v8 offset:6144
    v_mfma_f32_16x16x32_bf16 v[160:163], v[64:67], v[92:95], v[160:163]
    ds_read_b128 v[48:51], v8 offset:8192
    v_mfma_f32_16x16x32_bf16 v[164:167], v[68:71], v[92:95], v[164:167]
    ds_read_b128 v[52:55], v8 offset:10240
    v_mfma_f32_16x16x32_bf16 v[168:171], v[72:75], v[92:95], v[168:171]
    ds_read_b128 v[56:59], v8 offset:12288
    v_mfma_f32_16x16x32_bf16 v[172:175], v[76:79], v[92:95], v[172:175]
    ds_read_b128 v[60:63], v8 offset:14336
    v_mfma_f32_16x16x32_bf16 v[176:179], v[64:67], v[96:99], v[176:179]
    v_mfma_f32_16x16x32_bf16 v[180:183], v[68:71], v[96:99], v[180:183]
    v_mfma_f32_16x16x32_bf16 v[184:187], v[72:75], v[96:99], v[184:187]
    v_mfma_f32_16x16x32_bf16 v[188:191], v[76:79], v[96:99], v[188:191]
    v_mfma_f32_16x16x32_bf16 v[192:195], v[64:67], v[100:103], v[192:195]
    v_mfma_f32_16x16x32_bf16 v[196:199], v[68:71], v[100:103], v[196:199]
    v_mfma_f32_16x16x32_bf16 v[200:203], v[72:75], v[100:103], v[200:203]
    v_mfma_f32_16x16x32_bf16 v[204:207], v[76:79], v[100:103], v[204:207]
    v_mfma_f32_16x16x32_bf16 v[208:211], v[64:67], v[104:107], v[208:211]
    v_mfma_f32_16x16x32_bf16 v[212:215], v[68:71], v[104:107], v[212:215]
    v_mfma_f32_16x16x32_bf16 v[216:219], v[72:75], v[104:107], v[216:219]
    v_mfma_f32_16x16x32_bf16 v[220:223], v[76:79], v[104:107], v[220:223]
    v_mfma_f32_16x16x32_bf16 v[224:227], v[64:67], v[108:111], v[224:227]
    v_mfma_f32_16x16x32_bf16 v[228:231], v[68:71], v[108:111], v[228:231]
    v_mfma_f32_16x16x32_bf16 v[232:235], v[72:75], v[108:111], v[232:235]
    v_mfma_f32_16x16x32_bf16 v[236:239], v[76:79], v[108:111], v[236:239]
    s_waitcnt lgkmcnt(0)
    s_barrier
    v_mfma_f32_16x16x32_bf16 v[112:115], v[16:19], v[32:35], v[112:115]
    ds_read_b128 v[80:83], v9 offset:0
    v_mfma_f32_16x16x32_bf16 v[116:119], v[20:23], v[32:35], v[116:119]
    ds_read_b64_tr_b16 v[64:65], v2 offset:32768
    v_mfma_f32_16x16x32_bf16 v[120:123], v[24:27], v[32:35], v[120:123]
    ds_read_b64_tr_b16 v[66:67], v2 offset:33792
    v_mfma_f32_16x16x32_bf16 v[124:127], v[28:31], v[32:35], v[124:127]
    ds_read_b64_tr_b16 v[68:69], v3 offset:32768
    v_mfma_f32_16x16x32_bf16 v[128:131], v[16:19], v[36:39], v[128:131]
    ds_read_b64_tr_b16 v[70:71], v3 offset:33792
    v_mfma_f32_16x16x32_bf16 v[132:135], v[20:23], v[36:39], v[132:135]
    ds_read_b64_tr_b16 v[72:73], v2 offset:40960
    v_mfma_f32_16x16x32_bf16 v[136:139], v[24:27], v[36:39], v[136:139]
    ds_read_b64_tr_b16 v[74:75], v2 offset:41984
    v_mfma_f32_16x16x32_bf16 v[140:143], v[28:31], v[36:39], v[140:143]
    ds_read_b64_tr_b16 v[76:77], v3 offset:40960
    v_mfma_f32_16x16x32_bf16 v[144:147], v[16:19], v[40:43], v[144:147]
    ds_read_b64_tr_b16 v[78:79], v3 offset:41984
    v_mfma_f32_16x16x32_bf16 v[148:151], v[20:23], v[40:43], v[148:151]
    ds_read_b128 v[84:87], v9 offset:2048
    v_mfma_f32_16x16x32_bf16 v[152:155], v[24:27], v[40:43], v[152:155]
    ds_read_b128 v[88:91], v9 offset:4096
    v_mfma_f32_16x16x32_bf16 v[156:159], v[28:31], v[40:43], v[156:159]
    ds_read_b128 v[92:95], v9 offset:6144
    v_mfma_f32_16x16x32_bf16 v[160:163], v[16:19], v[44:47], v[160:163]
    ds_read_b128 v[96:99], v9 offset:8192
    v_mfma_f32_16x16x32_bf16 v[164:167], v[20:23], v[44:47], v[164:167]
    ds_read_b128 v[100:103], v9 offset:10240
    v_mfma_f32_16x16x32_bf16 v[168:171], v[24:27], v[44:47], v[168:171]
    ds_read_b128 v[104:107], v9 offset:12288
    v_mfma_f32_16x16x32_bf16 v[172:175], v[28:31], v[44:47], v[172:175]
    ds_read_b128 v[108:111], v9 offset:14336
    v_mfma_f32_16x16x32_bf16 v[176:179], v[16:19], v[48:51], v[176:179]
    v_mfma_f32_16x16x32_bf16 v[180:183], v[20:23], v[48:51], v[180:183]
    v_mfma_f32_16x16x32_bf16 v[184:187], v[24:27], v[48:51], v[184:187]
    v_mfma_f32_16x16x32_bf16 v[188:191], v[28:31], v[48:51], v[188:191]
    v_mfma_f32_16x16x32_bf16 v[192:195], v[16:19], v[52:55], v[192:195]
    v_mfma_f32_16x16x32_bf16 v[196:199], v[20:23], v[52:55], v[196:199]
    v_mfma_f32_16x16x32_bf16 v[200:203], v[24:27], v[52:55], v[200:203]
    v_mfma_f32_16x16x32_bf16 v[204:207], v[28:31], v[52:55], v[204:207]
    v_mfma_f32_16x16x32_bf16 v[208:211], v[16:19], v[56:59], v[208:211]
    v_mfma_f32_16x16x32_bf16 v[212:215], v[20:23], v[56:59], v[212:215]
    v_mfma_f32_16x16x32_bf16 v[216:219], v[24:27], v[56:59], v[216:219]
    v_mfma_f32_16x16x32_bf16 v[220:223], v[28:31], v[56:59], v[220:223]
    v_mfma_f32_16x16x32_bf16 v[224:227], v[16:19], v[60:63], v[224:227]
    v_mfma_f32_16x16x32_bf16 v[228:231], v[20:23], v[60:63], v[228:231]
    v_mfma_f32_16x16x32_bf16 v[232:235], v[24:27], v[60:63], v[232:235]
    v_mfma_f32_16x16x32_bf16 v[236:239], v[28:31], v[60:63], v[236:239]
    s_waitcnt lgkmcnt(0)
    s_barrier
    v_mfma_f32_16x16x32_bf16 v[112:115], v[64:67], v[80:83], v[112:115]
    ds_read_b128 v[32:35], v8 offset:16384
    v_mfma_f32_16x16x32_bf16 v[116:119], v[68:71], v[80:83], v[116:119]
    ds_read_b64_tr_b16 v[16:17], v6 offset:0
    v_mfma_f32_16x16x32_bf16 v[120:123], v[72:75], v[80:83], v[120:123]
    ds_read_b64_tr_b16 v[18:19], v6 offset:1024
    v_mfma_f32_16x16x32_bf16 v[124:127], v[76:79], v[80:83], v[124:127]
    ds_read_b64_tr_b16 v[20:21], v7 offset:0
    v_mfma_f32_16x16x32_bf16 v[128:131], v[64:67], v[84:87], v[128:131]
    ds_read_b64_tr_b16 v[22:23], v7 offset:1024
    v_mfma_f32_16x16x32_bf16 v[132:135], v[68:71], v[84:87], v[132:135]
    ds_read_b64_tr_b16 v[24:25], v6 offset:8192
    v_mfma_f32_16x16x32_bf16 v[136:139], v[72:75], v[84:87], v[136:139]
    ds_read_b64_tr_b16 v[26:27], v6 offset:9216
    v_mfma_f32_16x16x32_bf16 v[140:143], v[76:79], v[84:87], v[140:143]
    ds_read_b64_tr_b16 v[28:29], v7 offset:8192
    v_mfma_f32_16x16x32_bf16 v[144:147], v[64:67], v[88:91], v[144:147]
    ds_read_b64_tr_b16 v[30:31], v7 offset:9216
    v_mfma_f32_16x16x32_bf16 v[148:151], v[68:71], v[88:91], v[148:151]
    ds_read_b128 v[36:39], v8 offset:18432
    v_mfma_f32_16x16x32_bf16 v[152:155], v[72:75], v[88:91], v[152:155]
    ds_read_b128 v[40:43], v8 offset:20480
    v_mfma_f32_16x16x32_bf16 v[156:159], v[76:79], v[88:91], v[156:159]
    ds_read_b128 v[44:47], v8 offset:22528
    v_mfma_f32_16x16x32_bf16 v[160:163], v[64:67], v[92:95], v[160:163]
    ds_read_b128 v[48:51], v8 offset:24576
    v_mfma_f32_16x16x32_bf16 v[164:167], v[68:71], v[92:95], v[164:167]
    ds_read_b128 v[52:55], v8 offset:26624
    v_mfma_f32_16x16x32_bf16 v[168:171], v[72:75], v[92:95], v[168:171]
    ds_read_b128 v[56:59], v8 offset:28672
    v_mfma_f32_16x16x32_bf16 v[172:175], v[76:79], v[92:95], v[172:175]
    ds_read_b128 v[60:63], v8 offset:30720
    v_mfma_f32_16x16x32_bf16 v[176:179], v[64:67], v[96:99], v[176:179]
    v_mfma_f32_16x16x32_bf16 v[180:183], v[68:71], v[96:99], v[180:183]
    v_mfma_f32_16x16x32_bf16 v[184:187], v[72:75], v[96:99], v[184:187]
    v_mfma_f32_16x16x32_bf16 v[188:191], v[76:79], v[96:99], v[188:191]
    v_mfma_f32_16x16x32_bf16 v[192:195], v[64:67], v[100:103], v[192:195]
    v_mfma_f32_16x16x32_bf16 v[196:199], v[68:71], v[100:103], v[196:199]
    v_mfma_f32_16x16x32_bf16 v[200:203], v[72:75], v[100:103], v[200:203]
    v_mfma_f32_16x16x32_bf16 v[204:207], v[76:79], v[100:103], v[204:207]
    v_mfma_f32_16x16x32_bf16 v[208:211], v[64:67], v[104:107], v[208:211]
    v_mfma_f32_16x16x32_bf16 v[212:215], v[68:71], v[104:107], v[212:215]
    v_mfma_f32_16x16x32_bf16 v[216:219], v[72:75], v[104:107], v[216:219]
    v_mfma_f32_16x16x32_bf16 v[220:223], v[76:79], v[104:107], v[220:223]
    v_mfma_f32_16x16x32_bf16 v[224:227], v[64:67], v[108:111], v[224:227]
    v_mfma_f32_16x16x32_bf16 v[228:231], v[68:71], v[108:111], v[228:231]
    v_mfma_f32_16x16x32_bf16 v[232:235], v[72:75], v[108:111], v[232:235]
    v_mfma_f32_16x16x32_bf16 v[236:239], v[76:79], v[108:111], v[236:239]
    s_waitcnt lgkmcnt(0)
    s_barrier
    v_mfma_f32_16x16x32_bf16 v[112:115], v[16:19], v[32:35], v[112:115]
    ds_read_b128 v[80:83], v9 offset:16384
    v_mfma_f32_16x16x32_bf16 v[116:119], v[20:23], v[32:35], v[116:119]
    ds_read_b64_tr_b16 v[64:65], v6 offset:16384
    v_mfma_f32_16x16x32_bf16 v[120:123], v[24:27], v[32:35], v[120:123]
    ds_read_b64_tr_b16 v[66:67], v6 offset:17408
    v_mfma_f32_16x16x32_bf16 v[124:127], v[28:31], v[32:35], v[124:127]
    ds_read_b64_tr_b16 v[68:69], v7 offset:16384
    v_mfma_f32_16x16x32_bf16 v[128:131], v[16:19], v[36:39], v[128:131]
    ds_read_b64_tr_b16 v[70:71], v7 offset:17408
    v_mfma_f32_16x16x32_bf16 v[132:135], v[20:23], v[36:39], v[132:135]
    ds_read_b64_tr_b16 v[72:73], v6 offset:24576
    v_mfma_f32_16x16x32_bf16 v[136:139], v[24:27], v[36:39], v[136:139]
    ds_read_b64_tr_b16 v[74:75], v6 offset:25600
    v_mfma_f32_16x16x32_bf16 v[140:143], v[28:31], v[36:39], v[140:143]
    ds_read_b64_tr_b16 v[76:77], v7 offset:24576
    v_mfma_f32_16x16x32_bf16 v[144:147], v[16:19], v[40:43], v[144:147]
    ds_read_b64_tr_b16 v[78:79], v7 offset:25600
    v_mfma_f32_16x16x32_bf16 v[148:151], v[20:23], v[40:43], v[148:151]
    ds_read_b128 v[84:87], v9 offset:18432
    v_mfma_f32_16x16x32_bf16 v[152:155], v[24:27], v[40:43], v[152:155]
    ds_read_b128 v[88:91], v9 offset:20480
    v_mfma_f32_16x16x32_bf16 v[156:159], v[28:31], v[40:43], v[156:159]
    ds_read_b128 v[92:95], v9 offset:22528
    v_mfma_f32_16x16x32_bf16 v[160:163], v[16:19], v[44:47], v[160:163]
    ds_read_b128 v[96:99], v9 offset:24576
    v_mfma_f32_16x16x32_bf16 v[164:167], v[20:23], v[44:47], v[164:167]
    ds_read_b128 v[100:103], v9 offset:26624
    v_mfma_f32_16x16x32_bf16 v[168:171], v[24:27], v[44:47], v[168:171]
    ds_read_b128 v[104:107], v9 offset:28672
    v_mfma_f32_16x16x32_bf16 v[172:175], v[28:31], v[44:47], v[172:175]
    ds_read_b128 v[108:111], v9 offset:30720
    v_mfma_f32_16x16x32_bf16 v[176:179], v[16:19], v[48:51], v[176:179]
    v_mfma_f32_16x16x32_bf16 v[180:183], v[20:23], v[48:51], v[180:183]
    v_mfma_f32_16x16x32_bf16 v[184:187], v[24:27], v[48:51], v[184:187]
    v_mfma_f32_16x16x32_bf16 v[188:191], v[28:31], v[48:51], v[188:191]
    v_mfma_f32_16x16x32_bf16 v[192:195], v[16:19], v[52:55], v[192:195]
    v_mfma_f32_16x16x32_bf16 v[196:199], v[20:23], v[52:55], v[196:199]
    v_mfma_f32_16x16x32_bf16 v[200:203], v[24:27], v[52:55], v[200:203]
    v_mfma_f32_16x16x32_bf16 v[204:207], v[28:31], v[52:55], v[204:207]
    v_mfma_f32_16x16x32_bf16 v[208:211], v[16:19], v[56:59], v[208:211]
    v_mfma_f32_16x16x32_bf16 v[212:215], v[20:23], v[56:59], v[212:215]
    v_mfma_f32_16x16x32_bf16 v[216:219], v[24:27], v[56:59], v[216:219]
    v_mfma_f32_16x16x32_bf16 v[220:223], v[28:31], v[56:59], v[220:223]
    v_mfma_f32_16x16x32_bf16 v[224:227], v[16:19], v[60:63], v[224:227]
    v_mfma_f32_16x16x32_bf16 v[228:231], v[20:23], v[60:63], v[228:231]
    v_mfma_f32_16x16x32_bf16 v[232:235], v[24:27], v[60:63], v[232:235]
    v_mfma_f32_16x16x32_bf16 v[236:239], v[28:31], v[60:63], v[236:239]
    s_waitcnt lgkmcnt(0)
C_last:
    v_and_b32 v14, 15, v1
    v_lshlrev_b32 v2, 3, v14
    v_add_u32 v2, 45056, v2
    s_lshl_b32 s34, s3, 7
    s_add_u32 s34, s34, 46080
    v_lshl_add_u32 v3, v11, 4, s34
    v_mov_b32 v4, 48128
    s_barrier
    v_mfma_f32_16x16x32_bf16 v[112:115], v[64:67], v[80:83], v[112:115]
    ds_read_b128 v[32:35], v3 offset:0
    s_add_u32 s4, s86, 0xc00000
    s_addc_u32 s5, s87, 0
    v_mfma_f32_16x16x32_bf16 v[116:119], v[68:71], v[80:83], v[116:119]
    ds_read_b128 v[36:39], v3 offset:64
    s_mov_b32 s6, 0x6c0000
    s_mov_b32 s7, 0x20000
    v_mfma_f32_16x16x32_bf16 v[120:123], v[72:75], v[80:83], v[120:123]
    ds_read_b128 v[40:43], v3 offset:512
    s_add_u32 s12, s86, 0x1800000
    s_addc_u32 s13, s87, 0
    v_mfma_f32_16x16x32_bf16 v[124:127], v[76:79], v[80:83], v[124:127]
    ds_read_b128 v[44:47], v3 offset:576
    s_mov_b32 s14, 0x4b000
    s_mov_b32 s15, 0x20000
    v_mfma_f32_16x16x32_bf16 v[128:131], v[64:67], v[84:87], v[128:131]
    ds_read2_b32 v[16:17], v2 offset0:0 offset1:32
    s_lshl_b32 s34, s45, 2
    s_add_u32 s34, s34, s3
    v_mfma_f32_16x16x32_bf16 v[132:135], v[68:71], v[84:87], v[132:135]
    ds_read2_b32 v[18:19], v2 offset0:64 offset1:96
    s_mul_i32 s35, s44, 108
    s_add_u32 s35, s35, s34
    v_mfma_f32_16x16x32_bf16 v[136:139], v[72:75], v[84:87], v[136:139]
    ds_read2_b32 v[20:21], v2 offset0:128 offset1:160
    s_lshl_b32 s35, s35, 12
    s_cmp_ge_u32 s34, 54
    v_mfma_f32_16x16x32_bf16 v[140:143], v[76:79], v[84:87], v[140:143]
    ds_read2_b32 v[22:23], v2 offset0:192 offset1:224
    s_cselect_b32 s35, 0x7ff00000, s35
    s_add_u32 s36, s35, 221184
    v_mfma_f32_16x16x32_bf16 v[144:147], v[64:67], v[88:91], v[144:147]
    ds_read_b64 v[48:49], v4
    v_lshlrev_b32 v5, 4, v1
    v_mfma_f32_16x16x32_bf16 v[148:151], v[68:71], v[88:91], v[148:151]
    s_waitcnt lgkmcnt(4)
    v_fma_f32 v112, -v32, v16, v112
    v_fma_f32 v113, -v33, v16, v113
    v_mfma_f32_16x16x32_bf16 v[152:155], v[72:75], v[88:91], v[152:155]
    v_fma_f32 v114, -v34, v16, v114
    v_fma_f32 v115, -v35, v16, v115
    v_mfma_f32_16x16x32_bf16 v[156:159], v[76:79], v[88:91], v[156:159]
    v_fma_f32 v120, -v40, v16, v120
    v_fma_f32 v121, -v41, v16, v121
    v_mfma_f32_16x16x32_bf16 v[160:163], v[64:67], v[92:95], v[160:163]
    v_fma_f32 v122, -v42, v16, v122
    v_fma_f32 v123, -v43, v16, v123
    v_mfma_f32_16x16x32_bf16 v[164:167], v[68:71], v[92:95], v[164:167]
    v_fma_f32 v116, -v36, v16, v116
    v_fma_f32 v117, -v37, v16, v117
    v_mfma_f32_16x16x32_bf16 v[168:171], v[72:75], v[92:95], v[168:171]
    v_fma_f32 v118, -v38, v16, v118
    v_fma_f32 v119, -v39, v16, v119
    v_mfma_f32_16x16x32_bf16 v[172:175], v[76:79], v[92:95], v[172:175]
    v_fma_f32 v124, -v44, v16, v124
    v_fma_f32 v125, -v45, v16, v125
    v_mfma_f32_16x16x32_bf16 v[176:179], v[64:67], v[96:99], v[176:179]
    v_fma_f32 v126, -v46, v16, v126
    v_fma_f32 v127, -v47, v16, v127
    v_mfma_f32_16x16x32_bf16 v[180:183], v[68:71], v[96:99], v[180:183]
    v_max_f32 v112, 0, v112
    v_max_f32 v113, 0, v113
    v_mfma_f32_16x16x32_bf16 v[184:187], v[72:75], v[96:99], v[184:187]
    v_max_f32 v114, 0, v114
    v_max_f32 v115, 0, v115
    v_mfma_f32_16x16x32_bf16 v[188:191], v[76:79], v[96:99], v[188:191]
    v_max_f32 v116, 0, v116
    v_max_f32 v117, 0, v117
    v_mfma_f32_16x16x32_bf16 v[192:195], v[64:67], v[100:103], v[192:195]
    v_max_f32 v118, 0, v118
    v_max_f32 v119, 0, v119
    v_mfma_f32_16x16x32_bf16 v[196:199], v[68:71], v[100:103], v[196:199]
    v_mul_f32 v112, v112, v120
    v_mul_f32 v113, v113, v121
    v_mfma_f32_16x16x32_bf16 v[200:203], v[72:75], v[100:103], v[200:203]
    v_mul_f32 v114, v114, v122
    v_mul_f32 v115, v115, v123
    v_mfma_f32_16x16x32_bf16 v[204:207], v[76:79], v[100:103], v[204:207]
    v_mul_f32 v116, v116, v124
    v_mul_f32 v117, v117, v125
    v_mfma_f32_16x16x32_bf16 v[208:211], v[64:67], v[104:107], v[208:211]
    v_mul_f32 v118, v118, v126
    v_mul_f32 v119, v119, v127
    v_mfma_f32_16x16x32_bf16 v[212:215], v[68:71], v[104:107], v[212:215]
    v_cvt_pk_bf16_f32 v24, v112, v113
    v_cvt_pk_bf16_f32 v25, v114, v115
    v_mfma_f32_16x16x32_bf16 v[216:219], v[72:75], v[104:107], v[216:219]
    v_cvt_pk_bf16_f32 v26, v116, v117
    v_cvt_pk_bf16_f32 v27, v118, v119
    v_mfma_f32_16x16x32_bf16 v[220:223], v[76:79], v[104:107], v[220:223]
    buffer_store_dwordx4 v[24:27], v5, s[4:7], s35 offen offset:0 sc1
    v_fma_f32 v128, -v32, v17, v128
    v_mfma_f32_16x16x32_bf16 v[224:227], v[64:67], v[108:111], v[224:227]
    v_fma_f32 v129, -v33, v17, v129
    v_fma_f32 v130, -v34, v17, v130
    v_mfma_f32_16x16x32_bf16 v[228:231], v[68:71], v[108:111], v[228:231]
    v_fma_f32 v131, -v35, v17, v131
    v_fma_f32 v136, -v40, v17, v136
    v_mfma_f32_16x16x32_bf16 v[232:235], v[72:75], v[108:111], v[232:235]
    v_fma_f32 v137, -v41, v17, v137
    v_fma_f32 v138, -v42, v17, v138
    v_mfma_f32_16x16x32_bf16 v[236:239], v[76:79], v[108:111], v[236:239]
    v_fma_f32 v139, -v43, v17, v139
    v_fma_f32 v132, -v36, v17, v132
    v_fma_f32 v133, -v37, v17, v133
    v_fma_f32 v134, -v38, v17, v134
    v_fma_f32 v135, -v39, v17, v135
    v_fma_f32 v140, -v44, v17, v140
    v_fma_f32 v141, -v45, v17, v141
    v_fma_f32 v142, -v46, v17, v142
    v_fma_f32 v143, -v47, v17, v143
    s_waitcnt lgkmcnt(0)
C_post:
    v_readfirstlane_b32 s50, v48
    v_readfirstlane_b32 s51, v49
    v_max_f32 v128, 0, v128
    v_max_f32 v129, 0, v129
    v_max_f32 v130, 0, v130
    v_max_f32 v131, 0, v131
    v_max_f32 v132, 0, v132
    v_max_f32 v133, 0, v133
    v_max_f32 v134, 0, v134
    v_max_f32 v135, 0, v135
    v_pk_mul_f32 v[128:129], v[128:129], v[136:137]
    v_pk_mul_f32 v[130:131], v[130:131], v[138:139]
    v_pk_mul_f32 v[132:133], v[132:133], v[140:141]
    v_pk_mul_f32 v[134:135], v[134:135], v[142:143]
    v_cvt_pk_bf16_f32 v28, v128, v129
    v_cvt_pk_bf16_f32 v29, v130, v131
    v_cvt_pk_bf16_f32 v30, v132, v133
    v_cvt_pk_bf16_f32 v31, v134, v135
    buffer_store_dwordx4 v[28:31], v5, s[4:7], s35 offen offset:1024 sc1
    v_pk_fma_f32 v[144:145], v[32:33], v[18:19], v[144:145] op_sel_hi:[1,0,1] neg_lo:[0,1,0] neg_hi:[0,1,0]
    v_pk_fma_f32 v[146:147], v[34:35], v[18:19], v[146:147] op_sel_hi:[1,0,1] neg_lo:[0,1,0] neg_hi:[0,1,0]
    v_pk_fma_f32 v[152:153], v[40:41], v[18:19], v[152:153] op_sel_hi:[1,0,1] neg_lo:[0,1,0] neg_hi:[0,1,0]
    v_pk_fma_f32 v[154:155], v[42:43], v[18:19], v[154:155] op_sel_hi:[1,0,1] neg_lo:[0,1,0] neg_hi:[0,1,0]
    v_pk_fma_f32 v[148:149], v[36:37], v[18:19], v[148:149] op_sel_hi:[1,0,1] neg_lo:[0,1,0] neg_hi:[0,1,0]
    v_pk_fma_f32 v[150:151], v[38:39], v[18:19], v[150:151] op_sel_hi:[1,0,1] neg_lo:[0,1,0] neg_hi:[0,1,0]
    v_pk_fma_f32 v[156:157], v[44:45], v[18:19], v[156:157] op_sel_hi:[1,0,1] neg_lo:[0,1,0] neg_hi:[0,1,0]
    v_pk_fma_f32 v[158:159], v[46:47], v[18:19], v[158:159] op_sel_hi:[1,0,1] neg_lo:[0,1,0] neg_hi:[0,1,0]
    v_max_f32 v144, 0, v144
    v_max_f32 v145, 0, v145
    v_max_f32 v146, 0, v146
    v_max_f32 v147, 0, v147
    v_max_f32 v148, 0, v148
    v_max_f32 v149, 0, v149
    v_max_f32 v150, 0, v150
    v_max_f32 v151, 0, v151
    v_pk_mul_f32 v[144:145], v[144:145], v[152:153]
    v_pk_mul_f32 v[146:147], v[146:147], v[154:155]
    v_pk_mul_f32 v[148:149], v[148:149], v[156:157]
    v_pk_mul_f32 v[150:151], v[150:151], v[158:159]
    v_cvt_pk_bf16_f32 v52, v144, v145
    v_cvt_pk_bf16_f32 v53, v146, v147
    v_cvt_pk_bf16_f32 v54, v148, v149
    v_cvt_pk_bf16_f32 v55, v150, v151
    buffer_store_dwordx4 v[52:55], v5, s[4:7], s35 offen offset:2048 sc1
    v_pk_fma_f32 v[160:161], v[32:33], v[18:19], v[160:161] op_sel:[0,1,0] op_sel_hi:[1,1,1] neg_lo:[0,1,0] neg_hi:[0,1,0]
    v_pk_fma_f32 v[162:163], v[34:35], v[18:19], v[162:163] op_sel:[0,1,0] op_sel_hi:[1,1,1] neg_lo:[0,1,0] neg_hi:[0,1,0]
    v_pk_fma_f32 v[168:169], v[40:41], v[18:19], v[168:169] op_sel:[0,1,0] op_sel_hi:[1,1,1] neg_lo:[0,1,0] neg_hi:[0,1,0]
    v_pk_fma_f32 v[170:171], v[42:43], v[18:19], v[170:171] op_sel:[0,1,0] op_sel_hi:[1,1,1] neg_lo:[0,1,0] neg_hi:[0,1,0]
    v_pk_fma_f32 v[164:165], v[36:37], v[18:19], v[164:165] op_sel:[0,1,0] op_sel_hi:[1,1,1] neg_lo:[0,1,0] neg_hi:[0,1,0]
    v_pk_fma_f32 v[166:167], v[38:39], v[18:19], v[166:167] op_sel:[0,1,0] op_sel_hi:[1,1,1] neg_lo:[0,1,0] neg_hi:[0,1,0]
    v_pk_fma_f32 v[172:173], v[44:45], v[18:19], v[172:173] op_sel:[0,1,0] op_sel_hi:[1,1,1] neg_lo:[0,1,0] neg_hi:[0,1,0]
    v_pk_fma_f32 v[174:175], v[46:47], v[18:19], v[174:175] op_sel:[0,1,0] op_sel_hi:[1,1,1] neg_lo:[0,1,0] neg_hi:[0,1,0]
    v_max_f32 v160, 0, v160
    v_max_f32 v161, 0, v161
    v_max_f32 v162, 0, v162
    v_max_f32 v163, 0, v163
    v_max_f32 v164, 0, v164
    v_max_f32 v165, 0, v165
    v_max_f32 v166, 0, v166
    v_max_f32 v167, 0, v167
    v_pk_mul_f32 v[160:161], v[160:161], v[168:169]
    v_pk_mul_f32 v[162:163], v[162:163], v[170:171]
    v_pk_mul_f32 v[164:165], v[164:165], v[172:173]
    v_pk_mul_f32 v[166:167], v[166:167], v[174:175]
    v_cvt_pk_bf16_f32 v56, v160, v161
    v_cvt_pk_bf16_f32 v57, v162, v163
    v_cvt_pk_bf16_f32 v58, v164, v165
    v_cvt_pk_bf16_f32 v59, v166, v167
    buffer_store_dwordx4 v[56:59], v5, s[4:7], s35 offen offset:3072 sc1
    v_pk_fma_f32 v[176:177], v[32:33], v[20:21], v[176:177] op_sel_hi:[1,0,1] neg_lo:[0,1,0] neg_hi:[0,1,0]
    v_pk_fma_f32 v[178:179], v[34:35], v[20:21], v[178:179] op_sel_hi:[1,0,1] neg_lo:[0,1,0] neg_hi:[0,1,0]
    v_pk_fma_f32 v[184:185], v[40:41], v[20:21], v[184:185] op_sel_hi:[1,0,1] neg_lo:[0,1,0] neg_hi:[0,1,0]
    v_pk_fma_f32 v[186:187], v[42:43], v[20:21], v[186:187] op_sel_hi:[1,0,1] neg_lo:[0,1,0] neg_hi:[0,1,0]
    v_pk_fma_f32 v[180:181], v[36:37], v[20:21], v[180:181] op_sel_hi:[1,0,1] neg_lo:[0,1,0] neg_hi:[0,1,0]
    v_pk_fma_f32 v[182:183], v[38:39], v[20:21], v[182:183] op_sel_hi:[1,0,1] neg_lo:[0,1,0] neg_hi:[0,1,0]
    v_pk_fma_f32 v[188:189], v[44:45], v[20:21], v[188:189] op_sel_hi:[1,0,1] neg_lo:[0,1,0] neg_hi:[0,1,0]
    v_pk_fma_f32 v[190:191], v[46:47], v[20:21], v[190:191] op_sel_hi:[1,0,1] neg_lo:[0,1,0] neg_hi:[0,1,0]
    v_max_f32 v176, 0, v176
    v_max_f32 v177, 0, v177
    v_max_f32 v178, 0, v178
    v_max_f32 v179, 0, v179
    v_max_f32 v180, 0, v180
    v_max_f32 v181, 0, v181
    v_max_f32 v182, 0, v182
    v_max_f32 v183, 0, v183
    v_pk_mul_f32 v[176:177], v[176:177], v[184:185]
    v_pk_mul_f32 v[178:179], v[178:179], v[186:187]
    v_pk_mul_f32 v[180:181], v[180:181], v[188:189]
    v_pk_mul_f32 v[182:183], v[182:183], v[190:191]
    v_cvt_pk_bf16_f32 v24, v176, v177
    v_cvt_pk_bf16_f32 v25, v178, v179
    v_cvt_pk_bf16_f32 v26, v180, v181
    v_cvt_pk_bf16_f32 v27, v182, v183
    buffer_store_dwordx4 v[24:27], v5, s[4:7], s36 offen offset:0 sc1
    v_pk_fma_f32 v[192:193], v[32:33], v[20:21], v[192:193] op_sel:[0,1,0] op_sel_hi:[1,1,1] neg_lo:[0,1,0] neg_hi:[0,1,0]
    v_pk_fma_f32 v[194:195], v[34:35], v[20:21], v[194:195] op_sel:[0,1,0] op_sel_hi:[1,1,1] neg_lo:[0,1,0] neg_hi:[0,1,0]
    v_pk_fma_f32 v[200:201], v[40:41], v[20:21], v[200:201] op_sel:[0,1,0] op_sel_hi:[1,1,1] neg_lo:[0,1,0] neg_hi:[0,1,0]
    v_pk_fma_f32 v[202:203], v[42:43], v[20:21], v[202:203] op_sel:[0,1,0] op_sel_hi:[1,1,1] neg_lo:[0,1,0] neg_hi:[0,1,0]
    v_pk_fma_f32 v[196:197], v[36:37], v[20:21], v[196:197] op_sel:[0,1,0] op_sel_hi:[1,1,1] neg_lo:[0,1,0] neg_hi:[0,1,0]
    v_pk_fma_f32 v[198:199], v[38:39], v[20:21], v[198:199] op_sel:[0,1,0] op_sel_hi:[1,1,1] neg_lo:[0,1,0] neg_hi:[0,1,0]
    v_pk_fma_f32 v[204:205], v[44:45], v[20:21], v[204:205] op_sel:[0,1,0] op_sel_hi:[1,1,1] neg_lo:[0,1,0] neg_hi:[0,1,0]
    v_pk_fma_f32 v[206:207], v[46:47], v[20:21], v[206:207] op_sel:[0,1,0] op_sel_hi:[1,1,1] neg_lo:[0,1,0] neg_hi:[0,1,0]
    v_max_f32 v192, 0, v192
    v_max_f32 v193, 0, v193
    v_max_f32 v194, 0, v194
    v_max_f32 v195, 0, v195
    v_max_f32 v196, 0, v196
    v_max_f32 v197, 0, v197
    v_max_f32 v198, 0, v198
    v_max_f32 v199, 0, v199
    v_pk_mul_f32 v[192:193], v[192:193], v[200:201]
    v_pk_mul_f32 v[194:195], v[194:195], v[202:203]
    v_pk_mul_f32 v[196:197], v[196:197], v[204:205]
    v_pk_mul_f32 v[198:199], v[198:199], v[206:207]
    v_cvt_pk_bf16_f32 v28, v192, v193
    v_cvt_pk_bf16_f32 v29, v194, v195
    v_cvt_pk_bf16_f32 v30, v196, v197
    v_cvt_pk_bf16_f32 v31, v198, v199
    buffer_store_dwordx4 v[28:31], v5, s[4:7], s36 offen offset:1024 sc1
    v_pk_fma_f32 v[208:209], v[32:33], v[22:23], v[208:209] op_sel_hi:[1,0,1] neg_lo:[0,1,0] neg_hi:[0,1,0]
    v_pk_fma_f32 v[210:211], v[34:35], v[22:23], v[210:211] op_sel_hi:[1,0,1] neg_lo:[0,1,0] neg_hi:[0,1,0]
    v_pk_fma_f32 v[216:217], v[40:41], v[22:23], v[216:217] op_sel_hi:[1,0,1] neg_lo:[0,1,0] neg_hi:[0,1,0]
    v_pk_fma_f32 v[218:219], v[42:43], v[22:23], v[218:219] op_sel_hi:[1,0,1] neg_lo:[0,1,0] neg_hi:[0,1,0]
    v_pk_fma_f32 v[212:213], v[36:37], v[22:23], v[212:213] op_sel_hi:[1,0,1] neg_lo:[0,1,0] neg_hi:[0,1,0]
    v_pk_fma_f32 v[214:215], v[38:39], v[22:23], v[214:215] op_sel_hi:[1,0,1] neg_lo:[0,1,0] neg_hi:[0,1,0]
    v_pk_fma_f32 v[220:221], v[44:45], v[22:23], v[220:221] op_sel_hi:[1,0,1] neg_lo:[0,1,0] neg_hi:[0,1,0]
    v_pk_fma_f32 v[222:223], v[46:47], v[22:23], v[222:223] op_sel_hi:[1,0,1] neg_lo:[0,1,0] neg_hi:[0,1,0]
    v_max_f32 v208, 0, v208
    v_max_f32 v209, 0, v209
    v_max_f32 v210, 0, v210
    v_max_f32 v211, 0, v211
    v_max_f32 v212, 0, v212
    v_max_f32 v213, 0, v213
    v_max_f32 v214, 0, v214
    v_max_f32 v215, 0, v215
    v_pk_mul_f32 v[208:209], v[208:209], v[216:217]
    v_pk_mul_f32 v[210:211], v[210:211], v[218:219]
    v_pk_mul_f32 v[212:213], v[212:213], v[220:221]
    v_pk_mul_f32 v[214:215], v[214:215], v[222:223]
    v_cvt_pk_bf16_f32 v52, v208, v209
    v_cvt_pk_bf16_f32 v53, v210, v211
    v_cvt_pk_bf16_f32 v54, v212, v213
    v_cvt_pk_bf16_f32 v55, v214, v215
    buffer_store_dwordx4 v[52:55], v5, s[4:7], s36 offen offset:2048 sc1
    v_pk_fma_f32 v[224:225], v[32:33], v[22:23], v[224:225] op_sel:[0,1,0] op_sel_hi:[1,1,1] neg_lo:[0,1,0] neg_hi:[0,1,0]
    v_pk_fma_f32 v[226:227], v[34:35], v[22:23], v[226:227] op_sel:[0,1,0] op_sel_hi:[1,1,1] neg_lo:[0,1,0] neg_hi:[0,1,0]
    v_pk_fma_f32 v[232:233], v[40:41], v[22:23], v[232:233] op_sel:[0,1,0] op_sel_hi:[1,1,1] neg_lo:[0,1,0] neg_hi:[0,1,0]
    v_pk_fma_f32 v[234:235], v[42:43], v[22:23], v[234:235] op_sel:[0,1,0] op_sel_hi:[1,1,1] neg_lo:[0,1,0] neg_hi:[0,1,0]
    v_pk_fma_f32 v[228:229], v[36:37], v[22:23], v[228:229] op_sel:[0,1,0] op_sel_hi:[1,1,1] neg_lo:[0,1,0] neg_hi:[0,1,0]
    v_pk_fma_f32 v[230:231], v[38:39], v[22:23], v[230:231] op_sel:[0,1,0] op_sel_hi:[1,1,1] neg_lo:[0,1,0] neg_hi:[0,1,0]
    v_pk_fma_f32 v[236:237], v[44:45], v[22:23], v[236:237] op_sel:[0,1,0] op_sel_hi:[1,1,1] neg_lo:[0,1,0] neg_hi:[0,1,0]
    v_pk_fma_f32 v[238:239], v[46:47], v[22:23], v[238:239] op_sel:[0,1,0] op_sel_hi:[1,1,1] neg_lo:[0,1,0] neg_hi:[0,1,0]
    v_max_f32 v224, 0, v224
    v_max_f32 v225, 0, v225
    v_max_f32 v226, 0, v226
    v_max_f32 v227, 0, v227
    v_max_f32 v228, 0, v228
    v_max_f32 v229, 0, v229
    v_max_f32 v230, 0, v230
    v_max_f32 v231, 0, v231
    v_pk_mul_f32 v[224:225], v[224:225], v[232:233]
    v_pk_mul_f32 v[226:227], v[226:227], v[234:235]
    v_pk_mul_f32 v[228:229], v[228:229], v[236:237]
    v_pk_mul_f32 v[230:231], v[230:231], v[238:239]
    v_cvt_pk_bf16_f32 v56, v224, v225
    v_cvt_pk_bf16_f32 v57, v226, v227
    v_cvt_pk_bf16_f32 v58, v228, v229
    v_cvt_pk_bf16_f32 v59, v230, v231
    buffer_store_dwordx4 v[56:59], v5, s[4:7], s36 offen offset:3072 sc1
    s_lshl_b32 s35, s44, 6
    s_add_u32 s35, s35, s34
    s_lshl_b32 s35, s35, 7
    s_add_u32 s35, s35, 176128
    v_mov_b32 v6, 48136
    v_mov_b32 v7, 1
    s_waitcnt lgkmcnt(0)
    s_mov_b64 exec, 1
    ds_add_u32 v6, v7
    s_mov_b64 exec, -1
GEMM2:
    s_setprio 0
    s_add_u32 s12, s86, 0x1800000
    s_addc_u32 s13, s87, 0
    s_mov_b32 s14, 0x4b000
    s_mov_b32 s15, 0x20000
    v_lshlrev_b32 v2, 4, v1
    s_mul_i32 s34, s48, 276480
    s_add_u32 s34, s34, 0x900000
    s_add_u32 s8, s86, s34
    s_addc_u32 s9, s87, 0
    s_mov_b32 s10, 276480
    s_mov_b32 s11, 0x20000
    s_and_b32 s34, s47, 3
    s_lshl_b32 s34, s34, 1
    s_add_u32 s34, s34, s48
    s_and_b32 s34, s34, 7
    s_mul_i32 s34, s34, 7
    s_add_u32 s34, s34, s3
    s_lshl_b32 s36, s34, 12
    s_mul_i32 s37, s34, 5120
    v_add_u32 v3, 4096, v2
    buffer_load_dwordx4 v[12:15], v2, s[8:11], s37 offen offset:0 sc1
    buffer_load_dwordx4 v[16:19], v2, s[8:11], s37 offen offset:1024 sc1
    buffer_load_dwordx4 v[20:23], v2, s[8:11], s37 offen offset:2048 sc1
    buffer_load_dwordx4 v[24:27], v2, s[8:11], s37 offen offset:3072 sc1
    buffer_load_dwordx4 v[28:31], v3, s[8:11], s37 offen sc1
    s_add_u32 s37, s37, 20480
    s_cmp_ge_u32 s37, 276480
    s_cselect_b32 s39, 276480, 0
    s_sub_u32 s37, s37, s39
    buffer_load_dwordx4 v[32:35], v2, s[8:11], s37 offen offset:0 sc1
    buffer_load_dwordx4 v[36:39], v2, s[8:11], s37 offen offset:1024 sc1
    buffer_load_dwordx4 v[40:43], v2, s[8:11], s37 offen offset:2048 sc1
    buffer_load_dwordx4 v[44:47], v2, s[8:11], s37 offen offset:3072 sc1
    buffer_load_dwordx4 v[48:51], v3, s[8:11], s37 offen sc1
    s_add_u32 s37, s37, 20480
    s_cmp_ge_u32 s37, 276480
    s_cselect_b32 s39, 276480, 0
    s_sub_u32 s37, s37, s39
    v_mov_b32 v10, 0
    s_waitcnt vmcnt(10)
    s_mov_b64 exec, 1
    v_mov_b32 v4, s50
    v_mov_b32 v5, s51
    buffer_store_dwordx2 v[4:5], v10, s[12:15], s35 offen offset:0 sc1
    s_cmp_lt_u32 s2, 32
    s_cselect_b32 s39, 0x1c3d0, 0
    s_add_u32 s39, s39, 0xbc08
    v_mov_b32 v4, s39
    v_mov_b32 v5, 1
    ds_add_u32 v4, v5
    s_mov_b64 exec, -1
    buffer_load_dwordx4 v[52:55], v2, s[8:11], s37 offen offset:0 sc1
    buffer_load_dwordx4 v[56:59], v2, s[8:11], s37 offen offset:1024 sc1
    buffer_load_dwordx4 v[60:63], v2, s[8:11], s37 offen offset:2048 sc1
    buffer_load_dwordx4 v[64:67], v2, s[8:11], s37 offen offset:3072 sc1
    buffer_load_dwordx4 v[68:71], v3, s[8:11], s37 offen sc1
    s_add_u32 s37, s37, 20480
    s_cmp_ge_u32 s37, 276480
    s_cselect_b32 s39, 276480, 0
    s_sub_u32 s37, s37, s39
    buffer_load_dwordx4 v[72:75], v2, s[8:11], s37 offen offset:0 sc1
    buffer_load_dwordx4 v[76:79], v2, s[8:11], s37 offen offset:1024 sc1
    buffer_load_dwordx4 v[80:83], v2, s[8:11], s37 offen offset:2048 sc1
    buffer_load_dwordx4 v[84:87], v2, s[8:11], s37 offen offset:3072 sc1
    buffer_load_dwordx4 v[88:91], v3, s[8:11], s37 offen sc1
    s_add_u32 s37, s37, 20480
    s_cmp_ge_u32 s37, 276480
    s_cselect_b32 s39, 276480, 0
    s_sub_u32 s37, s37, s39
    buffer_load_dwordx4 v[92:95], v2, s[8:11], s37 offen offset:0 sc1
    buffer_load_dwordx4 v[96:99], v2, s[8:11], s37 offen offset:1024 sc1
    buffer_load_dwordx4 v[100:103], v2, s[8:11], s37 offen offset:2048 sc1
    buffer_load_dwordx4 v[104:107], v2, s[8:11], s37 offen offset:3072 sc1
    buffer_load_dwordx4 v[108:111], v3, s[8:11], s37 offen sc1
    s_add_u32 s37, s37, 20480
    s_cmp_ge_u32 s37, 276480
    s_cselect_b32 s39, 276480, 0
    s_sub_u32 s37, s37, s39
    s_mul_i32 s40, s3, 20480
    s_cmp_lt_u32 s2, 32
    s_cselect_b32 s43, 0xffffe000, 0
    s_add_u32 s43, s43, 0x2000
    s_cmp_ge_u32 s3, 2
    s_cselect_b32 s39, s43, 0
    s_add_u32 s40, s40, s39
    v_add_u32 v9, s40, v2
    s_cmp_lt_u32 s2, 32
    s_cselect_b32 s41, 0x1c80, 0
    s_add_u32 s41, s41, 0x2800
    s_lshr_b32 s39, s3, 1
    s_mul_i32 s41, s41, s39
    s_cmp_lt_u32 s2, 32
    s_cselect_b32 s39, 0xffffc6c0, 0
    s_add_u32 s39, s39, 0x23000
    s_add_u32 s41, s41, s39
    s_bitcmp1_b32 s3, 0
    s_cselect_b32 s39, 5120, 0
    s_add_u32 s41, s41, s39
    s_cmp_ge_u32 s2, 32
    s_cbranch_scc1 G2_nodma
    v_mov_b32 v10, 163804
    s_mov_b32 s53, 0
LS_85:
    ds_read_b32 v11, v10
    s_waitcnt lgkmcnt(0)
    v_readfirstlane_b32 s54, v11
    s_nop 0
    s_cmp_ge_u32 s54, 6
    s_cbranch_scc1 LD_86
    s_add_u32 s53, s53, 1
    s_cmp_gt_u32 s53, 3200000
    s_cbranch_scc1 LD_86
    s_sleep 1
    s_branch LS_85
LD_86:
    s_add_u32 m0, s40, 0
    s_nop 0
    buffer_load_dwordx4 v2, s[8:11], s37 offen offset:0 sc1 lds
    buffer_load_dwordx4 v2, s[8:11], s37 offen offset:1024 sc1 lds
    buffer_load_dwordx4 v2, s[8:11], s37 offen offset:2048 sc1 lds
    buffer_load_dwordx4 v2, s[8:11], s37 offen offset:3072 sc1 lds
    s_add_u32 m0, s40, 4096
    s_nop 0
    buffer_load_dwordx4 v3, s[8:11], s37 offen sc1 lds
    s_add_u32 s37, s37, 20480
    s_cmp_ge_u32 s37, 276480
    s_cselect_b32 s39, 276480, 0
    s_sub_u32 s37, s37, s39
    s_add_u32 m0, s40, 5120
    s_nop 0
    buffer_load_dwordx4 v2, s[8:11], s37 offen offset:0 sc1 lds
    buffer_load_dwordx4 v2, s[8:11], s37 offen offset:1024 sc1 lds
    buffer_load_dwordx4 v2, s[8:11], s37 offen offset:2048 sc1 lds
    buffer_load_dwordx4 v2, s[8:11], s37 offen offset:3072 sc1 lds
    s_add_u32 m0, s40, 9216
    s_nop 0
    buffer_load_dwordx4 v3, s[8:11], s37 offen sc1 lds
    s_add_u32 s37, s37, 20480
    s_cmp_ge_u32 s37, 276480
    s_cselect_b32 s39, 276480, 0
    s_sub_u32 s37, s37, s39
    s_add_u32 m0, s40, 10240
    s_nop 0
    buffer_load_dwordx4 v2, s[8:11], s37 offen offset:0 sc1 lds
    buffer_load_dwordx4 v2, s[8:11], s37 offen offset:1024 sc1 lds
    buffer_load_dwordx4 v2, s[8:11], s37 offen offset:2048 sc1 lds
    buffer_load_dwordx4 v2, s[8:11], s37 offen offset:3072 sc1 lds
    s_add_u32 m0, s40, 14336
    s_nop 0
    buffer_load_dwordx4 v3, s[8:11], s37 offen sc1 lds
    s_add_u32 s37, s37, 20480
    s_cmp_ge_u32 s37, 276480
    s_cselect_b32 s39, 276480, 0
    s_sub_u32 s37, s37, s39
    s_add_u32 m0, s40, 15360
    s_nop 0
    buffer_load_dwordx4 v2, s[8:11], s37 offen offset:0 sc1 lds
    buffer_load_dwordx4 v2, s[8:11], s37 offen offset:1024 sc1 lds
    buffer_load_dwordx4 v2, s[8:11], s37 offen offset:2048 sc1 lds
    buffer_load_dwordx4 v2, s[8:11], s37 offen offset:3072 sc1 lds
    s_add_u32 m0, s40, 19456
    s_nop 0
    buffer_load_dwordx4 v3, s[8:11], s37 offen sc1 lds
    s_add_u32 s37, s37, 20480
    s_cmp_ge_u32 s37, 276480
    s_cselect_b32 s39, 276480, 0
    s_sub_u32 s37, s37, s39
    v_mov_b32 v8, 163792
    s_cmp_lg_u32 s3, 3
    s_cbranch_scc1 G2_go
    s_setprio 0
    v_min_u32 v170, 53, v1
    s_lshr_b32 s33, s47, 1
    s_lshl_b32 s33, s33, 6
    v_add_u32 v170, s33, v170
    v_lshlrev_b32 v170, 7, v170
    v_add_u32 v170, 176128, v170
    s_mov_b64 exec, 1
    s_mov_b64 s[56:57], 1
    buffer_load_dwordx2 v[168:169], v170, s[12:15], 0 offen offset:0 sc1
    s_mov_b32 s53, 0
    s_waitcnt vmcnt(0)
PL_89:
    v_cmp_eq_u64 vcc, s[50:51], v[168:169]
    s_nop 0
    s_andn2_b64 s[54:55], s[56:57], vcc
    s_cbranch_scc0 PD_90
    s_add_u32 s53, s53, 1
    s_cmp_gt_u32 s53, 200000
    s_cbranch_scc1 PD_90
    s_sleep 8
    buffer_load_dwordx2 v[168:169], v170, s[12:15], 0 offen offset:0 sc1
    s_waitcnt vmcnt(0)
    s_branch PL_89
PD_90:
    s_mov_b64 exec, -1
    s_mov_b64 s[56:57], 0
    s_mov_b32 s53, 0
HP_87:
    buffer_load_dwordx2 v[168:169], v170, s[12:15], 0 offen offset:0 sc1
HP_87x:
    s_waitcnt vmcnt(0)
    v_cmp_eq_u64 vcc, s[50:51], v[168:169]
    s_add_u32 s53, s53, 1
    s_cmp_gt_u32 s53, 200000
    s_cselect_b64 s[54:55], -1, vcc
    s_or_b64 s[56:57], s[56:57], s[54:55]
    s_mov_b64 exec, 1
    v_mov_b32 v172, s56
    v_mov_b32 v173, s57
    ds_write_b64 v8, v[172:173]
    s_not_b64 exec, s[56:57]
    s_cbranch_scc0 HD_88
    s_sleep 1
    s_branch HP_87
HD_88:
    s_mov_b64 exec, -1
    s_branch G2_go
G2_nodma:
    v_mov_b32 v8, 48152
G2_go:
    s_cmp_lt_u32 s2, 32
    s_cselect_b32 s42, 0x1c3bc, 0
    s_add_u32 s42, s42, 0xbc0c
    s_cmp_lt_u32 s2, 32
    s_cselect_b32 s35, 0xfffffffe, 0
    s_add_u32 s35, s35, 0x4
    s_mul_i32 s34, s47, 221184
    s_add_u32 s34, s34, 0xc00000
    s_add_u32 s4, s86, s34
    s_addc_u32 s5, s87, 0
    s_mov_b32 s6, 221184
    s_mov_b32 s7, 0x20000
    s_mov_b32 s16, s82
    s_mov_b32 s17, s83
    s_mov_b32 s18, 0x280000
    s_mov_b32 s19, 0x20000
    s_add_u32 s34, s3, 0
    s_and_b32 s34, s34, 3
    s_lshl_b32 s34, s34, 10
    v_add_u32 v4, s34, v2
    s_add_u32 s34, s3, 1
    s_and_b32 s34, s34, 3
    s_lshl_b32 s34, s34, 10
    v_add_u32 v5, s34, v2
    s_add_u32 s34, s3, 2
    s_and_b32 s34, s34, 3
    s_lshl_b32 s34, s34, 10
    v_add_u32 v6, s34, v2
    s_add_u32 s34, s3, 3
    s_and_b32 s34, s34, 3
    s_lshl_b32 s34, s34, 10
    v_add_u32 v7, s34, v2
    s_mov_b64 s[58:59], 0
    s_and_b32 s34, s47, 3
    s_lshl_b32 s34, s34, 1
    s_add_u32 s34, s34, s48
    s_and_b32 s34, s34, 7
    s_mul_i32 s34, s34, 7
    s_add_u32 s34, s34, s3
    s_add_u32 s20, s34, 0
    s_lshl_b32 s20, s20, 12
    s_add_u32 s21, s34, 4
    s_cmp_ge_u32 s21, 54
    s_cselect_b32 s39, 54, 0
    s_sub_u32 s21, s21, s39
    s_lshl_b32 s21, s21, 12
    s_add_u32 s22, s34, 8
    s_cmp_ge_u32 s22, 54
    s_cselect_b32 s39, 54, 0
    s_sub_u32 s22, s22, s39
    s_lshl_b32 s22, s22, 12
    s_add_u32 s23, s34, 12
    s_cmp_ge_u32 s23, 54
    s_cselect_b32 s39, 54, 0
    s_sub_u32 s23, s23, s39
    s_lshl_b32 s23, s23, 12
    s_add_u32 s24, s34, 16
    s_cmp_ge_u32 s24, 54
    s_cselect_b32 s39, 54, 0
    s_sub_u32 s24, s24, s39
    s_lshl_b32 s24, s24, 12
    s_add_u32 s25, s34, 36
    s_cmp_ge_u32 s25, 54
    s_cselect_b32 s39, 54, 0
    s_sub_u32 s25, s25, s39
    s_lshl_b32 s25, s25, 12
    s_add_u32 s26, s34, 32
    s_cmp_ge_u32 s26, 54
    s_cselect_b32 s39, 54, 0
    s_sub_u32 s26, s26, s39
    s_lshl_b32 s26, s26, 12
    s_add_u32 s27, s34, 20
    s_cmp_ge_u32 s27, 54
    s_cselect_b32 s39, 54, 0
    s_sub_u32 s27, s27, s39
    s_lshl_b32 s27, s27, 12
    s_add_u32 s28, s34, 24
    s_cmp_ge_u32 s28, 54
    s_cselect_b32 s39, 54, 0
    s_sub_u32 s28, s28, s39
    s_lshl_b32 s28, s28, 12
    s_add_u32 s29, s34, 40
    s_cmp_ge_u32 s29, 54
    s_cselect_b32 s39, 54, 0
    s_sub_u32 s29, s29, s39
    s_mul_i32 s40, s29, 5120
    s_lshl_b32 s29, s29, 12
    s_add_u32 s30, s34, 28
    s_cmp_ge_u32 s30, 54
    s_cselect_b32 s39, 54, 0
    s_sub_u32 s30, s30, s39
    s_lshl_b32 s30, s30, 12
    s_sub_u32 s38, s3, 1
    s_and_b32 s38, s38, 3
    s_cmp_ge_u32 s38, 2
    s_cselect_b32 s39, s43, 0
    s_mul_i32 s38, s38, 20480
    s_add_u32 s38, s38, s39
    s_add_u32 s60, s38, 0
    s_sub_u32 s38, s3, 2
    s_and_b32 s38, s38, 3
    s_cmp_ge_u32 s38, 2
    s_cselect_b32 s39, s43, 0
    s_mul_i32 s38, s38, 20480
    s_add_u32 s38, s38, s39
    s_add_u32 s61, s38, 5120
    s_sub_u32 s38, s3, 3
    s_and_b32 s38, s38, 3
    s_cmp_ge_u32 s38, 2
    s_cselect_b32 s39, s43, 0
    s_mul_i32 s38, s38, 20480
    s_add_u32 s38, s38, s39
    s_add_u32 s62, s38, 10240
    s_cmp_lt_u32 s2, 32
    s_cselect_b32 s38, 0xffff5900, 0
    s_add_u32 s38, s38, 0x5400
    s_mul_i32 s38, s38, 0
    s_cmp_lt_u32 s2, 32
    s_cselect_b32 s63, 0x2fc0, 0
    s_add_u32 s63, s63, 0x18800
    s_add_u32 s63, s63, s38
    s_cmp_lt_u32 s2, 32
    s_cselect_b32 s38, 0xffff6780, 0
    s_add_u32 s38, s38, 0x5400
    s_mul_i32 s38, s38, 0
    s_cmp_lt_u32 s2, 32
    s_cselect_b32 s65, 0x9f40, 0
    s_add_u32 s65, s65, 0x1c400
    s_add_u32 s65, s65, s38
    s_mul_i32 s38, s3, 5120
    s_add_u32 s63, s63, s38
    s_cmp_eq_u32 s3, 3
    s_cselect_b32 s63, s65, s63
    s_cmp_lt_u32 s2, 32
    s_cselect_b32 s38, 0xffff5900, 0
    s_add_u32 s38, s38, 0x5400
    s_mul_i32 s38, s38, 1
    s_cmp_lt_u32 s2, 32
    s_cselect_b32 s64, 0x2fc0, 0
    s_add_u32 s64, s64, 0x18800
    s_add_u32 s64, s64, s38
    s_cmp_lt_u32 s2, 32
    s_cselect_b32 s38, 0xffff6780, 0
    s_add_u32 s38, s38, 0x5400
    s_mul_i32 s38, s38, 1
    s_cmp_lt_u32 s2, 32
    s_cselect_b32 s65, 0x9f40, 0
    s_add_u32 s65, s65, 0x1c400
    s_add_u32 s65, s65, s38
    s_mul_i32 s38, s3, 5120
    s_add_u32 s64, s64, s38
    s_cmp_eq_u32 s3, 3
    s_cselect_b32 s64, s65, s64
    s_movk_i32 s57, 1120
    s_lshl_b32 s31, s3, 3
    s_add_u32 s39, s31, 8
    s_lshl_b32 s32, 1, s39
    s_add_u32 s39, s31, 16
    s_lshl_b32 s33, 2, s39
    s_add_u32 s39, s31, 24
    s_lshl_b32 s34, 4, s39
    s_cmp_lt_u32 s2, 32
    s_cselect_b32 s36, 0xffff9900, 0
    s_add_u32 s36, s36, 0x1400
    s_lshr_b32 s39, s3, 1
    s_mul_i32 s36, s36, s39
    s_cmp_lt_u32 s2, 32
    s_cselect_b32 s39, 0x43c0, 0
    s_add_u32 s39, s39, 0x16000
    s_add_u32 s36, s36, s39
    s_bitcmp1_b32 s3, 0
    s_cselect_b32 s39, 2560, 0
    s_add_u32 s36, s36, s39
    s_lshl_b32 s37, s3, 6
    s_cmp_lt_u32 s2, 32
    s_cselect_b32 s39, 0xa000, 0
    s_add_u32 s39, s39, 0xa000
    s_add_u32 s37, s37, s39
    s_lshl_b32 s56, s47, 2
    s_add_u32 s56, s56, s3
    s_mul_i32 s56, s56, 20480
    s_mul_i32 s39, s48, 160
    s_add_u32 s56, s56, s39
    s_lshr_b32 s38, s20, 12
    s_bitcmp1_b64 s[58:59], s38
    s_cbranch_scc0 HW_i0
HR_i0:
    buffer_load_dwordx4 v[112:115], v4, s[4:7], s20 offen sc1
    buffer_load_dwordx4 v[116:119], v5, s[4:7], s20 offen sc1
    buffer_load_dwordx4 v[120:123], v6, s[4:7], s20 offen sc1
    buffer_load_dwordx4 v[124:127], v7, s[4:7], s20 offen sc1
    s_lshr_b32 s38, s21, 12
    s_bitcmp1_b64 s[58:59], s38
    s_cbranch_scc0 HW_i1
HR_i1:
    buffer_load_dwordx4 v[128:131], v4, s[4:7], s21 offen sc1
    buffer_load_dwordx4 v[132:135], v5, s[4:7], s21 offen sc1
    buffer_load_dwordx4 v[136:139], v6, s[4:7], s21 offen sc1
    buffer_load_dwordx4 v[140:143], v7, s[4:7], s21 offen sc1
    s_lshr_b32 s38, s22, 12
    s_bitcmp1_b64 s[58:59], s38
    s_cbranch_scc0 HW_i2
HR_i2:
    buffer_load_dwordx4 v[144:147], v4, s[4:7], s22 offen sc1
    buffer_load_dwordx4 v[148:151], v5, s[4:7], s22 offen sc1
    buffer_load_dwordx4 v[152:155], v6, s[4:7], s22 offen sc1
    buffer_load_dwordx4 v[156:159], v7, s[4:7], s22 offen sc1
    s_waitcnt vmcnt(11)
    v_mfma_f32_16x16x32_bf16 v[176:179], v[12:15], v[112:115], 0
    v_mfma_f32_16x16x32_bf16 v[180:183], v[16:19], v[112:115], 0
    v_mfma_f32_16x16x32_bf16 v[184:187], v[20:23], v[112:115], 0
    v_mfma_f32_16x16x32_bf16 v[188:191], v[24:27], v[112:115], 0
    v_mfma_f32_16x16x32_bf16 v[192:195], v[28:31], v[112:115], 0
    s_lshr_b32 s38, s23, 12
    s_bitcmp1_b64 s[58:59], s38
    s_cbranch_scc0 HW_i3
HR_i3:
    buffer_load_dwordx4 v[160:163], v4, s[4:7], s23 offen sc1
    s_waitcnt vmcnt(11)
    v_mfma_f32_16x16x32_bf16 v[196:199], v[12:15], v[116:119], 0
    v_mfma_f32_16x16x32_bf16 v[200:203], v[16:19], v[116:119], 0
    v_mfma_f32_16x16x32_bf16 v[204:207], v[20:23], v[116:119], 0
    v_mfma_f32_16x16x32_bf16 v[208:211], v[24:27], v[116:119], 0
    v_mfma_f32_16x16x32_bf16 v[212:215], v[28:31], v[116:119], 0
    buffer_load_dwordx4 v[164:167], v5, s[4:7], s23 offen sc1
    s_waitcnt vmcnt(11)
    v_mfma_f32_16x16x32_bf16 v[216:219], v[12:15], v[120:123], 0
    v_mfma_f32_16x16x32_bf16 v[220:223], v[16:19], v[120:123], 0
    v_mfma_f32_16x16x32_bf16 v[224:227], v[20:23], v[120:123], 0
    v_mfma_f32_16x16x32_bf16 v[228:231], v[24:27], v[120:123], 0
    v_mfma_f32_16x16x32_bf16 v[232:235], v[28:31], v[120:123], 0
    buffer_load_dwordx4 v[168:171], v6, s[4:7], s23 offen sc1
    s_waitcnt vmcnt(11)
    v_mov_b32 v10, s42
    ds_read_b32 v11, v10
    v_mfma_f32_16x16x32_bf16 v[236:239], v[12:15], v[124:127], 0
    v_mfma_f32_16x16x32_bf16 v[240:243], v[16:19], v[124:127], 0
    v_mfma_f32_16x16x32_bf16 v[244:247], v[20:23], v[124:127], 0
    v_mfma_f32_16x16x32_bf16 v[248:251], v[24:27], v[124:127], 0
    v_mfma_f32_16x16x32_bf16 v[252:255], v[28:31], v[124:127], 0
    s_waitcnt lgkmcnt(0)
    v_readfirstlane_b32 s54, v11
    s_nop 0
    s_cmp_ge_u32 s54, s35
    s_cbranch_scc0 WL_wait
WL_ret:
    buffer_load_dwordx4 v[172:175], v7, s[4:7], s23 offen sc1
    buffer_load_dwordx4 v[12:15], v2, s[8:11], s40 offen offset:0 sc1
    buffer_load_dwordx4 v[16:19], v2, s[8:11], s40 offen offset:1024 sc1
    buffer_load_dwordx4 v[20:23], v2, s[8:11], s40 offen offset:2048 sc1
    buffer_load_dwordx4 v[24:27], v2, s[8:11], s40 offen offset:3072 sc1
    buffer_load_dwordx4 v[28:31], v3, s[8:11], s40 offen sc1
    s_waitcnt vmcnt(16)
    v_mfma_f32_16x16x32_bf16 v[176:179], v[32:35], v[128:131], v[176:179]
    v_mfma_f32_16x16x32_bf16 v[180:183], v[36:39], v[128:131], v[180:183]
    v_mfma_f32_16x16x32_bf16 v[184:187], v[40:43], v[128:131], v[184:187]
    v_mfma_f32_16x16x32_bf16 v[188:191], v[44:47], v[128:131], v[188:191]
    v_mfma_f32_16x16x32_bf16 v[192:195], v[48:51], v[128:131], v[192:195]
    s_lshr_b32 s38, s24, 12
    s_bitcmp1_b64 s[58:59], s38
    s_cbranch_scc0 HW_i4
HR_i4:
    buffer_load_dwordx4 v[112:115], v4, s[4:7], s24 offen sc1
    s_waitcnt vmcnt(16)
    v_mfma_f32_16x16x32_bf16 v[196:199], v[32:35], v[132:135], v[196:199]
    v_mfma_f32_16x16x32_bf16 v[200:203], v[36:39], v[132:135], v[200:203]
    v_mfma_f32_16x16x32_bf16 v[204:207], v[40:43], v[132:135], v[204:207]
    v_mfma_f32_16x16x32_bf16 v[208:211], v[44:47], v[132:135], v[208:211]
    v_mfma_f32_16x16x32_bf16 v[212:215], v[48:51], v[132:135], v[212:215]
    buffer_load_dwordx4 v[116:119], v5, s[4:7], s24 offen sc1
    s_waitcnt vmcnt(16)
    v_mfma_f32_16x16x32_bf16 v[216:219], v[32:35], v[136:139], v[216:219]
    v_mfma_f32_16x16x32_bf16 v[220:223], v[36:39], v[136:139], v[220:223]
    v_mfma_f32_16x16x32_bf16 v[224:227], v[40:43], v[136:139], v[224:227]
    v_mfma_f32_16x16x32_bf16 v[228:231], v[44:47], v[136:139], v[228:231]
    v_mfma_f32_16x16x32_bf16 v[232:235], v[48:51], v[136:139], v[232:235]
    buffer_load_dwordx4 v[120:123], v6, s[4:7], s24 offen sc1
    s_waitcnt vmcnt(16)
    v_mfma_f32_16x16x32_bf16 v[236:239], v[32:35], v[140:143], v[236:239]
    v_mfma_f32_16x16x32_bf16 v[240:243], v[36:39], v[140:143], v[240:243]
    v_mfma_f32_16x16x32_bf16 v[244:247], v[40:43], v[140:143], v[244:247]
    v_mfma_f32_16x16x32_bf16 v[248:251], v[44:47], v[140:143], v[248:251]
    v_mfma_f32_16x16x32_bf16 v[252:255], v[48:51], v[140:143], v[252:255]
    buffer_load_dwordx4 v[124:127], v7, s[4:7], s24 offen sc1
    v_add_u32 v10, s41, v2
    ds_read_b128 v[32:35], v10 offset:0
    ds_read_b128 v[36:39], v10 offset:1024
    ds_read_b128 v[40:43], v10 offset:2048
    ds_read_b128 v[44:47], v10 offset:3072
    ds_read_b128 v[48:51], v10 offset:4096
    s_waitcnt vmcnt(16)
    v_mfma_f32_16x16x32_bf16 v[176:179], v[52:55], v[144:147], v[176:179]
    v_mfma_f32_16x16x32_bf16 v[180:183], v[56:59], v[144:147], v[180:183]
    v_mfma_f32_16x16x32_bf16 v[184:187], v[60:63], v[144:147], v[184:187]
    v_mfma_f32_16x16x32_bf16 v[188:191], v[64:67], v[144:147], v[188:191]
    v_mfma_f32_16x16x32_bf16 v[192:195], v[68:71], v[144:147], v[192:195]
    s_lshr_b32 s38, s25, 12
    s_bitcmp1_b64 s[58:59], s38
    s_cbranch_scc0 HW_i5
HR_i5:
    buffer_load_dwordx4 v[128:131], v4, s[4:7], s25 offen sc1
    s_waitcnt vmcnt(16)
    v_mfma_f32_16x16x32_bf16 v[196:199], v[52:55], v[148:151], v[196:199]
    v_mfma_f32_16x16x32_bf16 v[200:203], v[56:59], v[148:151], v[200:203]
    v_mfma_f32_16x16x32_bf16 v[204:207], v[60:63], v[148:151], v[204:207]
    v_mfma_f32_16x16x32_bf16 v[208:211], v[64:67], v[148:151], v[208:211]
    v_mfma_f32_16x16x32_bf16 v[212:215], v[68:71], v[148:151], v[212:215]
    buffer_load_dwordx4 v[132:135], v5, s[4:7], s25 offen sc1
    s_waitcnt vmcnt(16)
    v_mfma_f32_16x16x32_bf16 v[216:219], v[52:55], v[152:155], v[216:219]
    v_mfma_f32_16x16x32_bf16 v[220:223], v[56:59], v[152:155], v[220:223]
    v_mfma_f32_16x16x32_bf16 v[224:227], v[60:63], v[152:155], v[224:227]
    v_mfma_f32_16x16x32_bf16 v[228:231], v[64:67], v[152:155], v[228:231]
    v_mfma_f32_16x16x32_bf16 v[232:235], v[68:71], v[152:155], v[232:235]
    buffer_load_dwordx4 v[136:139], v6, s[4:7], s25 offen sc1
    s_waitcnt vmcnt(16)
    v_mfma_f32_16x16x32_bf16 v[236:239], v[52:55], v[156:159], v[236:239]
    v_mfma_f32_16x16x32_bf16 v[240:243], v[56:59], v[156:159], v[240:243]
    v_mfma_f32_16x16x32_bf16 v[244:247], v[60:63], v[156:159], v[244:247]
    v_mfma_f32_16x16x32_bf16 v[248:251], v[64:67], v[156:159], v[248:251]
    v_mfma_f32_16x16x32_bf16 v[252:255], v[68:71], v[156:159], v[252:255]
    buffer_load_dwordx4 v[140:143], v7, s[4:7], s25 offen sc1
    ds_read_b128 v[52:55], v9 offset:15360
    ds_read_b128 v[56:59], v9 offset:16384
    ds_read_b128 v[60:63], v9 offset:17408
    ds_read_b128 v[64:67], v9 offset:18432
    ds_read_b128 v[68:71], v9 offset:19456
    s_waitcnt vmcnt(16)
    v_mfma_f32_16x16x32_bf16 v[176:179], v[72:75], v[160:163], v[176:179]
    v_mfma_f32_16x16x32_bf16 v[180:183], v[76:79], v[160:163], v[180:183]
    v_mfma_f32_16x16x32_bf16 v[184:187], v[80:83], v[160:163], v[184:187]
    v_mfma_f32_16x16x32_bf16 v[188:191], v[84:87], v[160:163], v[188:191]
    v_mfma_f32_16x16x32_bf16 v[192:195], v[88:91], v[160:163], v[192:195]
    s_lshr_b32 s38, s26, 12
    s_bitcmp1_b64 s[58:59], s38
    s_cbranch_scc0 HW_i6
HR_i6:
    buffer_load_dwordx4 v[144:147], v5, s[4:7], s26 offen sc1
    s_waitcnt vmcnt(16)
    v_mfma_f32_16x16x32_bf16 v[196:199], v[72:75], v[164:167], v[196:199]
    v_mfma_f32_16x16x32_bf16 v[200:203], v[76:79], v[164:167], v[200:203]
    v_mfma_f32_16x16x32_bf16 v[204:207], v[80:83], v[164:167], v[204:207]
    v_mfma_f32_16x16x32_bf16 v[208:211], v[84:87], v[164:167], v[208:211]
    v_mfma_f32_16x16x32_bf16 v[212:215], v[88:91], v[164:167], v[212:215]
    s_lshr_b32 s38, s27, 12
    s_bitcmp1_b64 s[58:59], s38
    s_cbranch_scc0 HW_i7
HR_i7:
    buffer_load_dwordx4 v[148:151], v5, s[4:7], s27 offen sc1
    s_waitcnt vmcnt(16)
    v_mfma_f32_16x16x32_bf16 v[216:219], v[72:75], v[168:171], v[216:219]
    v_mfma_f32_16x16x32_bf16 v[220:223], v[76:79], v[168:171], v[220:223]
    v_mfma_f32_16x16x32_bf16 v[224:227], v[80:83], v[168:171], v[224:227]
    v_mfma_f32_16x16x32_bf16 v[228:231], v[84:87], v[168:171], v[228:231]
    v_mfma_f32_16x16x32_bf16 v[232:235], v[88:91], v[168:171], v[232:235]
    s_lshr_b32 s38, s28, 12
    s_bitcmp1_b64 s[58:59], s38
    s_cbranch_scc0 HW_i8
HR_i8:
    buffer_load_dwordx4 v[152:155], v5, s[4:7], s28 offen sc1
    s_waitcnt vmcnt(16)
    v_mfma_f32_16x16x32_bf16 v[236:239], v[72:75], v[172:175], v[236:239]
    v_mfma_f32_16x16x32_bf16 v[240:243], v[76:79], v[172:175], v[240:243]
    v_mfma_f32_16x16x32_bf16 v[244:247], v[80:83], v[172:175], v[244:247]
    v_mfma_f32_16x16x32_bf16 v[248:251], v[84:87], v[172:175], v[248:251]
    v_mfma_f32_16x16x32_bf16 v[252:255], v[88:91], v[172:175], v[252:255]
    s_lshr_b32 s38, s29, 12
    s_bitcmp1_b64 s[58:59], s38
    s_cbranch_scc0 HW_i9
HR_i9:
    buffer_load_dwordx4 v[156:159], v5, s[4:7], s29 offen sc1
    ds_read_b128 v[72:75], v9 offset:0
    ds_read_b128 v[76:79], v9 offset:1024
    ds_read_b128 v[80:83], v9 offset:2048
    ds_read_b128 v[84:87], v9 offset:3072
    ds_read_b128 v[88:91], v9 offset:4096
    s_waitcnt vmcnt(11)
    v_mfma_f32_16x16x32_bf16 v[176:179], v[92:95], v[112:115], v[176:179]
    v_mfma_f32_16x16x32_bf16 v[180:183], v[96:99], v[112:115], v[180:183]
    v_mfma_f32_16x16x32_bf16 v[184:187], v[100:103], v[112:115], v[184:187]
    v_mfma_f32_16x16x32_bf16 v[188:191], v[104:107], v[112:115], v[188:191]
    v_mfma_f32_16x16x32_bf16 v[192:195], v[108:111], v[112:115], v[192:195]
    s_lshr_b32 s38, s30, 12
    s_bitcmp1_b64 s[58:59], s38
    s_cbranch_scc0 HW_i10
HR_i10:
    buffer_load_dwordx4 v[160:163], v5, s[4:7], s30 offen sc1
    s_waitcnt vmcnt(11)
    v_mfma_f32_16x16x32_bf16 v[196:199], v[92:95], v[116:119], v[196:199]
    v_mfma_f32_16x16x32_bf16 v[200:203], v[96:99], v[116:119], v[200:203]
    v_mfma_f32_16x16x32_bf16 v[204:207], v[100:103], v[116:119], v[204:207]
    v_mfma_f32_16x16x32_bf16 v[208:211], v[104:107], v[116:119], v[208:211]
    v_mfma_f32_16x16x32_bf16 v[212:215], v[108:111], v[116:119], v[212:215]
    buffer_load_dwordx4 v[164:167], v6, s[4:7], s26 offen sc1
    s_waitcnt vmcnt(11)
    v_mfma_f32_16x16x32_bf16 v[216:219], v[92:95], v[120:123], v[216:219]
    v_mfma_f32_16x16x32_bf16 v[220:223], v[96:99], v[120:123], v[220:223]
    v_mfma_f32_16x16x32_bf16 v[224:227], v[100:103], v[120:123], v[224:227]
    v_mfma_f32_16x16x32_bf16 v[228:231], v[104:107], v[120:123], v[228:231]
    v_mfma_f32_16x16x32_bf16 v[232:235], v[108:111], v[120:123], v[232:235]
    buffer_load_dwordx4 v[168:171], v6, s[4:7], s27 offen sc1
    s_waitcnt vmcnt(11)
    v_mfma_f32_16x16x32_bf16 v[236:239], v[92:95], v[124:127], v[236:239]
    v_mfma_f32_16x16x32_bf16 v[240:243], v[96:99], v[124:127], v[240:243]
    v_mfma_f32_16x16x32_bf16 v[244:247], v[100:103], v[124:127], v[244:247]
    v_mfma_f32_16x16x32_bf16 v[248:251], v[104:107], v[124:127], v[248:251]
    v_mfma_f32_16x16x32_bf16 v[252:255], v[108:111], v[124:127], v[252:255]
    buffer_load_dwordx4 v[172:175], v6, s[4:7], s28 offen sc1
    ds_read_b128 v[92:95], v9 offset:5120
    ds_read_b128 v[96:99], v9 offset:6144
    ds_read_b128 v[100:103], v9 offset:7168
    ds_read_b128 v[104:107], v9 offset:8192
    ds_read_b128 v[108:111], v9 offset:9216
    s_waitcnt vmcnt(11)
    s_waitcnt lgkmcnt(15)
    v_mfma_f32_16x16x32_bf16 v[176:179], v[32:35], v[128:131], v[176:179]
    v_mfma_f32_16x16x32_bf16 v[180:183], v[36:39], v[128:131], v[180:183]
    v_mfma_f32_16x16x32_bf16 v[184:187], v[40:43], v[128:131], v[184:187]
    v_mfma_f32_16x16x32_bf16 v[188:191], v[44:47], v[128:131], v[188:191]
    v_mfma_f32_16x16x32_bf16 v[192:195], v[48:51], v[128:131], v[192:195]
    buffer_load_dwordx4 v[112:115], v6, s[4:7], s29 offen sc1
    s_waitcnt vmcnt(11)
    v_mfma_f32_16x16x32_bf16 v[196:199], v[32:35], v[132:135], v[196:199]
    v_mfma_f32_16x16x32_bf16 v[200:203], v[36:39], v[132:135], v[200:203]
    v_mfma_f32_16x16x32_bf16 v[204:207], v[40:43], v[132:135], v[204:207]
    v_mfma_f32_16x16x32_bf16 v[208:211], v[44:47], v[132:135], v[208:211]
    v_mfma_f32_16x16x32_bf16 v[212:215], v[48:51], v[132:135], v[212:215]
    buffer_load_dwordx4 v[116:119], v6, s[4:7], s30 offen sc1
    s_waitcnt vmcnt(11)
    v_mfma_f32_16x16x32_bf16 v[216:219], v[32:35], v[136:139], v[216:219]
    v_mfma_f32_16x16x32_bf16 v[220:223], v[36:39], v[136:139], v[220:223]
    v_mfma_f32_16x16x32_bf16 v[224:227], v[40:43], v[136:139], v[224:227]
    v_mfma_f32_16x16x32_bf16 v[228:231], v[44:47], v[136:139], v[228:231]
    v_mfma_f32_16x16x32_bf16 v[232:235], v[48:51], v[136:139], v[232:235]
    buffer_load_dwordx4 v[120:123], v7, s[4:7], s26 offen sc1
    s_waitcnt vmcnt(11)
    v_mfma_f32_16x16x32_bf16 v[236:239], v[32:35], v[140:143], v[236:239]
    v_mfma_f32_16x16x32_bf16 v[240:243], v[36:39], v[140:143], v[240:243]
    v_mfma_f32_16x16x32_bf16 v[244:247], v[40:43], v[140:143], v[244:247]
    v_mfma_f32_16x16x32_bf16 v[248:251], v[44:47], v[140:143], v[248:251]
    v_mfma_f32_16x16x32_bf16 v[252:255], v[48:51], v[140:143], v[252:255]
    buffer_load_dwordx4 v[124:127], v7, s[4:7], s27 offen sc1
    ds_read_b128 v[32:35], v9 offset:10240
    ds_read_b128 v[36:39], v9 offset:11264
    ds_read_b128 v[40:43], v9 offset:12288
    ds_read_b128 v[44:47], v9 offset:13312
    ds_read_b128 v[48:51], v9 offset:14336
    s_waitcnt vmcnt(11)
    s_waitcnt lgkmcnt(15)
    v_mfma_f32_16x16x32_bf16 v[196:199], v[52:55], v[144:147], v[196:199]
    v_add_u32 v5, s60, v2
    v_add_u32 v6, s61, v2
    v_add_u32 v3, s41, v2
    v_mfma_f32_16x16x32_bf16 v[200:203], v[56:59], v[144:147], v[200:203]
    v_mfma_f32_16x16x32_bf16 v[204:207], v[60:63], v[144:147], v[204:207]
    v_mfma_f32_16x16x32_bf16 v[208:211], v[64:67], v[144:147], v[208:211]
    v_mfma_f32_16x16x32_bf16 v[212:215], v[68:71], v[144:147], v[212:215]
    buffer_load_dwordx4 v[128:131], v7, s[4:7], s28 offen sc1
    s_waitcnt vmcnt(11)
    s_waitcnt lgkmcnt(10)
    v_mfma_f32_16x16x32_bf16 v[196:199], v[72:75], v[148:151], v[196:199]
    v_mfma_f32_16x16x32_bf16 v[200:203], v[76:79], v[148:151], v[200:203]
    v_mfma_f32_16x16x32_bf16 v[204:207], v[80:83], v[148:151], v[204:207]
    v_mfma_f32_16x16x32_bf16 v[208:211], v[84:87], v[148:151], v[208:211]
    v_mfma_f32_16x16x32_bf16 v[212:215], v[88:91], v[148:151], v[212:215]
    buffer_load_dwordx4 v[132:135], v7, s[4:7], s29 offen sc1
    s_waitcnt vmcnt(11)
    s_waitcnt lgkmcnt(5)
    v_mfma_f32_16x16x32_bf16 v[196:199], v[92:95], v[152:155], v[196:199]
    v_mfma_f32_16x16x32_bf16 v[200:203], v[96:99], v[152:155], v[200:203]
    v_mfma_f32_16x16x32_bf16 v[204:207], v[100:103], v[152:155], v[204:207]
    v_mfma_f32_16x16x32_bf16 v[208:211], v[104:107], v[152:155], v[208:211]
    v_mfma_f32_16x16x32_bf16 v[212:215], v[108:111], v[152:155], v[212:215]
    buffer_load_dwordx4 v[136:139], v7, s[4:7], s30 offen sc1
    s_waitcnt vmcnt(11)
    v_mfma_f32_16x16x32_bf16 v[196:199], v[12:15], v[156:159], v[196:199]
    v_add_u32 v7, s62, v2
    v_mfma_f32_16x16x32_bf16 v[200:203], v[16:19], v[156:159], v[200:203]
    v_mfma_f32_16x16x32_bf16 v[204:207], v[20:23], v[156:159], v[204:207]
    v_mfma_f32_16x16x32_bf16 v[208:211], v[24:27], v[156:159], v[208:211]
    v_mfma_f32_16x16x32_bf16 v[212:215], v[28:31], v[156:159], v[212:215]
    buffer_load_dwordx4 v[140:143], v4, s[4:7], s26 offen sc1
    s_waitcnt vmcnt(11)
    s_waitcnt lgkmcnt(0)
    v_mfma_f32_16x16x32_bf16 v[196:199], v[32:35], v[160:163], v[196:199]
    v_mfma_f32_16x16x32_bf16 v[200:203], v[36:39], v[160:163], v[200:203]
    v_mfma_f32_16x16x32_bf16 v[204:207], v[40:43], v[160:163], v[204:207]
    v_mfma_f32_16x16x32_bf16 v[208:211], v[44:47], v[160:163], v[208:211]
    v_mfma_f32_16x16x32_bf16 v[212:215], v[48:51], v[160:163], v[212:215]
    buffer_load_dwordx4 v[144:147], v4, s[4:7], s27 offen sc1
    s_waitcnt vmcnt(11)
    v_mfma_f32_16x16x32_bf16 v[216:219], v[52:55], v[164:167], v[216:219]
    v_add_u32 v160, s63, v2
    v_mfma_f32_16x16x32_bf16 v[220:223], v[56:59], v[164:167], v[220:223]
    ds_write_b128 v9, v[196:199] offset:0
    v_mfma_f32_16x16x32_bf16 v[224:227], v[60:63], v[164:167], v[224:227]
    ds_write_b128 v9, v[200:203] offset:1024
    v_mfma_f32_16x16x32_bf16 v[228:231], v[64:67], v[164:167], v[228:231]
    ds_write_b128 v9, v[204:207] offset:2048
    v_mfma_f32_16x16x32_bf16 v[232:235], v[68:71], v[164:167], v[232:235]
    ds_write_b128 v9, v[208:211] offset:3072
    buffer_load_dwordx4 v[148:151], v4, s[4:7], s28 offen sc1
    s_waitcnt vmcnt(11)
    v_mfma_f32_16x16x32_bf16 v[216:219], v[72:75], v[168:171], v[216:219]
    ds_write_b128 v9, v[212:215] offset:4096
    v_mfma_f32_16x16x32_bf16 v[220:223], v[76:79], v[168:171], v[220:223]
    v_mov_b32 v10, s32
    s_mov_b64 exec, 1
    ds_add_u32 v8, v10 offset:40
    s_mov_b64 exec, -1
    v_mfma_f32_16x16x32_bf16 v[224:227], v[80:83], v[168:171], v[224:227]
    v_mfma_f32_16x16x32_bf16 v[228:231], v[84:87], v[168:171], v[228:231]
    v_mfma_f32_16x16x32_bf16 v[232:235], v[88:91], v[168:171], v[232:235]
    buffer_load_dwordx4 v[152:155], v4, s[4:7], s29 offen sc1
    s_waitcnt vmcnt(11)
    v_mfma_f32_16x16x32_bf16 v[216:219], v[92:95], v[172:175], v[216:219]
    v_and_b32 v165, 15, v1
    v_lshl_add_u32 v164, v165, 2, s37
    v_lshrrev_b32 v169, 4, v1
    v_mfma_f32_16x16x32_bf16 v[220:223], v[96:99], v[172:175], v[220:223]
    v_mul_u32_u24 v165, 160, v165
    v_lshl_add_u32 v165, v169, 3, v165
    v_add_u32 v165, s41, v165
    v_mfma_f32_16x16x32_bf16 v[224:227], v[100:103], v[172:175], v[224:227]
    v_mul_u32_u24 v169, 205, v1
    v_add_u32 v166, 0, v169
    v_lshrrev_b32 v166, 11, v166
    v_mfma_f32_16x16x32_bf16 v[228:231], v[104:107], v[172:175], v[228:231]
    v_mad_u32_u24 v166, v166, s57, v2
    v_add_u32 v167, 13120, v169
    v_lshrrev_b32 v167, 11, v167
    v_mfma_f32_16x16x32_bf16 v[232:235], v[108:111], v[172:175], v[232:235]
    v_mad_u32_u24 v167, v167, s57, v2
    v_add_u32 v168, 26240, v169
    v_lshrrev_b32 v168, 11, v168
    buffer_load_dwordx4 v[156:159], v4, s[4:7], s30 offen sc1
    s_waitcnt vmcnt(11)
    v_mfma_f32_16x16x32_bf16 v[216:219], v[12:15], v[112:115], v[216:219]
    v_mad_u32_u24 v168, v168, s57, v2
    v_mfma_f32_16x16x32_bf16 v[220:223], v[16:19], v[112:115], v[220:223]
    v_mfma_f32_16x16x32_bf16 v[224:227], v[20:23], v[112:115], v[224:227]
    v_mfma_f32_16x16x32_bf16 v[228:231], v[24:27], v[112:115], v[228:231]
    v_mfma_f32_16x16x32_bf16 v[232:235], v[28:31], v[112:115], v[232:235]
    s_waitcnt vmcnt(10)
    v_mfma_f32_16x16x32_bf16 v[216:219], v[32:35], v[116:119], v[216:219]
    v_mfma_f32_16x16x32_bf16 v[220:223], v[36:39], v[116:119], v[220:223]
    v_mfma_f32_16x16x32_bf16 v[224:227], v[40:43], v[116:119], v[224:227]
    v_mfma_f32_16x16x32_bf16 v[228:231], v[44:47], v[116:119], v[228:231]
    v_mfma_f32_16x16x32_bf16 v[232:235], v[48:51], v[116:119], v[232:235]
    s_waitcnt vmcnt(9)
    v_mfma_f32_16x16x32_bf16 v[236:239], v[52:55], v[120:123], v[236:239]
    ds_read_b32 v11, v8 offset:40
    v_mfma_f32_16x16x32_bf16 v[240:243], v[56:59], v[120:123], v[240:243]
    ds_write_b128 v9, v[216:219] offset:5120
    v_mfma_f32_16x16x32_bf16 v[244:247], v[60:63], v[120:123], v[244:247]
    ds_write_b128 v9, v[220:223] offset:6144
    v_mfma_f32_16x16x32_bf16 v[248:251], v[64:67], v[120:123], v[248:251]
    ds_write_b128 v9, v[224:227] offset:7168
    v_mfma_f32_16x16x32_bf16 v[252:255], v[68:71], v[120:123], v[252:255]
    ds_write_b128 v9, v[228:231] offset:8192
    s_waitcnt vmcnt(8)
    v_mfma_f32_16x16x32_bf16 v[236:239], v[72:75], v[124:127], v[236:239]
    ds_write_b128 v9, v[232:235] offset:9216
    v_mfma_f32_16x16x32_bf16 v[240:243], v[76:79], v[124:127], v[240:243]
    v_mov_b32 v10, s33
    s_mov_b64 exec, 1
    ds_add_u32 v8, v10 offset:40
    s_mov_b64 exec, -1
    s_waitcnt lgkmcnt(6)
    v_readfirstlane_b32 s54, v11
    s_nop 0
    s_lshr_b32 s54, s54, s31
    s_andn2_b32 s54, 1, s54
    s_cbranch_scc1 PW_1
PWR_1:
    ds_read_b128 v[196:199], v5 offset:0
    v_mfma_f32_16x16x32_bf16 v[244:247], v[80:83], v[124:127], v[244:247]
    ds_read_b128 v[200:203], v5 offset:1024
    ds_read_b128 v[204:207], v5 offset:2048
    ds_read_b128 v[208:211], v5 offset:3072
    v_mfma_f32_16x16x32_bf16 v[248:251], v[84:87], v[124:127], v[248:251]
    ds_read_b128 v[212:215], v5 offset:4096
    v_mfma_f32_16x16x32_bf16 v[252:255], v[88:91], v[124:127], v[252:255]
    s_waitcnt vmcnt(7)
    v_mfma_f32_16x16x32_bf16 v[236:239], v[92:95], v[128:131], v[236:239]
    v_mfma_f32_16x16x32_bf16 v[240:243], v[96:99], v[128:131], v[240:243]
    v_mfma_f32_16x16x32_bf16 v[244:247], v[100:103], v[128:131], v[244:247]
    v_mfma_f32_16x16x32_bf16 v[248:251], v[104:107], v[128:131], v[248:251]
    v_mfma_f32_16x16x32_bf16 v[252:255], v[108:111], v[128:131], v[252:255]
    s_waitcnt lgkmcnt(0)
    v_pk_add_f32 v[176:177], v[176:177], v[196:197]
    v_pk_add_f32 v[178:179], v[178:179], v[198:199]
    v_pk_add_f32 v[180:181], v[180:181], v[200:201]
    s_waitcnt vmcnt(6)
    v_mfma_f32_16x16x32_bf16 v[236:239], v[12:15], v[132:135], v[236:239]
    v_pk_add_f32 v[182:183], v[182:183], v[202:203]
    v_pk_add_f32 v[184:185], v[184:185], v[204:205]
    v_pk_add_f32 v[186:187], v[186:187], v[206:207]
    v_mfma_f32_16x16x32_bf16 v[240:243], v[16:19], v[132:135], v[240:243]
    v_pk_add_f32 v[188:189], v[188:189], v[208:209]
    v_pk_add_f32 v[190:191], v[190:191], v[210:211]
    v_pk_add_f32 v[192:193], v[192:193], v[212:213]
    v_mfma_f32_16x16x32_bf16 v[244:247], v[20:23], v[132:135], v[244:247]
    v_pk_add_f32 v[194:195], v[194:195], v[214:215]
    v_mfma_f32_16x16x32_bf16 v[248:251], v[24:27], v[132:135], v[248:251]
    v_mfma_f32_16x16x32_bf16 v[252:255], v[28:31], v[132:135], v[252:255]
    s_waitcnt vmcnt(5)
    v_mfma_f32_16x16x32_bf16 v[236:239], v[32:35], v[136:139], v[236:239]
    v_mfma_f32_16x16x32_bf16 v[240:243], v[36:39], v[136:139], v[240:243]
    v_mfma_f32_16x16x32_bf16 v[244:247], v[40:43], v[136:139], v[244:247]
    v_mfma_f32_16x16x32_bf16 v[248:251], v[44:47], v[136:139], v[248:251]
    v_mfma_f32_16x16x32_bf16 v[252:255], v[48:51], v[136:139], v[252:255]
    s_waitcnt vmcnt(4)
    v_mfma_f32_16x16x32_bf16 v[176:179], v[52:55], v[140:143], v[176:179]
    ds_read_b32 v11, v8 offset:40
    v_mfma_f32_16x16x32_bf16 v[180:183], v[56:59], v[140:143], v[180:183]
    ds_write_b128 v9, v[236:239] offset:10240
    v_mfma_f32_16x16x32_bf16 v[184:187], v[60:63], v[140:143], v[184:187]
    ds_write_b128 v9, v[240:243] offset:11264
    v_mfma_f32_16x16x32_bf16 v[188:191], v[64:67], v[140:143], v[188:191]
    ds_write_b128 v9, v[244:247] offset:12288
    v_mfma_f32_16x16x32_bf16 v[192:195], v[68:71], v[140:143], v[192:195]
    ds_write_b128 v9, v[248:251] offset:13312
    s_waitcnt vmcnt(3)
    v_mfma_f32_16x16x32_bf16 v[176:179], v[72:75], v[144:147], v[176:179]
    ds_write_b128 v9, v[252:255] offset:14336
    v_mfma_f32_16x16x32_bf16 v[180:183], v[76:79], v[144:147], v[180:183]
    v_mov_b32 v10, s34
    s_mov_b64 exec, 1
    ds_add_u32 v8, v10 offset:40
    s_mov_b64 exec, -1
    s_waitcnt lgkmcnt(6)
    v_readfirstlane_b32 s54, v11
    s_nop 0
    s_lshr_b32 s54, s54, s31
    s_andn2_b32 s54, 2, s54
    s_cbranch_scc1 PW_2
PWR_2:
    ds_read_b128 v[196:199], v6 offset:0
    v_mfma_f32_16x16x32_bf16 v[184:187], v[80:83], v[144:147], v[184:187]
    ds_read_b128 v[200:203], v6 offset:1024
    ds_read_b128 v[204:207], v6 offset:2048
    ds_read_b128 v[208:211], v6 offset:3072
    v_mfma_f32_16x16x32_bf16 v[188:191], v[84:87], v[144:147], v[188:191]
    ds_read_b128 v[212:215], v6 offset:4096
    v_mfma_f32_16x16x32_bf16 v[192:195], v[88:91], v[144:147], v[192:195]
    s_waitcnt vmcnt(2)
    v_mfma_f32_16x16x32_bf16 v[176:179], v[92:95], v[148:151], v[176:179]
    ds_read_b32 v11, v8 offset:40
    v_mfma_f32_16x16x32_bf16 v[180:183], v[96:99], v[148:151], v[180:183]
    v_mfma_f32_16x16x32_bf16 v[184:187], v[100:103], v[148:151], v[184:187]
    v_mfma_f32_16x16x32_bf16 v[188:191], v[104:107], v[148:151], v[188:191]
    v_mfma_f32_16x16x32_bf16 v[192:195], v[108:111], v[148:151], v[192:195]
    s_waitcnt vmcnt(1)
    v_mfma_f32_16x16x32_bf16 v[176:179], v[12:15], v[152:155], v[176:179]
    v_mfma_f32_16x16x32_bf16 v[180:183], v[16:19], v[152:155], v[180:183]
    s_waitcnt lgkmcnt(0)
    v_readfirstlane_b32 s54, v11
    s_nop 0
    s_lshr_b32 s54, s54, s31
    s_andn2_b32 s54, 36, s54
    s_cbranch_scc1 PW_3
PWR_3:
    ds_read_b128 v[216:219], v7 offset:0
    ds_read_b128 v[220:223], v7 offset:1024
    v_mfma_f32_16x16x32_bf16 v[184:187], v[20:23], v[152:155], v[184:187]
    ds_read_b128 v[224:227], v7 offset:2048
    ds_read_b128 v[228:231], v7 offset:3072
    ds_read_b128 v[232:235], v7 offset:4096
    v_mfma_f32_16x16x32_bf16 v[188:191], v[24:27], v[152:155], v[188:191]
    ds_read_b32 v10, v164
    ds_read_b128 v[236:239], v160 offset:0
    ds_read_b128 v[240:243], v160 offset:1024
    v_mfma_f32_16x16x32_bf16 v[192:195], v[28:31], v[152:155], v[192:195]
    ds_read_b128 v[244:247], v160 offset:2048
    ds_read_b128 v[248:251], v160 offset:3072
    ds_read_b128 v[252:255], v160 offset:4096
    s_waitcnt vmcnt(0)
    v_mfma_f32_16x16x32_bf16 v[176:179], v[32:35], v[156:159], v[176:179]
    v_mfma_f32_16x16x32_bf16 v[180:183], v[36:39], v[156:159], v[180:183]
    v_mfma_f32_16x16x32_bf16 v[184:187], v[40:43], v[156:159], v[184:187]
    v_mfma_f32_16x16x32_bf16 v[188:191], v[44:47], v[156:159], v[188:191]
    s_waitcnt lgkmcnt(6)
    v_pk_add_f32 v[196:197], v[196:197], v[216:217]
    v_pk_add_f32 v[198:199], v[198:199], v[218:219]
    v_pk_add_f32 v[200:201], v[200:201], v[220:221]
    v_mfma_f32_16x16x32_bf16 v[192:195], v[48:51], v[156:159], v[192:195]
    v_pk_add_f32 v[202:203], v[202:203], v[222:223]
    v_pk_add_f32 v[204:205], v[204:205], v[224:225]
    v_pk_add_f32 v[206:207], v[206:207], v[226:227]
    v_pk_add_f32 v[208:209], v[208:209], v[228:229]
    v_pk_add_f32 v[210:211], v[210:211], v[230:231]
    v_pk_add_f32 v[212:213], v[212:213], v[232:233]
    v_pk_add_f32 v[214:215], v[214:215], v[234:235]
    s_waitcnt lgkmcnt(0)
    v_pk_fma_f32 v[236:237], v[196:197], v[10:11], v[236:237] op_sel_hi:[1,0,1]
    v_pk_fma_f32 v[238:239], v[198:199], v[10:11], v[238:239] op_sel_hi:[1,0,1]
    v_pk_fma_f32 v[240:241], v[200:201], v[10:11], v[240:241] op_sel_hi:[1,0,1]
    v_pk_fma_f32 v[242:243], v[202:203], v[10:11], v[242:243] op_sel_hi:[1,0,1]
    v_pk_fma_f32 v[244:245], v[204:205], v[10:11], v[244:245] op_sel_hi:[1,0,1]
    v_pk_fma_f32 v[246:247], v[206:207], v[10:11], v[246:247] op_sel_hi:[1,0,1]
    v_pk_fma_f32 v[248:249], v[208:209], v[10:11], v[248:249] op_sel_hi:[1,0,1]
    v_pk_fma_f32 v[250:251], v[210:211], v[10:11], v[250:251] op_sel_hi:[1,0,1]
    v_pk_fma_f32 v[252:253], v[212:213], v[10:11], v[252:253] op_sel_hi:[1,0,1]
    v_pk_fma_f32 v[254:255], v[214:215], v[10:11], v[254:255] op_sel_hi:[1,0,1]
    v_pk_fma_f32 v[236:237], v[176:177], v[10:11], v[236:237] op_sel_hi:[1,0,1]
    v_pk_fma_f32 v[238:239], v[178:179], v[10:11], v[238:239] op_sel_hi:[1,0,1]
    v_cvt_pk_bf16_f32 v12, v236, v237
    v_cvt_pk_bf16_f32 v13, v238, v239
    ds_write_b64 v165, v[12:13] offset:0
    v_pk_fma_f32 v[240:241], v[180:181], v[10:11], v[240:241] op_sel_hi:[1,0,1]
    v_pk_fma_f32 v[242:243], v[182:183], v[10:11], v[242:243] op_sel_hi:[1,0,1]
    v_cvt_pk_bf16_f32 v14, v240, v241
    v_cvt_pk_bf16_f32 v15, v242, v243
    ds_write_b64 v165, v[14:15] offset:32
    v_pk_fma_f32 v[244:245], v[184:185], v[10:11], v[244:245] op_sel_hi:[1,0,1]
    v_pk_fma_f32 v[246:247], v[186:187], v[10:11], v[246:247] op_sel_hi:[1,0,1]
    v_cvt_pk_bf16_f32 v16, v244, v245
    v_cvt_pk_bf16_f32 v17, v246, v247
    ds_write_b64 v165, v[16:17] offset:64
    v_pk_fma_f32 v[248:249], v[188:189], v[10:11], v[248:249] op_sel_hi:[1,0,1]
    v_pk_fma_f32 v[250:251], v[190:191], v[10:11], v[250:251] op_sel_hi:[1,0,1]
    v_cvt_pk_bf16_f32 v18, v248, v249
    v_cvt_pk_bf16_f32 v19, v250, v251
    ds_write_b64 v165, v[18:19] offset:96
    v_pk_fma_f32 v[252:253], v[192:193], v[10:11], v[252:253] op_sel_hi:[1,0,1]
    v_pk_fma_f32 v[254:255], v[194:195], v[10:11], v[254:255] op_sel_hi:[1,0,1]
    v_cvt_pk_bf16_f32 v20, v252, v253
    v_cvt_pk_bf16_f32 v21, v254, v255
    ds_write_b64 v165, v[20:21] offset:128
    ds_read_b128 v[24:27], v3 offset:0
    ds_read_b128 v[28:31], v3 offset:1024
    ds_read_b128 v[32:35], v3 offset:2048
    s_waitcnt lgkmcnt(2)
    buffer_store_dwordx4 v[24:27], v166, s[16:19], s56 offen offset:0 sc1
    s_waitcnt lgkmcnt(1)
    buffer_store_dwordx4 v[28:31], v167, s[16:19], s56 offen offset:1024 sc1
    s_waitcnt lgkmcnt(0)
    s_mov_b64 exec, 0xffffffff
    buffer_store_dwordx4 v[32:35], v168, s[16:19], s56 offen offset:2048 sc1
    s_mov_b64 exec, -1
K_end:
    s_endpgm
WL_wait:
    v_mov_b32 v10, s42
    s_mov_b32 s53, 0
LS_91:
    ds_read_b32 v11, v10
    s_waitcnt lgkmcnt(0)
    v_readfirstlane_b32 s54, v11
    s_nop 0
    s_cmp_ge_u32 s54, s35
    s_cbranch_scc1 LD_92
    s_add_u32 s53, s53, 1
    s_cmp_gt_u32 s53, 3200000
    s_cbranch_scc1 LD_92
    s_sleep 1
    s_branch LS_91
LD_92:
    s_branch WL_ret
FR_wait:
    s_mov_b32 s53, 0
FR_loop:
    ds_read_b32 v7, v3 offset:40
    s_add_u32 s53, s53, 1
    s_waitcnt lgkmcnt(0)
    v_readfirstlane_b32 s54, v7
    s_cmp_gt_u32 s53, 3200000
    s_cbranch_scc1 FR_ret
    s_bitcmp1_b32 s54, s34
    s_cbranch_scc1 FR_ret
    s_sleep 1
    s_branch FR_loop
PW_1:
    s_mov_b32 s53, 0
PWL_1:
    ds_read_b32 v11, v8 offset:40
    s_add_u32 s53, s53, 1
    s_waitcnt lgkmcnt(0)
    v_readfirstlane_b32 s54, v11
    s_cmp_gt_u32 s53, 3200000
    s_cbranch_scc1 PWR_1
    s_lshr_b32 s54, s54, s31
    s_andn2_b32 s54, 1, s54
    s_cbranch_scc0 PWR_1
    s_sleep 1
    s_branch PWL_1
PW_2:
    s_mov_b32 s53, 0
PWL_2:
    ds_read_b32 v11, v8 offset:40
    s_add_u32 s53, s53, 1
    s_waitcnt lgkmcnt(0)
    v_readfirstlane_b32 s54, v11
    s_cmp_gt_u32 s53, 3200000
    s_cbranch_scc1 PWR_2
    s_lshr_b32 s54, s54, s31
    s_andn2_b32 s54, 2, s54
    s_cbranch_scc0 PWR_2
    s_sleep 1
    s_branch PWL_2
PW_3:
    s_mov_b32 s53, 0
PWL_3:
    ds_read_b32 v11, v8 offset:40
    s_add_u32 s53, s53, 1
    s_waitcnt lgkmcnt(0)
    v_readfirstlane_b32 s54, v11
    s_cmp_gt_u32 s53, 3200000
    s_cbranch_scc1 PWR_3
    s_lshr_b32 s54, s54, s31
    s_andn2_b32 s54, 36, s54
    s_cbranch_scc0 PWR_3
    s_sleep 1
    s_branch PWL_3
HW_g0:
    s_mov_b32 s53, 0
HL_g0:
    ds_read_b64 v[6:7], v3
    s_add_u32 s53, s53, 1
    s_waitcnt lgkmcnt(0)
    v_readfirstlane_b32 s58, v6
    v_readfirstlane_b32 s59, v7
    s_cmp_gt_u32 s53, 3200000
    s_cbranch_scc1 HR_g0
    s_bitcmp1_b64 s[58:59], s38
    s_cbranch_scc1 HR_g0
    s_sleep 1
    s_branch HL_g0
HW_g1:
    s_mov_b32 s53, 0
HL_g1:
    ds_read_b64 v[6:7], v3
    s_add_u32 s53, s53, 1
    s_waitcnt lgkmcnt(0)
    v_readfirstlane_b32 s58, v6
    v_readfirstlane_b32 s59, v7
    s_cmp_gt_u32 s53, 3200000
    s_cbranch_scc1 HR_g1
    s_bitcmp1_b64 s[58:59], s38
    s_cbranch_scc1 HR_g1
    s_sleep 1
    s_branch HL_g1
HW_g2:
    s_mov_b32 s53, 0
HL_g2:
    ds_read_b64 v[6:7], v3
    s_add_u32 s53, s53, 1
    s_waitcnt lgkmcnt(0)
    v_readfirstlane_b32 s58, v6
    v_readfirstlane_b32 s59, v7
    s_cmp_gt_u32 s53, 3200000
    s_cbranch_scc1 HR_g2
    s_bitcmp1_b64 s[58:59], s38
    s_cbranch_scc1 HR_g2
    s_sleep 1
    s_branch HL_g2
HW_g3:
    s_mov_b32 s53, 0
HL_g3:
    ds_read_b64 v[6:7], v3
    s_add_u32 s53, s53, 1
    s_waitcnt lgkmcnt(0)
    v_readfirstlane_b32 s58, v6
    v_readfirstlane_b32 s59, v7
    s_cmp_gt_u32 s53, 3200000
    s_cbranch_scc1 HR_g3
    s_bitcmp1_b64 s[58:59], s38
    s_cbranch_scc1 HR_g3
    s_sleep 1
    s_branch HL_g3
HW_g4:
    s_mov_b32 s53, 0
HL_g4:
    ds_read_b64 v[6:7], v3
    s_add_u32 s53, s53, 1
    s_waitcnt lgkmcnt(0)
    v_readfirstlane_b32 s58, v6
    v_readfirstlane_b32 s59, v7
    s_cmp_gt_u32 s53, 3200000
    s_cbranch_scc1 HR_g4
    s_bitcmp1_b64 s[58:59], s38
    s_cbranch_scc1 HR_g4
    s_sleep 1
    s_branch HL_g4
HW_i0:
    s_mov_b32 s53, 0
HL_i0:
    ds_read_b64 v[10:11], v8
    s_add_u32 s53, s53, 1
    s_waitcnt lgkmcnt(0)
    v_readfirstlane_b32 s58, v10
    v_readfirstlane_b32 s59, v11
    s_cmp_gt_u32 s53, 3200000
    s_cbranch_scc1 HR_i0
    s_bitcmp1_b64 s[58:59], s38
    s_cbranch_scc1 HR_i0
    s_sleep 1
    s_branch HL_i0
HW_i1:
    s_mov_b32 s53, 0
HL_i1:
    ds_read_b64 v[10:11], v8
    s_add_u32 s53, s53, 1
    s_waitcnt lgkmcnt(0)
    v_readfirstlane_b32 s58, v10
    v_readfirstlane_b32 s59, v11
    s_cmp_gt_u32 s53, 3200000
    s_cbranch_scc1 HR_i1
    s_bitcmp1_b64 s[58:59], s38
    s_cbranch_scc1 HR_i1
    s_sleep 1
    s_branch HL_i1
HW_i2:
    s_mov_b32 s53, 0
HL_i2:
    ds_read_b64 v[10:11], v8
    s_add_u32 s53, s53, 1
    s_waitcnt lgkmcnt(0)
    v_readfirstlane_b32 s58, v10
    v_readfirstlane_b32 s59, v11
    s_cmp_gt_u32 s53, 3200000
    s_cbranch_scc1 HR_i2
    s_bitcmp1_b64 s[58:59], s38
    s_cbranch_scc1 HR_i2
    s_sleep 1
    s_branch HL_i2
HW_i3:
    s_mov_b32 s53, 0
HL_i3:
    ds_read_b64 v[10:11], v8
    s_add_u32 s53, s53, 1
    s_waitcnt lgkmcnt(0)
    v_readfirstlane_b32 s58, v10
    v_readfirstlane_b32 s59, v11
    s_cmp_gt_u32 s53, 3200000
    s_cbranch_scc1 HR_i3
    s_bitcmp1_b64 s[58:59], s38
    s_cbranch_scc1 HR_i3
    s_sleep 1
    s_branch HL_i3
HW_i4:
    s_mov_b32 s53, 0
HL_i4:
    ds_read_b64 v[10:11], v8
    s_add_u32 s53, s53, 1
    s_waitcnt lgkmcnt(0)
    v_readfirstlane_b32 s58, v10
    v_readfirstlane_b32 s59, v11
    s_cmp_gt_u32 s53, 3200000
    s_cbranch_scc1 HR_i4
    s_bitcmp1_b64 s[58:59], s38
    s_cbranch_scc1 HR_i4
    s_sleep 1
    s_branch HL_i4
HW_i5:
    s_mov_b32 s53, 0
HL_i5:
    ds_read_b64 v[10:11], v8
    s_add_u32 s53, s53, 1
    s_waitcnt lgkmcnt(0)
    v_readfirstlane_b32 s58, v10
    v_readfirstlane_b32 s59, v11
    s_cmp_gt_u32 s53, 3200000
    s_cbranch_scc1 HR_i5
    s_bitcmp1_b64 s[58:59], s38
    s_cbranch_scc1 HR_i5
    s_sleep 1
    s_branch HL_i5
HW_i6:
    s_mov_b32 s53, 0
HL_i6:
    ds_read_b64 v[10:11], v8
    s_add_u32 s53, s53, 1
    s_waitcnt lgkmcnt(0)
    v_readfirstlane_b32 s58, v10
    v_readfirstlane_b32 s59, v11
    s_cmp_gt_u32 s53, 3200000
    s_cbranch_scc1 HR_i6
    s_bitcmp1_b64 s[58:59], s38
    s_cbranch_scc1 HR_i6
    s_sleep 1
    s_branch HL_i6
HW_i7:
    s_mov_b32 s53, 0
HL_i7:
    ds_read_b64 v[10:11], v8
    s_add_u32 s53, s53, 1
    s_waitcnt lgkmcnt(0)
    v_readfirstlane_b32 s58, v10
    v_readfirstlane_b32 s59, v11
    s_cmp_gt_u32 s53, 3200000
    s_cbranch_scc1 HR_i7
    s_bitcmp1_b64 s[58:59], s38
    s_cbranch_scc1 HR_i7
    s_sleep 1
    s_branch HL_i7
HW_i8:
    s_mov_b32 s53, 0
HL_i8:
    ds_read_b64 v[10:11], v8
    s_add_u32 s53, s53, 1
    s_waitcnt lgkmcnt(0)
    v_readfirstlane_b32 s58, v10
    v_readfirstlane_b32 s59, v11
    s_cmp_gt_u32 s53, 3200000
    s_cbranch_scc1 HR_i8
    s_bitcmp1_b64 s[58:59], s38
    s_cbranch_scc1 HR_i8
    s_sleep 1
    s_branch HL_i8
HW_i9:
    s_mov_b32 s53, 0
HL_i9:
    ds_read_b64 v[10:11], v8
    s_add_u32 s53, s53, 1
    s_waitcnt lgkmcnt(0)
    v_readfirstlane_b32 s58, v10
    v_readfirstlane_b32 s59, v11
    s_cmp_gt_u32 s53, 3200000
    s_cbranch_scc1 HR_i9
    s_bitcmp1_b64 s[58:59], s38
    s_cbranch_scc1 HR_i9
    s_sleep 1
    s_branch HL_i9
HW_i10:
    s_mov_b32 s53, 0
HL_i10:
    ds_read_b64 v[10:11], v8
    s_add_u32 s53, s53, 1
    s_waitcnt lgkmcnt(0)
    v_readfirstlane_b32 s58, v10
    v_readfirstlane_b32 s59, v11
    s_cmp_gt_u32 s53, 3200000
    s_cbranch_scc1 HR_i10
    s_bitcmp1_b64 s[58:59], s38
    s_cbranch_scc1 HR_i10
    s_sleep 1
    s_branch HL_i10
CS_0:
    v_mfma_f32_16x16x32_bf16 v[240:243], v[16:19], v[12:15], 0
    v_mfma_f32_16x16x32_bf16 v[244:247], v[20:23], v[12:15], 0
    v_mfma_f32_16x16x32_bf16 v[248:251], v[24:27], v[12:15], 0
    v_mfma_f32_16x16x32_bf16 v[252:255], v[28:31], v[12:15], 0
    s_branch CSR_0
CS_1:
    v_mfma_f32_16x16x32_bf16 v[240:243], v[64:67], v[12:15], v[240:243]
    v_mfma_f32_16x16x32_bf16 v[244:247], v[68:71], v[12:15], v[244:247]
    v_mfma_f32_16x16x32_bf16 v[248:251], v[72:75], v[12:15], v[248:251]
    v_mfma_f32_16x16x32_bf16 v[252:255], v[76:79], v[12:15], v[252:255]
    s_nop 4
    buffer_store_dwordx4 v[240:243], v10, s[12:15], s38 offen offset:0 sc1
    buffer_store_dwordx4 v[244:247], v10, s[12:15], s38 offen offset:64 sc1
    buffer_store_dwordx4 v[248:251], v10, s[12:15], s38 offen offset:512 sc1
    buffer_store_dwordx4 v[252:255], v10, s[12:15], s38 offen offset:576 sc1
    s_branch CSR_1
CS_2:
    v_mfma_f32_16x16x32_bf16 v[240:243], v[16:19], v[12:15], 0
    v_mfma_f32_16x16x32_bf16 v[244:247], v[20:23], v[12:15], 0
    v_mfma_f32_16x16x32_bf16 v[248:251], v[24:27], v[12:15], 0
    v_mfma_f32_16x16x32_bf16 v[252:255], v[28:31], v[12:15], 0
    s_branch CSR_2
CS_3:
    v_mfma_f32_16x16x32_bf16 v[240:243], v[64:67], v[12:15], v[240:243]
    v_mfma_f32_16x16x32_bf16 v[244:247], v[68:71], v[12:15], v[244:247]
    v_mfma_f32_16x16x32_bf16 v[248:251], v[72:75], v[12:15], v[248:251]
    v_mfma_f32_16x16x32_bf16 v[252:255], v[76:79], v[12:15], v[252:255]
    s_nop 4
    buffer_store_dwordx4 v[240:243], v10, s[12:15], s38 offen offset:0 sc1
    buffer_store_dwordx4 v[244:247], v10, s[12:15], s38 offen offset:64 sc1
    buffer_store_dwordx4 v[248:251], v10, s[12:15], s38 offen offset:512 sc1
    buffer_store_dwordx4 v[252:255], v10, s[12:15], s38 offen offset:576 sc1
    s_branch CSR_3
CS_4:
    v_mfma_f32_16x16x32_bf16 v[240:243], v[16:19], v[12:15], 0
    v_mfma_f32_16x16x32_bf16 v[244:247], v[20:23], v[12:15], 0
    v_mfma_f32_16x16x32_bf16 v[248:251], v[24:27], v[12:15], 0
    v_mfma_f32_16x16x32_bf16 v[252:255], v[28:31], v[12:15], 0
    s_branch CSR_4
CS_5:
    v_mfma_f32_16x16x32_bf16 v[240:243], v[64:67], v[12:15], v[240:243]
    v_mfma_f32_16x16x32_bf16 v[244:247], v[68:71], v[12:15], v[244:247]
    v_mfma_f32_16x16x32_bf16 v[248:251], v[72:75], v[12:15], v[248:251]
    v_mfma_f32_16x16x32_bf16 v[252:255], v[76:79], v[12:15], v[252:255]
    s_nop 4
    buffer_store_dwordx4 v[240:243], v10, s[12:15], s38 offen offset:0 sc1
    buffer_store_dwordx4 v[244:247], v10, s[12:15], s38 offen offset:64 sc1
    buffer_store_dwordx4 v[248:251], v10, s[12:15], s38 offen offset:512 sc1
    buffer_store_dwordx4 v[252:255], v10, s[12:15], s38 offen offset:576 sc1
    s_branch CSR_5
CS_6:
    v_mfma_f32_16x16x32_bf16 v[240:243], v[16:19], v[12:15], 0
    v_mfma_f32_16x16x32_bf16 v[244:247], v[20:23], v[12:15], 0
    v_mfma_f32_16x16x32_bf16 v[248:251], v[24:27], v[12:15], 0
    v_mfma_f32_16x16x32_bf16 v[252:255], v[28:31], v[12:15], 0
    s_branch CSR_6
CS_7:
    v_mfma_f32_16x16x32_bf16 v[240:243], v[64:67], v[12:15], v[240:243]
    v_mfma_f32_16x16x32_bf16 v[244:247], v[68:71], v[12:15], v[244:247]
    v_mfma_f32_16x16x32_bf16 v[248:251], v[72:75], v[12:15], v[248:251]
    v_mfma_f32_16x16x32_bf16 v[252:255], v[76:79], v[12:15], v[252:255]
    s_nop 4
    buffer_store_dwordx4 v[240:243], v10, s[12:15], s38 offen offset:0 sc1
    buffer_store_dwordx4 v[244:247], v10, s[12:15], s38 offen offset:64 sc1
    buffer_store_dwordx4 v[248:251], v10, s[12:15], s38 offen offset:512 sc1
    buffer_store_dwordx4 v[252:255], v10, s[12:15], s38 offen offset:576 sc1
    s_branch CSR_7
CS_8:
    v_mfma_f32_16x16x32_bf16 v[240:243], v[16:19], v[12:15], 0
    v_mfma_f32_16x16x32_bf16 v[244:247], v[20:23], v[12:15], 0
    v_mfma_f32_16x16x32_bf16 v[248:251], v[24:27], v[12:15], 0
    v_mfma_f32_16x16x32_bf16 v[252:255], v[28:31], v[12:15], 0
    s_branch CSR_8
CS_9:
    v_mfma_f32_16x16x32_bf16 v[240:243], v[64:67], v[12:15], v[240:243]
    v_mfma_f32_16x16x32_bf16 v[244:247], v[68:71], v[12:15], v[244:247]
    v_mfma_f32_16x16x32_bf16 v[248:251], v[72:75], v[12:15], v[248:251]
    v_mfma_f32_16x16x32_bf16 v[252:255], v[76:79], v[12:15], v[252:255]
    s_nop 4
    buffer_store_dwordx4 v[240:243], v10, s[12:15], s38 offen offset:0 sc1
    buffer_store_dwordx4 v[244:247], v10, s[12:15], s38 offen offset:64 sc1
    buffer_store_dwordx4 v[248:251], v10, s[12:15], s38 offen offset:512 sc1
    buffer_store_dwordx4 v[252:255], v10, s[12:15], s38 offen offset:576 sc1
    s_branch CSR_9
K_last:
.p2align 4
K_box:
.long 0x0, 0x0, 0x0, 0x0, 0x0, 0x0, 0x0, 0x0
.long 0x0, 0x0, 0x0, 0x0, 0x0, 0x0, 0x0, 0x0
.long 0x0, 0x0, 0x0, 0x0, 0x0, 0x0, 0x0, 0x0
.long 0x0, 0x0, 0x0, 0x0, 0x0, 0x0, 0x0, 0x0
.long 0x0, 0x0, 0x0, 0x0, 0x0, 0x0, 0x0, 0x0
.long 0x0, 0x0, 0x0, 0x0, 0x0, 0x0, 0x0, 0x0
.long 0x0, 0x0, 0x0, 0x0, 0x0, 0x0, 0x0, 0x0
.long 0x0, 0x0, 0x0, 0x0, 0x0, 0x0, 0x0, 0x0
.long 0x0, 0x3f800000, 0x3f803f80, 0x0, 0x0, 0x0, 0x3f803f80, 0x3f80
.long 0x0, 0x0, 0x3f800000, 0x3f803f80, 0x0, 0x0, 0x0, 0x3f803f80
.long 0x0, 0x0, 0x0, 0x3f800000, 0x0, 0x0, 0x0, 0x0
.long 0x0, 0x0, 0x0, 0x0, 0x0, 0x0, 0x0, 0x0
.long 0x0, 0x0, 0x0, 0x0, 0x0, 0x0, 0x0, 0x0
.long 0x0, 0x0, 0x0, 0x0, 0x0, 0x0, 0x0, 0x0
.long 0x0, 0x0, 0x0, 0x0, 0x0, 0x0, 0x0, 0x0
.long 0x0, 0x0, 0x0, 0x0, 0x0, 0x0, 0x0, 0x0
.long 0x0, 0x0, 0x0, 0x0, 0x0, 0x0, 0x0, 0x0
.long 0x0, 0x0, 0x0, 0x0, 0x3f80, 0x0, 0x0, 0x0
.long 0x3f803f80, 0x0, 0x0, 0x0, 0x3f803f80, 0x3f80, 0x0, 0x0
.long 0x3f800000, 0x3f803f80, 0x0, 0x0, 0x0, 0x3f803f80, 0x3f80, 0x0
.long 0x0, 0x3f800000, 0x3f803f80, 0x0, 0x0, 0x0, 0x3f803f80, 0x3f80
.long 0x0, 0x0, 0x3f800000, 0x3f803f80, 0x0, 0x0, 0x0, 0x3f803f80
.long 0x0, 0x0, 0x0, 0x3f800000, 0x0, 0x0, 0x0, 0x0
.long 0x0, 0x0, 0x0, 0x0, 0x0, 0x0, 0x0, 0x0
.long 0x0, 0x0, 0x0, 0x0, 0x0, 0x0, 0x0, 0x0
.long 0x0, 0x0, 0x0, 0x0, 0x0, 0x0, 0x0, 0x0
.long 0x0, 0x0, 0x0, 0x0, 0x0, 0x0, 0x0, 0x0
.long 0x0, 0x0, 0x0, 0x0, 0x0, 0x0, 0x0, 0x0
.long 0x0, 0x0, 0x0, 0x0, 0x0, 0x0, 0x0, 0x0
.long 0x0, 0x0, 0x0, 0x0, 0x3f80, 0x0, 0x0, 0x0
.long 0x3f803f80, 0x0, 0x0, 0x0, 0x3f803f80, 0x3f80, 0x0, 0x0
.long 0x3f800000, 0x3f803f80, 0x0, 0x0, 0x0, 0x3f803f80, 0x3f80, 0x0
.long 0x0, 0x0, 0x0, 0x3f803f80, 0x0, 0x0, 0x0, 0x3f800000
.long 0x0, 0x0, 0x0, 0x0, 0x0, 0x0, 0x0, 0x0
.long 0x0, 0x0, 0x0, 0x0, 0x0, 0x0, 0x0, 0x0
.long 0x0, 0x0, 0x0, 0x0, 0x0, 0x0, 0x0, 0x0
.long 0x0, 0x0, 0x0, 0x0, 0x0, 0x0, 0x0, 0x0
.long 0x0, 0x0, 0x0, 0x0, 0x0, 0x0, 0x0, 0x0
.long 0x0, 0x0, 0x0, 0x0, 0x0, 0x0, 0x0, 0x0
.long 0x0, 0x0, 0x0, 0x0, 0x0, 0x0, 0x0, 0x0
.long 0x3f803f80, 0x3f80, 0x0, 0x0, 0x3f803f80, 0x3f803f80, 0x0, 0x0
.long 0x3f803f80, 0x3f803f80, 0x3f80, 0x0, 0x3f800000, 0x3f803f80, 0x3f803f80, 0x0
.long 0x0, 0x3f803f80, 0x3f803f80, 0x3f80, 0x0, 0x3f800000, 0x3f803f80, 0x3f803f80
.long 0x0, 0x0, 0x3f803f80, 0x3f803f80, 0x0, 0x0, 0x3f800000, 0x3f803f80
.long 0x0, 0x0, 0x0, 0x3f803f80, 0x0, 0x0, 0x0, 0x3f800000
.long 0x0, 0x0, 0x0, 0x0, 0x0, 0x0, 0x0, 0x0
.long 0x0, 0x0, 0x0, 0x0, 0x0, 0x0, 0x0, 0x0
.long 0x0, 0x0, 0x0, 0x0, 0x0, 0x0, 0x0, 0x0
.long 0x0, 0x0, 0x0, 0x0, 0x0, 0x0, 0x0, 0x0
.long 0x0, 0x0, 0x0, 0x0, 0x0, 0x0, 0x0, 0x0
.long 0x0, 0x0, 0x0, 0x0, 0x0, 0x0, 0x0, 0x0
.long 0x3f80, 0x0, 0x0, 0x0, 0x3f803f80, 0x0, 0x0, 0x0
.long 0x3f803f80, 0x3f80, 0x0, 0x0, 0x3f803f80, 0x3f803f80, 0x0, 0x0
.long 0x3f803f80, 0x3f803f80, 0x3f80, 0x0, 0x3f800000, 0x3f803f80, 0x3f803f80, 0x0
.long 0x0, 0x3f803f80, 0x3f803f80, 0x3f80, 0x0, 0x3f800000, 0x3f803f80, 0x3f803f80
.long 0x0, 0x0, 0x3f803f80, 0x3f803f80, 0x0, 0x0, 0x3f800000, 0x3f803f80
.long 0x0, 0x0, 0x0, 0x0, 0x0, 0x0, 0x0, 0x0
.long 0x0, 0x0, 0x0, 0x0, 0x0, 0x0, 0x0, 0x0
.long 0x0, 0x0, 0x0, 0x0, 0x0, 0x0, 0x0, 0x0
.long 0x0, 0x0, 0x0, 0x0, 0x0, 0x0, 0x0, 0x0
.long 0x0, 0x0, 0x0, 0x0, 0x0, 0x0, 0x0, 0x0
.long 0x0, 0x0, 0x0, 0x0, 0x0, 0x0, 0x0, 0x0
.long 0x0, 0x0, 0x0, 0x0, 0x0, 0x0, 0x0, 0x0
.long 0x3f80, 0x0, 0x0, 0x0, 0x3f803f80, 0x0, 0x0, 0x0
.long 0x0, 0x3f800000, 0x3f803f80, 0x0, 0x0, 0x0, 0x3f803f80, 0x3f80
.long 0x0, 0x0, 0x3f800000, 0x3f803f80, 0x0, 0x0, 0x0, 0x3f803f80
.long 0x0, 0x0, 0x0, 0x3f800000, 0x0, 0x0, 0x0, 0x0
.long 0x0, 0x0, 0x0, 0x0, 0x0, 0x0, 0x0, 0x0
.long 0x0, 0x0, 0x0, 0x0, 0x0, 0x0, 0x0, 0x0
.long 0x0, 0x0, 0x0, 0x0, 0x0, 0x0, 0x0, 0x0
.long 0x0, 0x0, 0x0, 0x0, 0x0, 0x0, 0x0, 0x0
.long 0x0, 0x0, 0x0, 0x0, 0x0, 0x0, 0x0, 0x0
.long 0x0, 0x0, 0x0, 0x0, 0x0, 0x0, 0x0, 0x0
.long 0x0, 0x0, 0x0, 0x0, 0x3f80, 0x0, 0x0, 0x0
.long 0x3f803f80, 0x0, 0x0, 0x0, 0x3f803f80, 0x3f80, 0x0, 0x0
.long 0x3f800000, 0x3f803f80, 0x0, 0x0, 0x0, 0x3f803f80, 0x3f80, 0x0
.long 0x0, 0x3f800000, 0x3f803f80, 0x0, 0x0, 0x0, 0x3f803f80, 0x3f80
.long 0x0, 0x0, 0x3f800000, 0x3f803f80, 0x0, 0x0, 0x0, 0x3f803f80
.long 0x0, 0x0, 0x0, 0x3f800000, 0x0, 0x0, 0x0, 0x0
.long 0x0, 0x0, 0x0, 0x0, 0x0, 0x0, 0x0, 0x0
.long 0x0, 0x0, 0x0, 0x0, 0x0, 0x0, 0x0, 0x0
.long 0x0, 0x0, 0x0, 0x0, 0x0, 0x0, 0x0, 0x0
.long 0x0, 0x0, 0x0, 0x0, 0x0, 0x0, 0x0, 0x0
.long 0x0, 0x0, 0x0, 0x0, 0x0, 0x0, 0x0, 0x0
.long 0x0, 0x0, 0x0, 0x0, 0x0, 0x0, 0x0, 0x0
.long 0x0, 0x0, 0x0, 0x0, 0x3f80, 0x0, 0x0, 0x0
.long 0x3f803f80, 0x0, 0x0, 0x0, 0x3f803f80, 0x3f80, 0x0, 0x0
.long 0x3f800000, 0x3f803f80, 0x0, 0x0, 0x0, 0x3f803f80, 0x3f80, 0x0
.long 0x0, 0x0, 0x0, 0x0, 0x0, 0x0, 0x0, 0x0
.long 0x0, 0x0, 0x0, 0x0, 0x0, 0x0, 0x0, 0x0
.long 0x0, 0x0, 0x0, 0x0, 0x0, 0x0, 0x0, 0x0
.long 0x0, 0x0, 0x0, 0x0, 0x0, 0x0, 0x0, 0x0
.long 0x0, 0x0, 0x0, 0x0, 0x0, 0x0, 0x0, 0x0
.long 0x0, 0x0, 0x0, 0x0, 0x0, 0x0, 0x0, 0x0
.long 0x0, 0x0, 0x0, 0x0, 0x0, 0x0, 0x0, 0x0
.long 0x0, 0x0, 0x0, 0x0, 0x0, 0x0, 0x0, 0x0
.long 0x0, 0x0, 0x3f800000, 0x3f803f80, 0x0, 0x0, 0x0, 0x3f803f80
.long 0x0, 0x0, 0x0, 0x3f800000, 0x0, 0x0, 0x0, 0x0
.long 0x0, 0x0, 0x0, 0x0, 0x0, 0x0, 0x0, 0x0
.long 0x0, 0x0, 0x0, 0x0, 0x0, 0x0, 0x0, 0x0
.long 0x0, 0x0, 0x0, 0x0, 0x0, 0x0, 0x0, 0x0
.long 0x0, 0x0, 0x0, 0x0, 0x0, 0x0, 0x0, 0x0
.long 0x0, 0x0, 0x0, 0x0, 0x0, 0x0, 0x0, 0x0
.long 0x0, 0x0, 0x0, 0x0, 0x0, 0x0, 0x0, 0x0
.long 0x3f803f80, 0x3f803f80, 0x0, 0x0, 0x3f803f80, 0x3f803f80, 0x3f80, 0x0
.long 0x3f803f80, 0x3f803f80, 0x3f803f80, 0x0, 0x3f803f80, 0x3f803f80, 0x3f803f80, 0x3f80
.long 0x3f800000, 0x3f803f80, 0x3f803f80, 0x3f803f80, 0x0, 0x3f803f80, 0x3f803f80, 0x3f803f80
.long 0x0, 0x3f800000, 0x3f803f80, 0x3f803f80, 0x0, 0x0, 0x3f803f80, 0x3f803f80
.long 0x0, 0x0, 0x3f800000, 0x3f803f80, 0x0, 0x0, 0x0, 0x3f803f80
.long 0x0, 0x0, 0x0, 0x3f800000, 0x0, 0x0, 0x0, 0x0
.long 0x0, 0x0, 0x0, 0x0, 0x0, 0x0, 0x0, 0x0
.long 0x0, 0x0, 0x0, 0x0, 0x0, 0x0, 0x0, 0x0
.long 0x0, 0x0, 0x0, 0x0, 0x0, 0x0, 0x0, 0x0
.long 0x0, 0x0, 0x0, 0x0, 0x0, 0x0, 0x0, 0x0
.long 0x0, 0x0, 0x0, 0x0, 0x3f80, 0x0, 0x0, 0x0
.long 0x3f803f80, 0x0, 0x0, 0x0, 0x3f803f80, 0x3f80, 0x0, 0x0
.long 0x3f803f80, 0x3f803f80, 0x0, 0x0, 0x3f803f80, 0x3f803f80, 0x3f80, 0x0
.long 0x3f803f80, 0x3f803f80, 0x3f803f80, 0x0, 0x3f803f80, 0x3f803f80, 0x3f803f80, 0x3f80
.long 0x3f800000, 0x3f803f80, 0x3f803f80, 0x3f803f80, 0x0, 0x3f803f80, 0x3f803f80, 0x3f803f80
.long 0x0, 0x3f800000, 0x3f803f80, 0x3f803f80, 0x0, 0x0, 0x3f803f80, 0x3f803f80
.long 0x0, 0x0, 0x0, 0x0, 0x0, 0x0, 0x0, 0x0
.long 0x0, 0x0, 0x0, 0x0, 0x0, 0x0, 0x0, 0x0
.long 0x0, 0x0, 0x0, 0x0, 0x0, 0x0, 0x0, 0x0
.long 0x0, 0x0, 0x0, 0x0, 0x0, 0x0, 0x0, 0x0
.long 0x0, 0x0, 0x0, 0x0, 0x0, 0x0, 0x0, 0x0
.long 0x0, 0x0, 0x0, 0x0, 0x0, 0x0, 0x0, 0x0
.long 0x0, 0x0, 0x0, 0x0, 0x3f80, 0x0, 0x0, 0x0
.long 0x3f803f80, 0x0, 0x0, 0x0, 0x3f803f80, 0x3f80, 0x0, 0x0
.long 0x0, 0x0, 0x3f803f80, 0x3f803f80, 0x0, 0x0, 0x3f800000, 0x3f803f80
.long 0x0, 0x0, 0x0, 0x3f803f80, 0x0, 0x0, 0x0, 0x3f800000
.long 0x0, 0x0, 0x0, 0x0, 0x0, 0x0, 0x0, 0x0
.long 0x0, 0x0, 0x0, 0x0, 0x0, 0x0, 0x0, 0x0
.long 0x0, 0x0, 0x0, 0x0, 0x0, 0x0, 0x0, 0x0
.long 0x0, 0x0, 0x0, 0x0, 0x0, 0x0, 0x0, 0x0
.long 0x0, 0x0, 0x0, 0x0, 0x0, 0x0, 0x0, 0x0
.long 0x0, 0x0, 0x0, 0x0, 0x0, 0x0, 0x0, 0x0
.long 0x3f803f80, 0x3f803f80, 0x3f80, 0x0, 0x3f803f80, 0x3f803f80, 0x3f803f80, 0x0
.long 0x3f803f80, 0x3f803f80, 0x3f803f80, 0x3f80, 0x3f803f80, 0x3f803f80, 0x3f803f80, 0x3f803f80
.long 0x3f803f80, 0x3f803f80, 0x3f803f80, 0x3f803f80, 0x3f800000, 0x3f803f80, 0x3f803f80, 0x3f803f80
.long 0x0, 0x3f803f80, 0x3f803f80, 0x3f803f80, 0x0, 0x3f800000, 0x3f803f80, 0x3f803f80
.long 0x0, 0x0, 0x3f803f80, 0x3f803f80, 0x0, 0x0, 0x3f800000, 0x3f803f80
.long 0x0, 0x0, 0x0, 0x3f803f80, 0x0, 0x0, 0x0, 0x3f800000
.long 0x0, 0x0, 0x0, 0x0, 0x0, 0x0, 0x0, 0x0
.long 0x0, 0x0, 0x0, 0x0, 0x0, 0x0, 0x0, 0x0
.long 0x0, 0x0, 0x0, 0x0, 0x0, 0x0, 0x0, 0x0
.long 0x0, 0x0, 0x0, 0x0, 0x0, 0x0, 0x0, 0x0
.long 0x3f80, 0x0, 0x0, 0x0, 0x3f803f80, 0x0, 0x0, 0x0
.long 0x3f803f80, 0x3f80, 0x0, 0x0, 0x3f803f80, 0x3f803f80, 0x0, 0x0
.long 0x3f803f80, 0x3f803f80, 0x3f80, 0x0, 0x3f803f80, 0x3f803f80, 0x3f803f80, 0x0
.long 0x3f803f80, 0x3f803f80, 0x3f803f80, 0x3f80, 0x3f803f80, 0x3f803f80, 0x3f803f80, 0x3f803f80
.long 0x3f803f80, 0x3f803f80, 0x3f803f80, 0x3f803f80, 0x3f800000, 0x3f803f80, 0x3f803f80, 0x3f803f80
.long 0x0, 0x3f803f80, 0x3f803f80, 0x3f803f80, 0x0, 0x3f800000, 0x3f803f80, 0x3f803f80
.long 0x0, 0x0, 0x0, 0x0, 0x0, 0x0, 0x0, 0x0
.long 0x0, 0x0, 0x0, 0x0, 0x0, 0x0, 0x0, 0x0
.long 0x0, 0x0, 0x0, 0x0, 0x0, 0x0, 0x0, 0x0
.long 0x0, 0x0, 0x0, 0x0, 0x0, 0x0, 0x0, 0x0
.long 0x0, 0x0, 0x0, 0x0, 0x0, 0x0, 0x0, 0x0
.long 0x0, 0x0, 0x0, 0x0, 0x0, 0x0, 0x0, 0x0
.long 0x3f80, 0x0, 0x0, 0x0, 0x3f803f80, 0x0, 0x0, 0x0
.long 0x3f803f80, 0x3f80, 0x0, 0x0, 0x3f803f80, 0x3f803f80, 0x0, 0x0
K_stop:
.section .rodata,"a"
.p2align 6
.amdhsa_kernel parallel_sum__ssm_conv_s4d__glu_gated_reglu__prompt_kernel
  .amdhsa_next_free_vgpr 256
  .amdhsa_next_free_sgpr 102
  .amdhsa_accum_offset 256
  .amdhsa_group_segment_fixed_size 0
  .amdhsa_kernarg_size 112
  .amdhsa_user_sgpr_count 2
  .amdhsa_user_sgpr_kernarg_segment_ptr 1
  .amdhsa_system_sgpr_workgroup_id_x 1
  .amdhsa_float_denorm_mode_32 3
.end_amdhsa_kernel
```
